```python
import torch

def _softmax(x, axis=-1):
    return torch.softmax(x, dim=axis)
def _gelu(x):
    return torch.nn.functional.gelu(x, approximate="tanh")
def _silu(x):
    return torch.nn.functional.silu(x)
def _sigmoid(x):
    return torch.sigmoid(x)
def _layernorm(x, axis=-1, eps=1e-5):
    m = x.mean(dim=axis, keepdim=True)
    v = x.var(dim=axis, keepdim=True, unbiased=False)
    return (x - m) / torch.sqrt(v + eps)
def _scatter_add(tgt, idx, src, axis=0):
    return tgt.clone().index_add_(axis, idx, src)
def _segment_sum(src, seg, n):
    out = torch.zeros((n,) + src.shape[1:], dtype=src.dtype)
    return out.index_add_(0, seg, src)
def _pad(x, pw):
    flat = tuple(v for pair in reversed(pw) for v in pair)
    return torch.nn.functional.pad(x, flat)

kernel_name = 'recurrent_scan__ssm_conv_s5__glu_gated_reglu__prompt'

def setup_inputs():

    _w = (lambda a: (lambda t: t.to(torch.bfloat16) if t.is_floating_point() else t)(torch.as_tensor(a)))
    def _A_setup():
        B, S, D = 1, 2048, 640
        P = D
        Lambda_re = -0.5 * (lambda _x: torch.exp(torch.as_tensor(_x)))((lambda *s: torch.randn(*s, dtype=torch.bfloat16) * 0.8)(P))
        Lambda_im = (lambda *s: torch.randn(*s, dtype=torch.bfloat16) * 0.8)(P) * 1.0
        B_re = (lambda *s: torch.randn(*s, dtype=torch.bfloat16) * 0.8)(P, D) * (D ** -0.5)
        B_im = (lambda *s: torch.randn(*s, dtype=torch.bfloat16) * 0.8)(P, D) * (D ** -0.5)
        C_re = (lambda *s: torch.randn(*s, dtype=torch.bfloat16) * 0.8)(D, P) * (P ** -0.5)
        C_im = (lambda *s: torch.randn(*s, dtype=torch.bfloat16) * 0.8)(D, P) * (P ** -0.5)
        log_dt = (lambda *s: torch.randn(*s, dtype=torch.bfloat16) * 0.8)(P) * 0.3 - 2.0
        Dskip = (lambda *s: torch.randn(*s, dtype=torch.bfloat16) * 0.8)(D)
        return {
            "x": _w((lambda *s: torch.randn(*s, dtype=torch.bfloat16) * 0.05)(B, S, D)),
            "Lambda_re": _w(Lambda_re),
            "Lambda_im": _w(Lambda_im),
            "B_re": _w(B_re),
            "B_im": _w(B_im),
            "C_re": _w(C_re),
            "C_im": _w(C_im),
            "log_dt": _w(log_dt),
            "Dskip": _w(Dskip),
        }
    _A_in = _A_setup()

    def _B_setup():
        B, S, D, F = 1, 2048, 640, 1728
        return {
            "x": _w((lambda *s: torch.randn(*s, dtype=torch.bfloat16) * 0.05)(B, S, D)),
            "W_gate": _w((lambda *s: torch.randn(*s, dtype=torch.bfloat16) * 0.2)(D, F) * (2.0 / D) ** 0.5),
            "W_up": _w((lambda *s: torch.randn(*s, dtype=torch.bfloat16) * 0.2)(D, F) * (2.0 / D) ** 0.5),
            "W_down": _w((lambda *s: torch.randn(*s, dtype=torch.bfloat16) * 0.2)(F, D) * (1.0 / F) ** 0.5),
        }
    _B_in = _B_setup()

    return {
        "A_x": _A_in["x"],
        "A_Lambda_re": _A_in["Lambda_re"],
        "A_Lambda_im": _A_in["Lambda_im"],
        "A_B_re": _A_in["B_re"],
        "A_B_im": _A_in["B_im"],
        "A_C_re": _A_in["C_re"],
        "A_C_im": _A_in["C_im"],
        "A_log_dt": _A_in["log_dt"],
        "A_Dskip": _A_in["Dskip"],
        "B_x": _B_in["x"],
        "B_W_gate": _B_in["W_gate"],
        "B_W_up": _B_in["W_up"],
        "B_W_down": _B_in["W_down"],
    }

def reference(A_x, A_Lambda_re, A_Lambda_im, A_B_re, A_B_im, A_C_re, A_C_im, A_log_dt, A_Dskip, B_x, B_W_gate, B_W_up, B_W_down):
    def _A_ref(x, Lambda_re, Lambda_im, B_re, B_im, C_re, C_im, log_dt, Dskip):
        Bsz, L, H = x.shape
        Lam = Lambda_re + 1j * Lambda_im
        Bmat = B_re + 1j * B_im
        Cmat = C_re + 1j * C_im
        dt = torch.exp(log_dt)
        Lam_bar = torch.exp(dt * Lam)
        B_bar = ((Lam_bar - 1.0) / Lam)[:, None] * Bmat
        Bu = torch.einsum("bld,pd->blp", x + 0j, B_bar)
        h = torch.zeros_like(Bu[:, 0, :])
        hs = []
        for t in range(L):
            h = Lam_bar[None, :] * h + Bu[:, t, :]
            hs.append(h)
        hseq = torch.stack(hs, 1)
        y = 2.0 * torch.einsum("blp,dp->bld", hseq, Cmat).real + x * Dskip[None, None, :]
        return y

    def _B_ref(x, W_gate, W_up, W_down):
        gate = torch.einsum("bsd,df->bsf", x, W_gate)
        up = torch.einsum("bsd,df->bsf", x, W_up)
        gate = gate * (lambda x, dt: x.to(dt))(gate > 0, gate.dtype)
        h = gate * up
        return torch.einsum("bsf,fd->bsd", h, W_down)

    x = A_x
    xn = _layernorm(x, axis=-1)
    s = _A_ref(xn, A_Lambda_re, A_Lambda_im, A_B_re, A_B_im, A_C_re, A_C_im, A_log_dt, A_Dskip)
    g = _silu(_B_ref(xn, B_W_gate, B_W_up, B_W_down))
    return x + s * g
```

```asm
; @launch grid=(256,1,1) block=(512,1,1) lds=163840
.amdgcn_target "amdgcn-amd-amdhsa--gfx950"
.text
.globl recurrent_scan__ssm_conv_s5__glu_gated_reglu__prompt_kernel
.p2align 8
.type recurrent_scan__ssm_conv_s5__glu_gated_reglu__prompt_kernel,@function
recurrent_scan__ssm_conv_s5__glu_gated_reglu__prompt_kernel:
K1_BEG:
  s_cmp_ge_u32 s2, 256
  s_cbranch_scc1 K1_END
  s_load_dwordx16 s[16:31], s[0:1], 0
  s_load_dwordx16 s[32:47], s[0:1], 64
  v_lshrrev_b32 v1, 6, v0
  v_and_b32 v0, 63, v0
  v_readfirstlane_b32 s5, v1
  s_and_b32 s10, s2, 1
  s_lshl_b32 s10, s10, 2
  s_bfe_u32 s11, s2, 0x20003
  s_add_u32 s3, s10, s11
  s_lshr_b32 s10, s2, 5
  s_lshl_b32 s10, s10, 2
  s_bfe_u32 s11, s2, 0x20001
  s_add_u32 s4, s10, s11
  s_and_b32 s7, s5, 3
  v_lshrrev_b32 v36, 3, v0
  v_and_b32 v37, 7, v0
  v_lshrrev_b32 v38, 1, v36
  v_xor_b32 v38, v38, v37
  v_lshlrev_b32 v38, 4, v38
  v_lshrrev_b32 v39, 2, v36
  v_and_b32 v1, 3, v36
  v_lshl_add_u32 v39, v39, 5, v1
  v_mul_u32_u24 v39, 1280, v39
  v_add_u32 v2, v39, v38
  v_xor_b32 v3, 64, v2
  s_lshl_b32 s70, s3, 2
  s_add_u32 s70, s70, s7
  s_mul_i32 s70, s70, 81920
  s_lshl_b32 s73, s7, 13
  s_lshr_b32 s76, s3, 2
  s_mul_i32 s76, s76, 5
  s_lshl_b32 s12, s76, 7
  s_add_u32 s12, s12, s70
  s_mov_b32 s54, 2621440
  s_mov_b32 s55, 0x20000
  s_cmp_ge_u32 s5, 4
  s_waitcnt lgkmcnt(0)
  s_mov_b32 s52, s16
  s_mov_b32 s53, s17
  s_cbranch_scc0 K1_NA
  s_add_u32 m0, s73, 0
  s_add_u32 s13, s12, 0
  buffer_load_dwordx4 v2, s[52:55], s13 offen lds
  s_add_u32 m0, s73, 1024
  s_add_u32 s13, s12, 5120
  buffer_load_dwordx4 v3, s[52:55], s13 offen lds
  s_add_u32 m0, s73, 2048
  s_add_u32 s13, s12, 10240
  buffer_load_dwordx4 v2, s[52:55], s13 offen lds
  s_add_u32 m0, s73, 3072
  s_add_u32 s13, s12, 15360
  buffer_load_dwordx4 v3, s[52:55], s13 offen lds
  s_add_u32 m0, s73, 4096
  s_add_u32 s13, s12, 20480
  buffer_load_dwordx4 v2, s[52:55], s13 offen lds
  s_add_u32 m0, s73, 5120
  s_add_u32 s13, s12, 25600
  buffer_load_dwordx4 v3, s[52:55], s13 offen lds
  s_add_u32 m0, s73, 6144
  s_add_u32 s13, s12, 30720
  buffer_load_dwordx4 v2, s[52:55], s13 offen lds
  s_add_u32 m0, s73, 7168
  s_add_u32 s13, s12, 35840
  buffer_load_dwordx4 v3, s[52:55], s13 offen lds
K1_NA:
  s_add_u32 s10, s46, 17825792
  s_addc_u32 s11, s47, 0
  s_mov_b32 s48, s46
  s_and_b32 s49, s47, 0xffff
  s_mov_b32 s50, 20971520
  s_mov_b32 s51, 0x20000
  s_load_dword s6, s[10:11], 0
  s_cmp_lt_u32 s4, 23
  s_cbranch_scc0 K1_B
  s_mov_b32 s8, s4
  s_lshl_b32 s9, s4, 2
  s_cmp_ge_u32 s5, 4
  s_cbranch_scc0 K1_CA
  s_cmp_ge_u32 s7, 2
  s_cselect_b64 s[10:11], s[24:25], s[22:23]
  s_cselect_b64 s[12:13], s[38:39], s[36:37]
  s_mov_b32 s56, s10
  s_and_b32 s57, s11, 0xffff
  s_mov_b32 s58, 819200
  s_mov_b32 s59, 0x20000
  s_mov_b32 s60, s12
  s_and_b32 s61, s13, 0xffff
  s_mov_b32 s62, 2211840
  s_mov_b32 s63, 0x20000
  v_mul_u32_u24 v39, 1280, v36
  v_add_u32 v4, v39, v38
  s_and_b32 s10, s7, 1
  s_lshl_b32 s11, s10, 6
  v_xor_b32 v4, s11, v4
  s_lshr_b32 s11, s7, 1
  s_lshl_b32 s11, s11, 2
  v_and_b32 v38, 2, v36
  v_xor_b32 v38, v38, v37
  v_xor_b32 v38, s11, v38
  v_mul_u32_u24 v39, 3456, v36
  v_lshl_add_u32 v5, v38, 4, v39
  s_lshl_b32 s71, s8, 1
  s_add_u32 s71, s71, s10
  s_mul_i32 s71, s71, 10240
  s_mul_i32 s72, s10, 110592
  s_lshl_b32 s11, s9, 5
  s_add_u32 s72, s72, s11
  s_lshl_b32 s74, s7, 10
  s_lshl_b32 s75, s7, 12
  s_mov_b32 s77, s76
  s_lshl_b32 s10, s76, 7
  s_mul_i32 s11, s76, 221184
  s_add_u32 s12, s10, s70
  s_add_u32 s10, s10, s71
  s_add_u32 s11, s11, s72
  s_add_u32 m0, s74, 32768
  s_add_u32 s13, s10, 0
  buffer_load_dwordx4 v4, s[56:59], s13 offen lds
  s_add_u32 m0, s75, 36864
  s_add_u32 s13, s11, 0
  buffer_load_dwordx4 v5, s[60:63], s13 offen lds
  s_add_u32 m0, s75, 37888
  s_add_u32 s13, s11, 27648
  buffer_load_dwordx4 v5, s[60:63], s13 offen lds
  s_add_u32 m0, s75, 38912
  s_add_u32 s13, s11, 55296
  buffer_load_dwordx4 v5, s[60:63], s13 offen lds
  s_add_u32 m0, s75, 39936
  s_add_u32 s13, s11, 82944
  buffer_load_dwordx4 v5, s[60:63], s13 offen lds
  s_add_u32 s76, s76, 1
  s_cmp_eq_u32 s76, 10
  s_cselect_b32 s76, 0, s76
  s_lshl_b32 s10, s76, 7
  s_mul_i32 s11, s76, 221184
  s_add_u32 s12, s10, s70
  s_add_u32 s10, s10, s71
  s_add_u32 s11, s11, s72
  s_add_u32 m0, s74, 86016
  s_add_u32 s13, s10, 0
  buffer_load_dwordx4 v4, s[56:59], s13 offen lds
  s_add_u32 m0, s75, 90112
  s_add_u32 s13, s11, 0
  buffer_load_dwordx4 v5, s[60:63], s13 offen lds
  s_add_u32 m0, s75, 91136
  s_add_u32 s13, s11, 27648
  buffer_load_dwordx4 v5, s[60:63], s13 offen lds
  s_add_u32 m0, s75, 92160
  s_add_u32 s13, s11, 55296
  buffer_load_dwordx4 v5, s[60:63], s13 offen lds
  s_add_u32 m0, s75, 93184
  s_add_u32 s13, s11, 82944
  buffer_load_dwordx4 v5, s[60:63], s13 offen lds
  s_add_u32 m0, s73, 53248
  s_add_u32 s13, s12, 0
  buffer_load_dwordx4 v2, s[52:55], s13 offen lds
  s_add_u32 m0, s73, 54272
  s_add_u32 s13, s12, 5120
  buffer_load_dwordx4 v3, s[52:55], s13 offen lds
  s_add_u32 m0, s73, 55296
  s_add_u32 s13, s12, 10240
  buffer_load_dwordx4 v2, s[52:55], s13 offen lds
  s_waitcnt lgkmcnt(0)
  s_mul_i32 s6, s6, 0x41c64e6d
  s_add_u32 s6, s6, 0x7f4a7c15
  s_and_b32 s10, s2, 7
  s_lshr_b32 s11, s2, 3
  s_lshl_b32 s86, s10, 2
  s_and_b32 s12, s11, 3
  s_add_u32 s86, s86, s12
  s_lshr_b32 s87, s11, 2
  s_mul_i32 s89, s86, 94
  s_add_u32 s89, s89, s7
  s_add_u32 s89, s89, 40
  s_lshl_b32 s89, s89, 12
  s_mul_i32 s88, s87, 94
  s_add_u32 s88, s88, s7
  s_add_u32 s88, s88, 40
  s_mul_i32 s88, s88, 5120
  s_add_u32 s88, s88, 12582912
  s_mul_i32 s90, s7, 17408
  s_cmp_eq_u32 s7, 3
  s_cselect_b32 s90, 145408, s90
  s_mul_i32 s99, s87, 0
  s_lshr_b32 s99, s99, 3
  s_and_b32 s12, s86, 3
  s_mul_i32 s12, s12, 0
  s_add_u32 s99, s99, s12
  s_cmp_ge_u32 s99, 13
  s_cselect_b32 s12, 13, 0
  s_sub_u32 s99, s99, s12
  v_and_b32 v7, 31, v0
  v_lshlrev_b32 v7, 3, v7
  s_and_b32 s78, s7, 3
  s_lshl_b32 s10, s78, 1
  v_and_b32 v36, 31, v0
  v_lshrrev_b32 v37, 5, v0
  v_bfe_u32 v38, v0, 1, 3
  v_xor_b32 v38, v38, v37
  v_lshlrev_b32 v36, 7, v36
  v_xor_b32 v39, 0, v38
  v_lshl_add_u32 v20, v39, 4, v36
  v_xor_b32 v39, 2, v38
  v_lshl_add_u32 v21, v39, 4, v36
  v_xor_b32 v39, 4, v38
  v_lshl_add_u32 v22, v39, 4, v36
  v_xor_b32 v39, 6, v38
  v_lshl_add_u32 v23, v39, 4, v36
  v_bfe_u32 v36, v0, 2, 2
  v_lshl_add_u32 v36, v37, 3, v36
  v_lshlrev_b32 v36, 7, v36
  v_bfe_u32 v38, v0, 4, 1
  v_lshl_add_u32 v36, v38, 13, v36
  v_bfe_u32 v39, v0, 1, 1
  v_lshl_add_u32 v36, v39, 3, v36
  v_add_u32 v36, 36864, v36
  v_and_b32 v39, 1, v0
  v_lshlrev_b32 v38, 2, v38
  v_bfe_u32 v1, v0, 3, 1
  v_lshl_or_b32 v38, v1, 1, v38
  v_xor_b32 v38, v38, v39
  v_xor_b32 v39, s10, v38
  v_lshl_add_u32 v24, v39, 4, v36
  s_and_b32 s79, s7, 0
  s_lshl_b32 s10, s79, 12
  s_add_u32 s10, s10, 32768
  v_add_u32 v20, s10, v20
  v_mov_b32 v28, 0x3f803f80
  v_add_u32 v21, s10, v21
  v_mov_b32 v29, 0x3f803f80
  v_add_u32 v22, s10, v22
  v_mov_b32 v30, 0x3f803f80
  v_add_u32 v23, s10, v23
  v_mov_b32 v31, 0x3f803f80
  s_add_u32 s78, s78, 1
  s_lshl_b32 s78, s78, 8
  s_lshl_b32 s79, s79, 8
  s_mul_i32 s80, s4, 12800
  s_add_u32 s80, s80, 16842752
  s_lshl_b32 s10, s7, 6
  v_add_u32 v32, s10, v0
  v_min_u32 v33, 159, v32
  v_lshlrev_b32 v33, 3, v33
  v_bfe_u32 v36, v0, 2, 1
  v_lshl_add_u32 v34, v36, 5, s10
  v_lshrrev_b32 v36, 5, v0
  v_lshl_add_u32 v34, v36, 4, v34
  v_bfe_u32 v36, v0, 3, 2
  v_lshl_add_u32 v34, v36, 2, v34
  v_and_b32 v36, 3, v0
  v_add_lshl_u32 v34, v34, v36, 3
  s_lshl_b32 s81, s3, 11
  s_add_u32 s81, s81, 16777216
  v_lshlrev_b32 v27, 4, v0
  v_add_u32 v25, 1024, v27
  s_mul_i32 s95, s7, 5120
  s_mov_b32 s94, 17891328
  s_lshl_b32 s10, s3, 8
  s_lshl_b32 s11, s4, 3
  s_add_u32 s10, s10, s11
  s_lshl_b32 s11, s7, 1
  s_add_u32 s10, s10, s11
  v_lshrrev_b32 v36, 5, v0
  v_add_u32 v36, s10, v36
  v_lshlrev_b32 v160, 3, v36
  v_mul_u32_u24 v36, 1280, v36
  v_and_b32 v37, 31, v0
  v_lshl_add_u32 v161, v37, 3, v36
  v_lshrrev_b32 v36, 3, v0
  v_mul_u32_u24 v185, 1280, v36
  v_and_b32 v37, 7, v0
  v_lshl_add_u32 v185, v37, 4, v185
  s_lshl_b32 s13, s7, 10
  s_add_u32 s13, s13, 159744
  v_lshl_add_u32 v186, v0, 4, s13
  s_lshl_b32 s82, s2, 2
  s_add_u32 s82, s82, s7
  s_mov_b32 s21, s82
  s_min_u32 s82, s82, 939
  s_sub_u32 s10, s82, 400
  s_cmp_lt_u32 s82, 400
  s_cselect_b32 s10, s82, s10
  s_mul_i32 s14, s10, 6554
  s_lshr_b32 s14, s14, 16
  s_mul_i32 s11, s14, 10
  s_sub_u32 s15, s10, s11
  s_lshl_b32 s83, s15, 7
  s_lshl_b32 s15, s15, 2
  s_cmp_lt_u32 s82, 400
  s_cbranch_scc0 Ha_TW
  s_mov_b32 s64, s26
  s_and_b32 s65, s27, 0xffff
  s_mov_b32 s66, 819200
  s_mov_b32 s67, 0x20000
  s_mov_b32 s16, s28
  s_and_b32 s17, s29, 0xffff
  s_mov_b32 s18, 819200
  s_mov_b32 s19, 0x20000
  s_mul_i32 s10, s14, 20480
  s_add_u32 s83, s83, s10
  s_mov_b32 s20, s83
  v_lshl_add_u32 v187, v37, 7, s13
  v_lshl_add_u32 v187, v36, 4, v187
  v_lshrrev_b32 v38, 4, v0
  v_mul_u32_u24 v188, 5120, v38
  v_and_b32 v38, 1, v36
  v_lshl_add_u32 v188, v38, 8, v188
  v_lshl_add_u32 v188, v37, 4, v188
  s_mul_i32 s84, s14, 205
  s_lshr_b32 s84, s84, 10
  s_mul_i32 s84, s84, 465
  s_mul_i32 s11, s15, 5
  s_add_u32 s84, s84, s11
  s_add_u32 s84, s84, s14
  s_lshl_b32 s84, s84, 10
  s_branch Ha_TJ
Ha_TW:
  s_mov_b32 s64, s40
  s_and_b32 s65, s41, 0xffff
  s_mov_b32 s66, 2211840
  s_mov_b32 s67, 0x20000
  s_mov_b32 s16, s40
  s_and_b32 s17, s41, 0xffff
  s_mov_b32 s18, 2211840
  s_mov_b32 s19, 0x20000
  s_mul_i32 s10, s14, 40960
  s_add_u32 s83, s83, s10
  s_add_u32 s20, s83, 20480
  v_lshrrev_b32 v38, 4, v0
  v_lshl_add_u32 v187, v38, 5, s13
  v_bfe_u32 v37, v0, 2, 2
  v_lshl_add_u32 v187, v37, 7, v187
  v_and_b32 v37, 3, v0
  v_lshl_add_u32 v187, v37, 3, v187
  v_add_u32 v38, s15, v38
  v_mul_u32_u24 v37, 205, v38
  v_lshrrev_b32 v37, 10, v37
  v_mul_u32_u24 v37, 465, v37
  v_add_lshl_u32 v37, v37, v38, 10
  v_and_b32 v38, 15, v0
  v_lshl_add_u32 v188, v38, 4, v37
  s_add_u32 s84, s14, 40
  s_mul_i32 s84, s84, 5120
Ha_TJ:
  s_add_u32 s84, s84, 12582912
  s_cmp_gt_u32 s21, 939
  s_cselect_b32 s84, 20971520, s84
  s_cselect_b32 s83, 20971520, s83
  s_cselect_b32 s20, 20971520, s20
  s_waitcnt vmcnt(8)
  s_barrier
  s_lshl_b32 s10, s76, 7
  s_mul_i32 s11, s76, 221184
  s_add_u32 s12, s10, s70
  s_add_u32 s10, s10, s71
  s_add_u32 s11, s11, s72
  s_add_u32 m0, s73, 56320
  s_add_u32 s13, s12, 15360
  buffer_load_dwordx4 v3, s[52:55], s13 offen lds
  s_add_u32 m0, s73, 57344
  s_add_u32 s13, s12, 20480
  buffer_load_dwordx4 v2, s[52:55], s13 offen lds
  s_add_u32 m0, s73, 58368
  s_add_u32 s13, s12, 25600
  buffer_load_dwordx4 v3, s[52:55], s13 offen lds
  s_add_u32 m0, s73, 59392
  s_add_u32 s13, s12, 30720
  buffer_load_dwordx4 v2, s[52:55], s13 offen lds
  s_add_u32 m0, s73, 60416
  s_add_u32 s13, s12, 35840
  buffer_load_dwordx4 v3, s[52:55], s13 offen lds
  s_add_u32 s76, s76, 1
  s_cmp_eq_u32 s76, 10
  s_cselect_b32 s76, 0, s76
  buffer_load_dwordx2 v[170:171], v161, s[52:55], 0 offen offset:0
  buffer_load_dwordx2 v[172:173], v161, s[52:55], 0 offen offset:256
  buffer_load_dwordx2 v[174:175], v161, s[52:55], 0 offen offset:512
  buffer_load_dwordx2 v[176:177], v161, s[52:55], 0 offen offset:768
  buffer_load_dwordx2 v[178:179], v161, s[52:55], 0 offen offset:1024
  s_lshl_b32 s10, s76, 7
  s_mul_i32 s11, s76, 221184
  s_add_u32 s12, s10, s70
  s_add_u32 s10, s10, s71
  s_add_u32 s11, s11, s72
  s_add_u32 m0, s74, 139264
  s_add_u32 s13, s10, 0
  buffer_load_dwordx4 v4, s[56:59], s13 offen lds
  s_add_u32 m0, s75, 143360
  s_add_u32 s13, s11, 0
  buffer_load_dwordx4 v5, s[60:63], s13 offen lds
  s_add_u32 m0, s75, 144384
  s_add_u32 s13, s11, 27648
  buffer_load_dwordx4 v5, s[60:63], s13 offen lds
  s_add_u32 m0, s75, 145408
  s_add_u32 s13, s11, 55296
  buffer_load_dwordx4 v5, s[60:63], s13 offen lds
  s_add_u32 m0, s75, 146432
  s_add_u32 s13, s11, 82944
  buffer_load_dwordx4 v5, s[60:63], s13 offen lds
  s_add_u32 m0, s73, 106496
  s_add_u32 s13, s12, 0
  buffer_load_dwordx4 v2, s[52:55], s13 offen lds
  s_add_u32 m0, s73, 107520
  s_add_u32 s13, s12, 5120
  buffer_load_dwordx4 v3, s[52:55], s13 offen lds
  s_add_u32 m0, s73, 108544
  s_add_u32 s13, s12, 10240
  buffer_load_dwordx4 v2, s[52:55], s13 offen lds
  s_add_u32 m0, s73, 109568
  s_add_u32 s13, s12, 15360
  buffer_load_dwordx4 v3, s[52:55], s13 offen lds
  s_add_u32 m0, s73, 110592
  s_add_u32 s13, s12, 20480
  buffer_load_dwordx4 v2, s[52:55], s13 offen lds
  s_add_u32 m0, s73, 111616
  s_add_u32 s13, s12, 25600
  buffer_load_dwordx4 v3, s[52:55], s13 offen lds
  s_add_u32 m0, s73, 112640
  s_add_u32 s13, s12, 30720
  buffer_load_dwordx4 v2, s[52:55], s13 offen lds
  s_add_u32 m0, s73, 113664
  s_add_u32 s13, s12, 35840
  buffer_load_dwordx4 v3, s[52:55], s13 offen lds
  s_add_u32 s76, s76, 1
  s_cmp_eq_u32 s76, 10
  s_cselect_b32 s76, 0, s76
  s_and_b32 s10, s3, 3
  s_cmp_eq_u32 s10, 0
  s_cbranch_scc0 Ha_CS0
  v_add_u32 v58, 0, v20
  v_add_u32 v59, 0, v21
  v_add_u32 v60, 0, v22
  v_add_u32 v61, 0, v23
  v_add_u32 v62, 0, v24
  ds_read_b128 v[64:67], v58
  ds_read_b64_tr_b16 v[80:81], v62 offset:0
  ds_read_b64_tr_b16 v[82:83], v62 offset:512
  ds_read_b128 v[68:71], v59
  ds_read_b64_tr_b16 v[84:85], v62 offset:2048
  ds_read_b64_tr_b16 v[86:87], v62 offset:2560
  ds_read_b128 v[72:75], v60
  ds_read_b64_tr_b16 v[88:89], v62 offset:4096
  ds_read_b64_tr_b16 v[90:91], v62 offset:4608
  ds_read_b128 v[76:79], v61
  ds_read_b64_tr_b16 v[92:93], v62 offset:6144
  ds_read_b64_tr_b16 v[94:95], v62 offset:6656
  s_add_u32 s10, s77, 0
  s_mul_i32 s10, s10, 1280
  s_add_u32 s10, s10, s80
  s_add_u32 s11, s10, s78
  s_add_u32 s10, s10, s79
  s_waitcnt lgkmcnt(0)
  v_mfma_f32_32x32x16_bf16 v[96:111], v[28:31], v[64:67], 0
  v_mfma_f32_32x32x16_bf16 v[112:127], v[28:31], v[80:83], 0
  v_mfma_f32_32x32x16_bf16 v[96:111], v[28:31], v[68:71], v[96:111]
  v_mfma_f32_32x32x16_bf16 v[112:127], v[28:31], v[84:87], v[112:127]
  v_mfma_f32_32x32x16_bf16 v[96:111], v[28:31], v[72:75], v[96:111]
  v_mfma_f32_32x32x16_bf16 v[112:127], v[28:31], v[88:91], v[112:127]
  v_mfma_f32_32x32x16_bf16 v[96:111], v[28:31], v[76:79], v[96:111]
  v_mfma_f32_32x32x16_bf16 v[112:127], v[28:31], v[92:95], v[112:127]
  s_nop 13
  v_mov_b32 v97, s6
  v_mov_b32 v113, s6
  s_mov_b32 exec_hi, 0
  buffer_store_dwordx2 v[96:97], v7, s[48:51], s10 offen sc1
  buffer_store_dwordx2 v[112:113], v7, s[48:51], s11 offen sc1
  s_mov_b32 exec_hi, -1
Ha_CS0:
  s_waitcnt vmcnt(18)
  s_barrier
  s_lshl_b32 s10, s76, 7
  s_mul_i32 s11, s76, 221184
  s_add_u32 s12, s10, s70
  s_add_u32 s10, s10, s71
  s_add_u32 s11, s11, s72
  s_add_u32 m0, s74, 32768
  s_add_u32 s13, s10, 0
  buffer_load_dwordx4 v4, s[56:59], s13 offen lds
  s_add_u32 m0, s75, 36864
  s_add_u32 s13, s11, 0
  buffer_load_dwordx4 v5, s[60:63], s13 offen lds
  s_add_u32 m0, s75, 37888
  s_add_u32 s13, s11, 27648
  buffer_load_dwordx4 v5, s[60:63], s13 offen lds
  s_add_u32 m0, s75, 38912
  s_add_u32 s13, s11, 55296
  buffer_load_dwordx4 v5, s[60:63], s13 offen lds
  s_add_u32 m0, s75, 39936
  s_add_u32 s13, s11, 82944
  buffer_load_dwordx4 v5, s[60:63], s13 offen lds
  s_add_u32 m0, s73, 0
  s_add_u32 s13, s12, 0
  buffer_load_dwordx4 v2, s[52:55], s13 offen lds
  s_add_u32 m0, s73, 1024
  s_add_u32 s13, s12, 5120
  buffer_load_dwordx4 v3, s[52:55], s13 offen lds
  s_add_u32 m0, s73, 2048
  s_add_u32 s13, s12, 10240
  buffer_load_dwordx4 v2, s[52:55], s13 offen lds
  s_add_u32 m0, s73, 3072
  s_add_u32 s13, s12, 15360
  buffer_load_dwordx4 v3, s[52:55], s13 offen lds
  s_add_u32 m0, s73, 4096
  s_add_u32 s13, s12, 20480
  buffer_load_dwordx4 v2, s[52:55], s13 offen lds
  s_add_u32 m0, s73, 5120
  s_add_u32 s13, s12, 25600
  buffer_load_dwordx4 v3, s[52:55], s13 offen lds
  s_add_u32 m0, s73, 6144
  s_add_u32 s13, s12, 30720
  buffer_load_dwordx4 v2, s[52:55], s13 offen lds
  s_add_u32 m0, s73, 7168
  s_add_u32 s13, s12, 35840
  buffer_load_dwordx4 v3, s[52:55], s13 offen lds
  s_add_u32 s76, s76, 1
  s_cmp_eq_u32 s76, 10
  s_cselect_b32 s76, 0, s76
  s_and_b32 s10, s3, 3
  s_cmp_eq_u32 s10, 1
  s_cbranch_scc0 Ha_CS1
  v_add_u32 v58, 53248, v20
  v_add_u32 v59, 53248, v21
  v_add_u32 v60, 53248, v22
  v_add_u32 v61, 53248, v23
  v_add_u32 v62, 53248, v24
  ds_read_b128 v[64:67], v58
  ds_read_b64_tr_b16 v[80:81], v62 offset:0
  ds_read_b64_tr_b16 v[82:83], v62 offset:512
  ds_read_b128 v[68:71], v59
  ds_read_b64_tr_b16 v[84:85], v62 offset:2048
  ds_read_b64_tr_b16 v[86:87], v62 offset:2560
  ds_read_b128 v[72:75], v60
  ds_read_b64_tr_b16 v[88:89], v62 offset:4096
  ds_read_b64_tr_b16 v[90:91], v62 offset:4608
  ds_read_b128 v[76:79], v61
  ds_read_b64_tr_b16 v[92:93], v62 offset:6144
  ds_read_b64_tr_b16 v[94:95], v62 offset:6656
  s_add_u32 s10, s77, 1
  s_mul_i32 s10, s10, 1280
  s_add_u32 s10, s10, s80
  s_add_u32 s11, s10, s78
  s_add_u32 s10, s10, s79
  s_waitcnt lgkmcnt(0)
  v_mfma_f32_32x32x16_bf16 v[96:111], v[28:31], v[64:67], 0
  v_mfma_f32_32x32x16_bf16 v[112:127], v[28:31], v[80:83], 0
  v_mfma_f32_32x32x16_bf16 v[96:111], v[28:31], v[68:71], v[96:111]
  v_mfma_f32_32x32x16_bf16 v[112:127], v[28:31], v[84:87], v[112:127]
  v_mfma_f32_32x32x16_bf16 v[96:111], v[28:31], v[72:75], v[96:111]
  v_mfma_f32_32x32x16_bf16 v[112:127], v[28:31], v[88:91], v[112:127]
  v_mfma_f32_32x32x16_bf16 v[96:111], v[28:31], v[76:79], v[96:111]
  v_mfma_f32_32x32x16_bf16 v[112:127], v[28:31], v[92:95], v[112:127]
  s_nop 13
  v_mov_b32 v97, s6
  v_mov_b32 v113, s6
  s_mov_b32 exec_hi, 0
  buffer_store_dwordx2 v[96:97], v7, s[48:51], s10 offen sc1
  buffer_store_dwordx2 v[112:113], v7, s[48:51], s11 offen sc1
  s_mov_b32 exec_hi, -1
Ha_CS1:
  s_waitcnt vmcnt(26)
  v_lshlrev_b32 v210, 16, v170
  v_and_b32 v211, 0xffff0000, v170
  v_lshlrev_b32 v212, 16, v171
  v_and_b32 v213, 0xffff0000, v171
  v_lshlrev_b32 v214, 16, v172
  v_and_b32 v215, 0xffff0000, v172
  v_lshlrev_b32 v216, 16, v173
  v_and_b32 v217, 0xffff0000, v173
  v_lshlrev_b32 v218, 16, v174
  v_and_b32 v219, 0xffff0000, v174
  v_lshlrev_b32 v220, 16, v175
  v_and_b32 v221, 0xffff0000, v175
  v_lshlrev_b32 v222, 16, v176
  v_and_b32 v223, 0xffff0000, v176
  v_lshlrev_b32 v224, 16, v177
  v_and_b32 v225, 0xffff0000, v177
  v_lshlrev_b32 v226, 16, v178
  v_and_b32 v227, 0xffff0000, v178
  v_lshlrev_b32 v228, 16, v179
  v_and_b32 v229, 0xffff0000, v179
  v_add_f32 v162, v210, v211
  v_add_f32 v162, v162, v212
  v_add_f32 v162, v162, v213
  v_add_f32 v162, v162, v214
  v_add_f32 v162, v162, v215
  v_add_f32 v162, v162, v216
  v_add_f32 v162, v162, v217
  v_add_f32 v162, v162, v218
  v_add_f32 v162, v162, v219
  v_add_f32 v162, v162, v220
  v_add_f32 v162, v162, v221
  v_add_f32 v162, v162, v222
  v_add_f32 v162, v162, v223
  v_add_f32 v162, v162, v224
  v_add_f32 v162, v162, v225
  v_add_f32 v162, v162, v226
  v_add_f32 v162, v162, v227
  v_add_f32 v162, v162, v228
  v_add_f32 v162, v162, v229
  s_nop 1
  v_add_f32_dpp v162, v162, v162 row_ror:8 row_mask:0xf bank_mask:0xf
  s_nop 1
  v_add_f32_dpp v162, v162, v162 row_ror:4 row_mask:0xf bank_mask:0xf
  s_nop 1
  v_add_f32_dpp v162, v162, v162 row_ror:2 row_mask:0xf bank_mask:0xf
  s_nop 1
  v_add_f32_dpp v162, v162, v162 row_ror:1 row_mask:0xf bank_mask:0xf
  v_mov_b32 v163, v162
  s_nop 1
  v_permlane16_swap_b32 v162, v163
  s_nop 1
  v_add_f32 v162, v162, v163
  v_mul_f32 v162, 0x3acccccd, v162
  v_mov_b32 v164, 0
  v_sub_f32 v210, v210, v162
  v_fmac_f32 v164, v210, v210
  v_sub_f32 v211, v211, v162
  v_fmac_f32 v164, v211, v211
  v_sub_f32 v212, v212, v162
  v_fmac_f32 v164, v212, v212
  v_sub_f32 v213, v213, v162
  v_fmac_f32 v164, v213, v213
  v_sub_f32 v214, v214, v162
  v_fmac_f32 v164, v214, v214
  v_sub_f32 v215, v215, v162
  v_fmac_f32 v164, v215, v215
  v_sub_f32 v216, v216, v162
  v_fmac_f32 v164, v216, v216
  v_sub_f32 v217, v217, v162
  v_fmac_f32 v164, v217, v217
  v_sub_f32 v218, v218, v162
  v_fmac_f32 v164, v218, v218
  v_sub_f32 v219, v219, v162
  v_fmac_f32 v164, v219, v219
  v_sub_f32 v220, v220, v162
  v_fmac_f32 v164, v220, v220
  v_sub_f32 v221, v221, v162
  v_fmac_f32 v164, v221, v221
  v_sub_f32 v222, v222, v162
  v_fmac_f32 v164, v222, v222
  v_sub_f32 v223, v223, v162
  v_fmac_f32 v164, v223, v223
  v_sub_f32 v224, v224, v162
  v_fmac_f32 v164, v224, v224
  v_sub_f32 v225, v225, v162
  v_fmac_f32 v164, v225, v225
  v_sub_f32 v226, v226, v162
  v_fmac_f32 v164, v226, v226
  v_sub_f32 v227, v227, v162
  v_fmac_f32 v164, v227, v227
  v_sub_f32 v228, v228, v162
  v_fmac_f32 v164, v228, v228
  v_sub_f32 v229, v229, v162
  v_fmac_f32 v164, v229, v229
  s_nop 1
  v_add_f32_dpp v164, v164, v164 row_ror:8 row_mask:0xf bank_mask:0xf
  s_nop 1
  v_add_f32_dpp v164, v164, v164 row_ror:4 row_mask:0xf bank_mask:0xf
  s_nop 1
  v_add_f32_dpp v164, v164, v164 row_ror:2 row_mask:0xf bank_mask:0xf
  s_nop 1
  v_add_f32_dpp v164, v164, v164 row_ror:1 row_mask:0xf bank_mask:0xf
  v_mov_b32 v163, v164
  s_nop 1
  v_permlane16_swap_b32 v164, v163
  s_nop 1
  v_add_f32 v164, v164, v163
  v_mul_f32 v164, 0x3acccccd, v164
  v_cvt_pk_bf16_f32 v164, v164, v164
  v_lshlrev_b32 v164, 16, v164
  v_add_f32 v164, 0x3727c5ac, v164
  v_cvt_pk_bf16_f32 v164, v164, v164
  v_lshlrev_b32 v164, 16, v164
  v_sqrt_f32 v164, v164
  v_mov_b32 v163, s6
  v_cvt_pk_bf16_f32 v162, v162, v164
  s_mov_b32 s10, 16777216
  s_mov_b32 exec_lo, 1
  s_mov_b32 exec_hi, 1
  buffer_store_dwordx2 v[162:163], v160, s[48:51], s10 offen sc1
  s_mov_b64 exec, -1
  s_waitcnt vmcnt(14)
  s_barrier
  s_add_u32 s13, s83, 0
  buffer_load_dwordx4 v[192:195], v185, s[64:67], s13 offen
  s_add_u32 s13, s83, 10240
  buffer_load_dwordx4 v[196:199], v185, s[64:67], s13 offen
  s_add_u32 s13, s20, 0
  buffer_load_dwordx4 v[200:203], v185, s[16:19], s13 offen
  s_add_u32 s13, s20, 10240
  buffer_load_dwordx4 v[204:207], v185, s[16:19], s13 offen
  s_lshl_b32 s10, s76, 7
  s_mul_i32 s11, s76, 221184
  s_add_u32 s12, s10, s70
  s_add_u32 s10, s10, s71
  s_add_u32 s11, s11, s72
  s_add_u32 m0, s74, 86016
  s_add_u32 s13, s10, 0
  buffer_load_dwordx4 v4, s[56:59], s13 offen lds
  s_add_u32 m0, s75, 90112
  s_add_u32 s13, s11, 0
  buffer_load_dwordx4 v5, s[60:63], s13 offen lds
  s_add_u32 m0, s75, 91136
  s_add_u32 s13, s11, 27648
  buffer_load_dwordx4 v5, s[60:63], s13 offen lds
  s_add_u32 m0, s75, 92160
  s_add_u32 s13, s11, 55296
  buffer_load_dwordx4 v5, s[60:63], s13 offen lds
  s_add_u32 m0, s75, 93184
  s_add_u32 s13, s11, 82944
  buffer_load_dwordx4 v5, s[60:63], s13 offen lds
  s_add_u32 m0, s73, 53248
  s_add_u32 s13, s12, 0
  buffer_load_dwordx4 v2, s[52:55], s13 offen lds
  s_add_u32 m0, s73, 54272
  s_add_u32 s13, s12, 5120
  buffer_load_dwordx4 v3, s[52:55], s13 offen lds
  s_add_u32 m0, s73, 55296
  s_add_u32 s13, s12, 10240
  buffer_load_dwordx4 v2, s[52:55], s13 offen lds
  s_add_u32 m0, s73, 56320
  s_add_u32 s13, s12, 15360
  buffer_load_dwordx4 v3, s[52:55], s13 offen lds
  s_add_u32 m0, s73, 57344
  s_add_u32 s13, s12, 20480
  buffer_load_dwordx4 v2, s[52:55], s13 offen lds
  s_add_u32 m0, s73, 58368
  s_add_u32 s13, s12, 25600
  buffer_load_dwordx4 v3, s[52:55], s13 offen lds
  s_add_u32 m0, s73, 59392
  s_add_u32 s13, s12, 30720
  buffer_load_dwordx4 v2, s[52:55], s13 offen lds
  s_add_u32 m0, s73, 60416
  s_add_u32 s13, s12, 35840
  buffer_load_dwordx4 v3, s[52:55], s13 offen lds
  s_add_u32 s76, s76, 1
  s_cmp_eq_u32 s76, 10
  s_cselect_b32 s76, 0, s76
  s_and_b32 s10, s3, 3
  s_cmp_eq_u32 s10, 2
  s_cbranch_scc0 Ha_CS2
  v_add_u32 v58, 106496, v20
  v_add_u32 v59, 106496, v21
  v_add_u32 v60, 106496, v22
  v_add_u32 v61, 106496, v23
  v_add_u32 v62, 106496, v24
  ds_read_b128 v[64:67], v58
  ds_read_b64_tr_b16 v[80:81], v62 offset:0
  ds_read_b64_tr_b16 v[82:83], v62 offset:512
  ds_read_b128 v[68:71], v59
  ds_read_b64_tr_b16 v[84:85], v62 offset:2048
  ds_read_b64_tr_b16 v[86:87], v62 offset:2560
  ds_read_b128 v[72:75], v60
  ds_read_b64_tr_b16 v[88:89], v62 offset:4096
  ds_read_b64_tr_b16 v[90:91], v62 offset:4608
  ds_read_b128 v[76:79], v61
  ds_read_b64_tr_b16 v[92:93], v62 offset:6144
  ds_read_b64_tr_b16 v[94:95], v62 offset:6656
  s_add_u32 s10, s77, 2
  s_mul_i32 s10, s10, 1280
  s_add_u32 s10, s10, s80
  s_add_u32 s11, s10, s78
  s_add_u32 s10, s10, s79
  s_waitcnt lgkmcnt(0)
  v_mfma_f32_32x32x16_bf16 v[96:111], v[28:31], v[64:67], 0
  v_mfma_f32_32x32x16_bf16 v[112:127], v[28:31], v[80:83], 0
  v_mfma_f32_32x32x16_bf16 v[96:111], v[28:31], v[68:71], v[96:111]
  v_mfma_f32_32x32x16_bf16 v[112:127], v[28:31], v[84:87], v[112:127]
  v_mfma_f32_32x32x16_bf16 v[96:111], v[28:31], v[72:75], v[96:111]
  v_mfma_f32_32x32x16_bf16 v[112:127], v[28:31], v[88:91], v[112:127]
  v_mfma_f32_32x32x16_bf16 v[96:111], v[28:31], v[76:79], v[96:111]
  v_mfma_f32_32x32x16_bf16 v[112:127], v[28:31], v[92:95], v[112:127]
  s_nop 13
  v_mov_b32 v97, s6
  v_mov_b32 v113, s6
  s_mov_b32 exec_hi, 0
  buffer_store_dwordx2 v[96:97], v7, s[48:51], s10 offen sc1
  buffer_store_dwordx2 v[112:113], v7, s[48:51], s11 offen sc1
  s_mov_b32 exec_hi, -1
Ha_CS2:
  s_waitcnt vmcnt(18)
  s_barrier
  s_lshl_b32 s10, s76, 7
  s_mul_i32 s11, s76, 221184
  s_add_u32 s12, s10, s70
  s_add_u32 s10, s10, s71
  s_add_u32 s11, s11, s72
  s_add_u32 m0, s74, 139264
  s_add_u32 s13, s10, 0
  buffer_load_dwordx4 v4, s[56:59], s13 offen lds
  s_add_u32 m0, s75, 143360
  s_add_u32 s13, s11, 0
  buffer_load_dwordx4 v5, s[60:63], s13 offen lds
  s_add_u32 m0, s75, 144384
  s_add_u32 s13, s11, 27648
  buffer_load_dwordx4 v5, s[60:63], s13 offen lds
  s_add_u32 m0, s75, 145408
  s_add_u32 s13, s11, 55296
  buffer_load_dwordx4 v5, s[60:63], s13 offen lds
  s_add_u32 m0, s75, 146432
  s_add_u32 s13, s11, 82944
  buffer_load_dwordx4 v5, s[60:63], s13 offen lds
  s_add_u32 m0, s73, 106496
  s_add_u32 s13, s12, 0
  buffer_load_dwordx4 v2, s[52:55], s13 offen lds
  s_add_u32 m0, s73, 107520
  s_add_u32 s13, s12, 5120
  buffer_load_dwordx4 v3, s[52:55], s13 offen lds
  s_add_u32 m0, s73, 108544
  s_add_u32 s13, s12, 10240
  buffer_load_dwordx4 v2, s[52:55], s13 offen lds
  s_add_u32 m0, s73, 109568
  s_add_u32 s13, s12, 15360
  buffer_load_dwordx4 v3, s[52:55], s13 offen lds
  s_add_u32 m0, s73, 110592
  s_add_u32 s13, s12, 20480
  buffer_load_dwordx4 v2, s[52:55], s13 offen lds
  s_add_u32 m0, s73, 111616
  s_add_u32 s13, s12, 25600
  buffer_load_dwordx4 v3, s[52:55], s13 offen lds
  s_add_u32 m0, s73, 112640
  s_add_u32 s13, s12, 30720
  buffer_load_dwordx4 v2, s[52:55], s13 offen lds
  s_add_u32 m0, s73, 113664
  s_add_u32 s13, s12, 35840
  buffer_load_dwordx4 v3, s[52:55], s13 offen lds
  s_add_u32 s76, s76, 1
  s_cmp_eq_u32 s76, 10
  s_cselect_b32 s76, 0, s76
  s_and_b32 s10, s3, 3
  s_cmp_eq_u32 s10, 3
  s_cbranch_scc0 Ha_CS3
  v_add_u32 v58, 0, v20
  v_add_u32 v59, 0, v21
  v_add_u32 v60, 0, v22
  v_add_u32 v61, 0, v23
  v_add_u32 v62, 0, v24
  ds_read_b128 v[64:67], v58
  ds_read_b64_tr_b16 v[80:81], v62 offset:0
  ds_read_b64_tr_b16 v[82:83], v62 offset:512
  ds_read_b128 v[68:71], v59
  ds_read_b64_tr_b16 v[84:85], v62 offset:2048
  ds_read_b64_tr_b16 v[86:87], v62 offset:2560
  ds_read_b128 v[72:75], v60
  ds_read_b64_tr_b16 v[88:89], v62 offset:4096
  ds_read_b64_tr_b16 v[90:91], v62 offset:4608
  ds_read_b128 v[76:79], v61
  ds_read_b64_tr_b16 v[92:93], v62 offset:6144
  ds_read_b64_tr_b16 v[94:95], v62 offset:6656
  s_add_u32 s10, s77, 3
  s_mul_i32 s10, s10, 1280
  s_add_u32 s10, s10, s80
  s_add_u32 s11, s10, s78
  s_add_u32 s10, s10, s79
  s_waitcnt lgkmcnt(0)
  v_mfma_f32_32x32x16_bf16 v[96:111], v[28:31], v[64:67], 0
  v_mfma_f32_32x32x16_bf16 v[112:127], v[28:31], v[80:83], 0
  v_mfma_f32_32x32x16_bf16 v[96:111], v[28:31], v[68:71], v[96:111]
  v_mfma_f32_32x32x16_bf16 v[112:127], v[28:31], v[84:87], v[112:127]
  v_mfma_f32_32x32x16_bf16 v[96:111], v[28:31], v[72:75], v[96:111]
  v_mfma_f32_32x32x16_bf16 v[112:127], v[28:31], v[88:91], v[112:127]
  v_mfma_f32_32x32x16_bf16 v[96:111], v[28:31], v[76:79], v[96:111]
  v_mfma_f32_32x32x16_bf16 v[112:127], v[28:31], v[92:95], v[112:127]
  s_nop 13
  v_mov_b32 v97, s6
  v_mov_b32 v113, s6
  s_mov_b32 exec_hi, 0
  buffer_store_dwordx2 v[96:97], v7, s[48:51], s10 offen sc1
  buffer_store_dwordx2 v[112:113], v7, s[48:51], s11 offen sc1
  s_mov_b32 exec_hi, -1
Ha_CS3:
  s_waitcnt vmcnt(26)
  s_cmp_lt_u32 s82, 400
  s_cbranch_scc0 Ha_T0W
  ds_write_b128 v186, v[192:195]
  ds_read_b128 v[192:195], v187
  ds_write_b128 v186, v[196:199]
  ds_read_b128 v[196:199], v187
  ds_write_b128 v186, v[200:203]
  ds_read_b128 v[200:203], v187
  ds_write_b128 v186, v[204:207]
  ds_read_b128 v[204:207], v187
  s_waitcnt lgkmcnt(0)
  buffer_store_dwordx4 v[192:195], v188, s[48:51], s84 offen offset:0 sc1
  buffer_store_dwordx4 v[196:199], v188, s[48:51], s84 offen offset:128 sc1
  buffer_store_dwordx4 v[200:203], v188, s[48:51], s84 offen offset:512 sc1
  buffer_store_dwordx4 v[204:207], v188, s[48:51], s84 offen offset:640 sc1
  s_branch Ha_T0E
Ha_T0W:
  ds_write_b128 v186, v[192:195]
  ds_read_b64_tr_b16 v[192:193], v187
  ds_read_b64_tr_b16 v[194:195], v187 offset:512
  ds_write_b128 v186, v[196:199]
  ds_read_b64_tr_b16 v[196:197], v187
  ds_read_b64_tr_b16 v[198:199], v187 offset:512
  ds_write_b128 v186, v[200:203]
  ds_read_b64_tr_b16 v[200:201], v187
  ds_read_b64_tr_b16 v[202:203], v187 offset:512
  ds_write_b128 v186, v[204:207]
  ds_read_b64_tr_b16 v[204:205], v187
  ds_read_b64_tr_b16 v[206:207], v187 offset:512
  s_waitcnt lgkmcnt(0)
  buffer_store_dwordx4 v[192:195], v188, s[48:51], s84 offen offset:0 sc1
  buffer_store_dwordx4 v[196:199], v188, s[48:51], s84 offen offset:256 sc1
  buffer_store_dwordx4 v[200:203], v188, s[48:51], s84 offen offset:512 sc1
  buffer_store_dwordx4 v[204:207], v188, s[48:51], s84 offen offset:768 sc1
Ha_T0E:
  s_waitcnt vmcnt(17)
  s_barrier
  s_lshl_b32 s10, s76, 7
  s_mul_i32 s11, s76, 221184
  s_add_u32 s12, s10, s70
  s_add_u32 s10, s10, s71
  s_add_u32 s11, s11, s72
  s_add_u32 m0, s74, 32768
  s_add_u32 s13, s10, 0
  buffer_load_dwordx4 v4, s[56:59], s13 offen lds
  s_add_u32 m0, s75, 36864
  s_add_u32 s13, s11, 0
  buffer_load_dwordx4 v5, s[60:63], s13 offen lds
  s_add_u32 m0, s75, 37888
  s_add_u32 s13, s11, 27648
  buffer_load_dwordx4 v5, s[60:63], s13 offen lds
  s_add_u32 m0, s75, 38912
  s_add_u32 s13, s11, 55296
  buffer_load_dwordx4 v5, s[60:63], s13 offen lds
  s_add_u32 m0, s75, 39936
  s_add_u32 s13, s11, 82944
  buffer_load_dwordx4 v5, s[60:63], s13 offen lds
  s_add_u32 m0, s73, 0
  s_add_u32 s13, s12, 0
  buffer_load_dwordx4 v2, s[52:55], s13 offen lds
  s_add_u32 m0, s73, 1024
  s_add_u32 s13, s12, 5120
  buffer_load_dwordx4 v3, s[52:55], s13 offen lds
  s_add_u32 m0, s73, 2048
  s_add_u32 s13, s12, 10240
  buffer_load_dwordx4 v2, s[52:55], s13 offen lds
  s_add_u32 m0, s73, 3072
  s_add_u32 s13, s12, 15360
  buffer_load_dwordx4 v3, s[52:55], s13 offen lds
  s_add_u32 m0, s73, 4096
  s_add_u32 s13, s12, 20480
  buffer_load_dwordx4 v2, s[52:55], s13 offen lds
  s_add_u32 m0, s73, 5120
  s_add_u32 s13, s12, 25600
  buffer_load_dwordx4 v3, s[52:55], s13 offen lds
  s_add_u32 m0, s73, 6144
  s_add_u32 s13, s12, 30720
  buffer_load_dwordx4 v2, s[52:55], s13 offen lds
  s_add_u32 m0, s73, 7168
  s_add_u32 s13, s12, 35840
  buffer_load_dwordx4 v3, s[52:55], s13 offen lds
  s_add_u32 s76, s76, 1
  s_cmp_eq_u32 s76, 10
  s_cselect_b32 s76, 0, s76
  s_and_b32 s10, s3, 3
  s_cmp_eq_u32 s10, 0
  s_cbranch_scc0 Ha_CS4
  v_add_u32 v58, 53248, v20
  v_add_u32 v59, 53248, v21
  v_add_u32 v60, 53248, v22
  v_add_u32 v61, 53248, v23
  v_add_u32 v62, 53248, v24
  ds_read_b128 v[64:67], v58
  ds_read_b64_tr_b16 v[80:81], v62 offset:0
  ds_read_b64_tr_b16 v[82:83], v62 offset:512
  ds_read_b128 v[68:71], v59
  ds_read_b64_tr_b16 v[84:85], v62 offset:2048
  ds_read_b64_tr_b16 v[86:87], v62 offset:2560
  ds_read_b128 v[72:75], v60
  ds_read_b64_tr_b16 v[88:89], v62 offset:4096
  ds_read_b64_tr_b16 v[90:91], v62 offset:4608
  ds_read_b128 v[76:79], v61
  ds_read_b64_tr_b16 v[92:93], v62 offset:6144
  ds_read_b64_tr_b16 v[94:95], v62 offset:6656
  s_add_u32 s10, s77, 4
  s_mul_i32 s10, s10, 1280
  s_add_u32 s10, s10, s80
  s_add_u32 s11, s10, s78
  s_add_u32 s10, s10, s79
  s_waitcnt lgkmcnt(0)
  v_mfma_f32_32x32x16_bf16 v[96:111], v[28:31], v[64:67], 0
  v_mfma_f32_32x32x16_bf16 v[112:127], v[28:31], v[80:83], 0
  v_mfma_f32_32x32x16_bf16 v[96:111], v[28:31], v[68:71], v[96:111]
  v_mfma_f32_32x32x16_bf16 v[112:127], v[28:31], v[84:87], v[112:127]
  v_mfma_f32_32x32x16_bf16 v[96:111], v[28:31], v[72:75], v[96:111]
  v_mfma_f32_32x32x16_bf16 v[112:127], v[28:31], v[88:91], v[112:127]
  v_mfma_f32_32x32x16_bf16 v[96:111], v[28:31], v[76:79], v[96:111]
  v_mfma_f32_32x32x16_bf16 v[112:127], v[28:31], v[92:95], v[112:127]
  s_nop 13
  v_mov_b32 v97, s6
  v_mov_b32 v113, s6
  s_mov_b32 exec_hi, 0
  buffer_store_dwordx2 v[96:97], v7, s[48:51], s10 offen sc1
  buffer_store_dwordx2 v[112:113], v7, s[48:51], s11 offen sc1
  s_mov_b32 exec_hi, -1
Ha_CS4:
  s_waitcnt vmcnt(13)
  s_barrier
  s_cmp_eq_u32 s7, 0
  s_cbranch_scc0 Ha_NF
  s_lshl_b32 s10, s2, 2
  s_add_u32 s10, s10, s94
  v_mov_b32 v1, s6
  s_mov_b64 exec, 1
  buffer_store_dword v1, off, s[48:51], s10 sc1
  s_mov_b64 exec, -1
Ha_NF:
  s_lshl_b32 s10, s76, 7
  s_mul_i32 s11, s76, 221184
  s_add_u32 s12, s10, s70
  s_add_u32 s10, s10, s71
  s_add_u32 s11, s11, s72
  s_add_u32 m0, s74, 86016
  s_add_u32 s13, s10, 0
  buffer_load_dwordx4 v4, s[56:59], s13 offen lds
  s_add_u32 m0, s75, 90112
  s_add_u32 s13, s11, 0
  buffer_load_dwordx4 v5, s[60:63], s13 offen lds
  s_add_u32 m0, s75, 91136
  s_add_u32 s13, s11, 27648
  buffer_load_dwordx4 v5, s[60:63], s13 offen lds
  s_add_u32 m0, s75, 92160
  s_add_u32 s13, s11, 55296
  buffer_load_dwordx4 v5, s[60:63], s13 offen lds
  s_add_u32 m0, s75, 93184
  s_add_u32 s13, s11, 82944
  buffer_load_dwordx4 v5, s[60:63], s13 offen lds
  s_add_u32 m0, s73, 53248
  s_add_u32 s13, s12, 0
  buffer_load_dwordx4 v2, s[52:55], s13 offen lds
  s_add_u32 m0, s73, 54272
  s_add_u32 s13, s12, 5120
  buffer_load_dwordx4 v3, s[52:55], s13 offen lds
  s_add_u32 m0, s73, 55296
  s_add_u32 s13, s12, 10240
  buffer_load_dwordx4 v2, s[52:55], s13 offen lds
  s_add_u32 m0, s73, 56320
  s_add_u32 s13, s12, 15360
  buffer_load_dwordx4 v3, s[52:55], s13 offen lds
  s_add_u32 m0, s73, 57344
  s_add_u32 s13, s12, 20480
  buffer_load_dwordx4 v2, s[52:55], s13 offen lds
  s_add_u32 m0, s73, 58368
  s_add_u32 s13, s12, 25600
  buffer_load_dwordx4 v3, s[52:55], s13 offen lds
  s_add_u32 m0, s73, 59392
  s_add_u32 s13, s12, 30720
  buffer_load_dwordx4 v2, s[52:55], s13 offen lds
  s_add_u32 m0, s73, 60416
  s_add_u32 s13, s12, 35840
  buffer_load_dwordx4 v3, s[52:55], s13 offen lds
  s_add_u32 s76, s76, 1
  s_cmp_eq_u32 s76, 10
  s_cselect_b32 s76, 0, s76
  s_waitcnt vmcnt(13)
  s_barrier
  s_lshl_b32 s10, s76, 7
  s_mul_i32 s11, s76, 221184
  s_add_u32 s12, s10, s70
  s_add_u32 s10, s10, s71
  s_add_u32 s11, s11, s72
  s_add_u32 m0, s74, 139264
  s_add_u32 s13, s10, 0
  buffer_load_dwordx4 v4, s[56:59], s13 offen lds
  s_add_u32 m0, s75, 143360
  s_add_u32 s13, s11, 0
  buffer_load_dwordx4 v5, s[60:63], s13 offen lds
  s_add_u32 m0, s75, 144384
  s_add_u32 s13, s11, 27648
  buffer_load_dwordx4 v5, s[60:63], s13 offen lds
  s_add_u32 m0, s75, 145408
  s_add_u32 s13, s11, 55296
  buffer_load_dwordx4 v5, s[60:63], s13 offen lds
  s_add_u32 m0, s75, 146432
  s_add_u32 s13, s11, 82944
  buffer_load_dwordx4 v5, s[60:63], s13 offen lds
  s_add_u32 m0, s73, 106496
  s_add_u32 s13, s12, 0
  buffer_load_dwordx4 v2, s[52:55], s13 offen lds
  s_add_u32 m0, s73, 107520
  s_add_u32 s13, s12, 5120
  buffer_load_dwordx4 v3, s[52:55], s13 offen lds
  s_add_u32 m0, s73, 108544
  s_add_u32 s13, s12, 10240
  buffer_load_dwordx4 v2, s[52:55], s13 offen lds
  s_add_u32 m0, s73, 109568
  s_add_u32 s13, s12, 15360
  buffer_load_dwordx4 v3, s[52:55], s13 offen lds
  s_add_u32 m0, s73, 110592
  s_add_u32 s13, s12, 20480
  buffer_load_dwordx4 v2, s[52:55], s13 offen lds
  s_add_u32 m0, s73, 111616
  s_add_u32 s13, s12, 25600
  buffer_load_dwordx4 v3, s[52:55], s13 offen lds
  s_add_u32 m0, s73, 112640
  s_add_u32 s13, s12, 30720
  buffer_load_dwordx4 v2, s[52:55], s13 offen lds
  s_add_u32 m0, s73, 113664
  s_add_u32 s13, s12, 35840
  buffer_load_dwordx4 v3, s[52:55], s13 offen lds
  s_add_u32 s76, s76, 1
  s_cmp_eq_u32 s76, 10
  s_cselect_b32 s76, 0, s76
  s_add_u32 s10, s80, 0
  buffer_load_dwordx2 v[42:43], v33, s[48:51], s10 offen sc1
  s_add_u32 s10, s80, 1280
  buffer_load_dwordx2 v[44:45], v33, s[48:51], s10 offen sc1
  s_add_u32 s10, s80, 2560
  buffer_load_dwordx2 v[46:47], v33, s[48:51], s10 offen sc1
  s_add_u32 s10, s80, 3840
  buffer_load_dwordx2 v[48:49], v33, s[48:51], s10 offen sc1
  s_add_u32 s10, s80, 5120
  buffer_load_dwordx2 v[50:51], v33, s[48:51], s10 offen sc1
  s_add_u32 s10, s80, 6400
  buffer_load_dwordx2 v[52:53], v33, s[48:51], s10 offen sc1
  s_add_u32 s10, s80, 7680
  buffer_load_dwordx2 v[54:55], v33, s[48:51], s10 offen sc1
  s_add_u32 s10, s80, 8960
  buffer_load_dwordx2 v[56:57], v33, s[48:51], s10 offen sc1
  s_add_u32 s10, s80, 10240
  buffer_load_dwordx2 v[58:59], v33, s[48:51], s10 offen sc1
  s_add_u32 s10, s80, 11520
  buffer_load_dwordx2 v[60:61], v33, s[48:51], s10 offen sc1
  buffer_load_dwordx2 v[40:41], v34, s[48:51], s81 offen sc1
  s_waitcnt vmcnt(24)
  s_barrier
  buffer_load_dwordx4 v[148:151], v27, s[48:51], s94 offen sc1
  s_lshl_b32 s10, s76, 7
  s_mul_i32 s11, s76, 221184
  s_add_u32 s12, s10, s70
  s_add_u32 s10, s10, s71
  s_add_u32 s11, s11, s72
  s_add_u32 m0, s74, 32768
  s_add_u32 s13, s10, 0
  buffer_load_dwordx4 v4, s[56:59], s13 offen lds
  s_add_u32 m0, s75, 36864
  s_add_u32 s13, s11, 0
  buffer_load_dwordx4 v5, s[60:63], s13 offen lds
  s_add_u32 m0, s75, 37888
  s_add_u32 s13, s11, 27648
  buffer_load_dwordx4 v5, s[60:63], s13 offen lds
  s_add_u32 m0, s75, 38912
  s_add_u32 s13, s11, 55296
  buffer_load_dwordx4 v5, s[60:63], s13 offen lds
  s_add_u32 m0, s75, 39936
  s_add_u32 s13, s11, 82944
  buffer_load_dwordx4 v5, s[60:63], s13 offen lds
  s_add_u32 m0, s73, 0
  s_add_u32 s13, s12, 0
  buffer_load_dwordx4 v2, s[52:55], s13 offen lds
  s_add_u32 m0, s73, 1024
  s_add_u32 s13, s12, 5120
  buffer_load_dwordx4 v3, s[52:55], s13 offen lds
  s_add_u32 m0, s73, 2048
  s_add_u32 s13, s12, 10240
  buffer_load_dwordx4 v2, s[52:55], s13 offen lds
  s_add_u32 m0, s73, 3072
  s_add_u32 s13, s12, 15360
  buffer_load_dwordx4 v3, s[52:55], s13 offen lds
  s_add_u32 m0, s73, 4096
  s_add_u32 s13, s12, 20480
  buffer_load_dwordx4 v2, s[52:55], s13 offen lds
  s_add_u32 m0, s73, 5120
  s_add_u32 s13, s12, 25600
  buffer_load_dwordx4 v3, s[52:55], s13 offen lds
  s_add_u32 m0, s73, 6144
  s_add_u32 s13, s12, 30720
  buffer_load_dwordx4 v2, s[52:55], s13 offen lds
  s_add_u32 m0, s73, 7168
  s_add_u32 s13, s12, 35840
  buffer_load_dwordx4 v3, s[52:55], s13 offen lds
  s_add_u32 s76, s76, 1
  s_cmp_eq_u32 s76, 10
  s_cselect_b32 s76, 0, s76
  s_waitcnt vmcnt(13)
  s_barrier
  s_mov_b32 s85, 0
Ha_CHK:
  v_xor_b32 v1, s6, v41
  v_xor_b32 v36, s6, v43
  v_or_b32 v1, v1, v36
  v_xor_b32 v36, s6, v45
  v_or_b32 v1, v1, v36
  v_xor_b32 v36, s6, v47
  v_or_b32 v1, v1, v36
  v_xor_b32 v36, s6, v49
  v_or_b32 v1, v1, v36
  v_xor_b32 v36, s6, v51
  v_or_b32 v1, v1, v36
  v_xor_b32 v36, s6, v53
  v_or_b32 v1, v1, v36
  v_xor_b32 v36, s6, v55
  v_or_b32 v1, v1, v36
  v_xor_b32 v36, s6, v57
  v_or_b32 v1, v1, v36
  v_xor_b32 v36, s6, v59
  v_or_b32 v1, v1, v36
  v_xor_b32 v36, s6, v61
  v_or_b32 v1, v1, v36
  v_cmp_ne_u32 vcc, 0, v1
  s_add_u32 s85, s85, 1
  s_cmp_lt_u32 s85, 20000
  s_cselect_b64 s[12:13], -1, 0
  s_nop 1
  s_and_b64 vcc, vcc, s[12:13]
  s_cbranch_scc0 Ha_OK
  s_sleep 8
  s_add_u32 s10, s80, 0
  buffer_load_dwordx2 v[42:43], v33, s[48:51], s10 offen sc1
  s_add_u32 s10, s80, 1280
  buffer_load_dwordx2 v[44:45], v33, s[48:51], s10 offen sc1
  s_add_u32 s10, s80, 2560
  buffer_load_dwordx2 v[46:47], v33, s[48:51], s10 offen sc1
  s_add_u32 s10, s80, 3840
  buffer_load_dwordx2 v[48:49], v33, s[48:51], s10 offen sc1
  s_add_u32 s10, s80, 5120
  buffer_load_dwordx2 v[50:51], v33, s[48:51], s10 offen sc1
  s_add_u32 s10, s80, 6400
  buffer_load_dwordx2 v[52:53], v33, s[48:51], s10 offen sc1
  s_add_u32 s10, s80, 7680
  buffer_load_dwordx2 v[54:55], v33, s[48:51], s10 offen sc1
  s_add_u32 s10, s80, 8960
  buffer_load_dwordx2 v[56:57], v33, s[48:51], s10 offen sc1
  s_add_u32 s10, s80, 10240
  buffer_load_dwordx2 v[58:59], v33, s[48:51], s10 offen sc1
  s_add_u32 s10, s80, 11520
  buffer_load_dwordx2 v[60:61], v33, s[48:51], s10 offen sc1
  buffer_load_dwordx2 v[40:41], v34, s[48:51], s81 offen sc1
  s_waitcnt vmcnt(0)
  s_branch Ha_CHK
Ha_OK:
  v_add_f32 v42, v42, v44
  v_add_f32 v42, v42, v46
  v_add_f32 v42, v42, v48
  v_add_f32 v42, v42, v50
  v_add_f32 v42, v42, v52
  v_add_f32 v42, v42, v54
  v_add_f32 v42, v42, v56
  v_add_f32 v42, v42, v58
  v_add_f32 v42, v42, v60
  v_and_b32 v45, 0xffff, v40
  v_xor_b32 v45, 0x8000, v45
  v_lshl_or_b32 v44, v45, 16, v45
  v_mov_b32 v46, 0
  v_mov_b32 v47, 0
  v_lshlrev_b32 v36, 4, v32
  ds_write_b128 v36, v[44:47] offset:53248
  v_and_b32 v40, 0xffff0000, v40
  v_rcp_f32 v40, v40
  v_lshrrev_b32 v34, 1, v34
  v_cvt_pk_bf16_f32 v48, v42, v42
  ds_write_b32 v34, v40 offset:61440
  v_lshlrev_b32 v48, 16, v48
  v_sub_f32 v49, v42, v48
  v_cvt_pk_bf16_f32 v48, v42, v49
  v_and_b32 v50, 0xffff0000, v48
  v_sub_f32 v49, v49, v50
  v_mov_b32 v50, 0
  v_mov_b32 v51, 0
  v_cvt_pk_bf16_f32 v49, v49, v50
  v_lshlrev_b32 v33, 1, v33
  v_mov_b32 v52, 0
  v_mov_b32 v53, 0
  ds_write_b128 v33, v[48:51] offset:57856
  ds_write_b128 v50, v[50:53] offset:57344
  v_xor_b32 v148, s6, v148
  v_xor_b32 v149, s6, v149
  v_xor_b32 v150, s6, v150
  v_xor_b32 v151, s6, v151
  v_or3_b32 v148, v148, v149, v150
  v_or_b32 v148, v148, v151
  v_cmp_ne_u32 vcc, 0, v148
  s_nop 4
  s_cbranch_vccz Ha_FOK
  s_mov_b32 s85, 0
  s_branch Ha_FP_1
Ha_FP:
  s_sleep 16
Ha_FP_1:
  buffer_load_dwordx4 v[148:151], v27, s[48:51], s94 offen sc1
  s_waitcnt vmcnt(0)
  v_xor_b32 v148, s6, v148
  v_xor_b32 v149, s6, v149
  v_xor_b32 v150, s6, v150
  v_xor_b32 v151, s6, v151
  v_or3_b32 v148, v148, v149, v150
  v_or_b32 v148, v148, v151
  v_cmp_ne_u32 vcc, 0, v148
  s_add_u32 s85, s85, 1
  s_cmp_lt_u32 s85, 20000
  s_cselect_b64 s[12:13], -1, 0
  s_nop 1
  s_and_b64 vcc, vcc, s[12:13]
  s_cbranch_scc1 Ha_FP
Ha_FOK:
  s_add_u32 s91, s88, 102400
  s_add_u32 m0, s95, 63488
  s_add_u32 s68, s91, 0
  buffer_load_dwordx4 v27, s[48:51], s68 offen sc1 lds
  s_add_u32 m0, s95, 64512
  s_add_u32 s68, s91, 1024
  buffer_load_dwordx4 v27, s[48:51], s68 offen sc1 lds
  s_add_u32 m0, s95, 65536
  s_add_u32 s68, s91, 2048
  buffer_load_dwordx4 v27, s[48:51], s68 offen sc1 lds
  s_add_u32 m0, s95, 66560
  s_add_u32 s68, s91, 3072
  buffer_load_dwordx4 v27, s[48:51], s68 offen sc1 lds
  s_add_u32 m0, s95, 67584
  s_add_u32 s68, s91, 4096
  buffer_load_dwordx4 v27, s[48:51], s68 offen sc1 lds
  s_add_u32 s91, s88, 143360
  s_add_u32 m0, s95, 83968
  s_add_u32 s68, s91, 0
  buffer_load_dwordx4 v27, s[48:51], s68 offen sc1 lds
  s_add_u32 m0, s95, 84992
  s_add_u32 s68, s91, 1024
  buffer_load_dwordx4 v27, s[48:51], s68 offen sc1 lds
  s_add_u32 m0, s95, 86016
  s_add_u32 s68, s91, 2048
  buffer_load_dwordx4 v27, s[48:51], s68 offen sc1 lds
  s_add_u32 m0, s95, 87040
  s_add_u32 s68, s91, 3072
  buffer_load_dwordx4 v27, s[48:51], s68 offen sc1 lds
  s_add_u32 m0, s95, 88064
  s_add_u32 s68, s91, 4096
  buffer_load_dwordx4 v27, s[48:51], s68 offen sc1 lds
  s_waitcnt vmcnt(10)
  s_waitcnt lgkmcnt(0)
  s_barrier
  s_add_u32 s91, s88, 184320
  s_add_u32 m0, s95, 104448
  s_add_u32 s68, s91, 0
  buffer_load_dwordx4 v27, s[48:51], s68 offen sc1 lds
  s_add_u32 m0, s95, 105472
  s_add_u32 s68, s91, 1024
  buffer_load_dwordx4 v27, s[48:51], s68 offen sc1 lds
  s_add_u32 m0, s95, 106496
  s_add_u32 s68, s91, 2048
  buffer_load_dwordx4 v27, s[48:51], s68 offen sc1 lds
  s_add_u32 m0, s95, 107520
  s_add_u32 s68, s91, 3072
  buffer_load_dwordx4 v27, s[48:51], s68 offen sc1 lds
  s_add_u32 m0, s95, 108544
  s_add_u32 s68, s91, 4096
  buffer_load_dwordx4 v27, s[48:51], s68 offen sc1 lds
  s_add_u32 s91, s88, 225280
  s_add_u32 m0, s95, 124928
  s_add_u32 s68, s91, 0
  buffer_load_dwordx4 v27, s[48:51], s68 offen sc1 lds
  s_add_u32 m0, s95, 125952
  s_add_u32 s68, s91, 1024
  buffer_load_dwordx4 v27, s[48:51], s68 offen sc1 lds
  s_add_u32 m0, s95, 126976
  s_add_u32 s68, s91, 2048
  buffer_load_dwordx4 v27, s[48:51], s68 offen sc1 lds
  s_add_u32 m0, s95, 128000
  s_add_u32 s68, s91, 3072
  buffer_load_dwordx4 v27, s[48:51], s68 offen sc1 lds
  s_add_u32 m0, s95, 129024
  s_add_u32 s68, s91, 4096
  buffer_load_dwordx4 v27, s[48:51], s68 offen sc1 lds
  s_add_u32 s91, s88, 0
  buffer_load_dwordx4 v[160:163], v27, s[48:51], s91 offen offset:0 sc1
  buffer_load_dwordx4 v[164:167], v27, s[48:51], s91 offen offset:1024 sc1
  buffer_load_dwordx4 v[168:171], v27, s[48:51], s91 offen offset:2048 sc1
  buffer_load_dwordx4 v[172:175], v27, s[48:51], s91 offen offset:3072 sc1
  buffer_load_dwordx4 v[176:179], v25, s[48:51], s91 offen offset:3072 sc1
  s_add_u32 s91, s88, 20480
  buffer_load_dwordx4 v[180:183], v27, s[48:51], s91 offen offset:0 sc1
  buffer_load_dwordx4 v[184:187], v27, s[48:51], s91 offen offset:1024 sc1
  buffer_load_dwordx4 v[188:191], v27, s[48:51], s91 offen offset:2048 sc1
  buffer_load_dwordx4 v[192:195], v27, s[48:51], s91 offen offset:3072 sc1
  buffer_load_dwordx4 v[196:199], v25, s[48:51], s91 offen offset:3072 sc1
  s_add_u32 s91, s88, 40960
  buffer_load_dwordx4 v[200:203], v27, s[48:51], s91 offen offset:0 sc1
  buffer_load_dwordx4 v[204:207], v27, s[48:51], s91 offen offset:1024 sc1
  buffer_load_dwordx4 v[208:211], v27, s[48:51], s91 offen offset:2048 sc1
  buffer_load_dwordx4 v[212:215], v27, s[48:51], s91 offen offset:3072 sc1
  buffer_load_dwordx4 v[216:219], v25, s[48:51], s91 offen offset:3072 sc1
  s_add_u32 s91, s88, 61440
  buffer_load_dwordx4 v[220:223], v27, s[48:51], s91 offen offset:0 sc1
  buffer_load_dwordx4 v[224:227], v27, s[48:51], s91 offen offset:1024 sc1
  buffer_load_dwordx4 v[228:231], v27, s[48:51], s91 offen offset:2048 sc1
  buffer_load_dwordx4 v[232:235], v27, s[48:51], s91 offen offset:3072 sc1
  buffer_load_dwordx4 v[236:239], v25, s[48:51], s91 offen offset:3072 sc1
  s_waitcnt lgkmcnt(0)
  s_barrier
  s_branch P2_H
K1_CA:
  s_mov_b32 s7, s5
  s_mov_b32 s56, s18
  s_and_b32 s57, s19, 0xffff
  s_mov_b32 s58, 1280
  s_mov_b32 s59, 0x20000
  s_mov_b32 s60, s20
  s_and_b32 s61, s21, 0xffff
  s_mov_b32 s62, 1280
  s_mov_b32 s63, 0x20000
  s_mov_b32 s64, s30
  s_and_b32 s65, s31, 0xffff
  s_mov_b32 s66, 1280
  s_mov_b32 s67, 0x20000
  v_and_b32 v1, 15, v0
  s_add_u32 s12, s8, 0
  s_lshl_b32 s12, s12, 5
  v_lshlrev_b32 v1, 1, v1
  buffer_load_ushort v40, v1, s[56:59], s12 offen
  buffer_load_ushort v41, v1, s[60:63], s12 offen
  buffer_load_ushort v42, v1, s[64:67], s12 offen
  s_and_b32 s10, s2, 7
  s_lshr_b32 s11, s2, 3
  s_lshl_b32 s86, s10, 2
  s_and_b32 s12, s11, 3
  s_add_u32 s86, s86, s12
  s_lshr_b32 s87, s11, 2
  s_mul_i32 s89, s86, 94
  s_add_u32 s89, s89, s7
  s_add_u32 s89, s89, 0
  s_lshl_b32 s89, s89, 12
  s_mul_i32 s88, s87, 94
  s_add_u32 s88, s88, s7
  s_add_u32 s88, s88, 0
  s_mul_i32 s88, s88, 5120
  s_add_u32 s88, s88, 12582912
  s_mul_i32 s90, s7, 17408
  s_cmp_eq_u32 s7, 3
  s_cselect_b32 s90, 145408, s90
  s_mul_i32 s99, s87, 0
  s_lshr_b32 s99, s99, 3
  s_and_b32 s12, s86, 3
  s_mul_i32 s12, s12, 0
  s_add_u32 s99, s99, s12
  s_cmp_ge_u32 s99, 10
  s_cselect_b32 s12, 10, 0
  s_sub_u32 s99, s99, s12
  s_getpc_b64 s[12:13]
Ca_PC:
  s_lshr_b32 s10, s2, 3
  s_lshl_b32 s10, s10, 2
  s_add_u32 s10, s10, s7
  s_lshl_b32 s10, s10, 9
  v_lshl_add_u32 v100, v0, 7, s10
  v_min_u32 v100, K1_END-K1_BEG, v100
  s_sub_u32 s12, s12, Ca_PC-K1_BEG
  s_subb_u32 s13, s13, 0
  v_mov_b32 v101, s13
  v_add_co_u32 v100, vcc, s12, v100
  s_nop 1
  v_addc_co_u32 v101, vcc, 0, v101, vcc
  s_mov_b64 exec, 15
  global_load_dword v102, v[100:101], off
  s_mov_b64 exec, -1
  v_and_b32 v36, 31, v0
  v_lshrrev_b32 v37, 5, v0
  v_bfe_u32 v38, v0, 1, 3
  v_xor_b32 v38, v38, v37
  v_lshlrev_b32 v36, 7, v36
  v_xor_b32 v39, 0, v38
  v_lshl_add_u32 v6, v39, 4, v36
  v_xor_b32 v39, 2, v38
  v_lshl_add_u32 v7, v39, 4, v36
  v_xor_b32 v39, 4, v38
  v_lshl_add_u32 v8, v39, 4, v36
  v_xor_b32 v39, 6, v38
  v_lshl_add_u32 v9, v39, 4, v36
  v_bfe_u32 v36, v0, 2, 2
  v_lshl_add_u32 v36, v37, 3, v36
  v_lshlrev_b32 v36, 7, v36
  v_bfe_u32 v38, v0, 4, 1
  v_lshl_add_u32 v36, v38, 13, v36
  v_bfe_u32 v39, v0, 1, 1
  v_lshl_add_u32 v36, v39, 3, v36
  v_add_u32 v36, 36864, v36
  v_and_b32 v39, 1, v0
  v_lshlrev_b32 v38, 2, v38
  v_bfe_u32 v1, v0, 3, 1
  v_lshl_or_b32 v38, v1, 1, v38
  v_xor_b32 v38, v38, v39
  v_xor_b32 v39, 0, v38
  v_lshl_add_u32 v10, v39, 4, v36
  v_xor_b32 v39, 2, v38
  v_lshl_add_u32 v11, v39, 4, v36
  v_xor_b32 v39, 4, v38
  v_lshl_add_u32 v12, v39, 4, v36
  v_xor_b32 v39, 6, v38
  v_lshl_add_u32 v13, v39, 4, v36
  s_lshl_b32 s12, s5, 13
  v_add_u32 v2, s12, v6
  v_add_u32 v6, 32768, v6
  v_add_u32 v3, s12, v7
  v_add_u32 v7, 32768, v7
  v_add_u32 v4, s12, v8
  v_add_u32 v8, 32768, v8
  v_add_u32 v5, s12, v9
  v_add_u32 v9, 32768, v9
  v_and_b32 v36, 31, v0
  v_lshlrev_b32 v36, 4, v36
  v_add_u32 v30, 57856, v36
  s_lshl_b32 s12, s5, 10
  s_add_u32 s12, s12, 53248
  v_add_u32 v28, s12, v36
  v_add_u32 v29, 512, v28
  v_cmp_gt_u32 vcc, 32, v0
  v_mov_b32 v37, 57344
  v_lshrrev_b32 v38, 4, v0
  v_cndmask_b32 v28, v37, v28, vcc
  v_cndmask_b32 v29, v37, v29, vcc
  s_lshl_b32 s12, s5, 8
  s_add_u32 s12, s12, 61440
  v_lshl_add_u32 v31, v38, 6, s12
  v_lshlrev_b32 v27, 4, v0
  v_bfe_u32 v36, v0, 4, 1
  v_lshlrev_b32 v26, 10, v36
  v_lshrrev_b32 v36, 5, v0
  v_lshl_add_u32 v26, v36, 8, v26
  v_and_b32 v36, 15, v0
  v_lshl_add_u32 v26, v36, 4, v26
  s_mov_b32 s70, 0xffff0000
  s_mov_b32 s71, -1
  s_mov_b32 s72, 0
  s_mov_b32 s73, -1
  s_mov_b32 s74, 0
  s_mov_b32 s75, 0xffff0000
  s_mov_b32 s76, 0x3fb8aa3b
  s_waitcnt vmcnt(0)
  v_lshlrev_b32 v40, 16, v40
  v_lshlrev_b32 v41, 16, v41
  v_lshlrev_b32 v42, 16, v42
  v_mul_f32 v42, s76, v42
  v_exp_f32 v42, v42
  s_nop 0
  v_cvt_pk_bf16_f32 v42, v42, v42
  v_lshlrev_b32 v42, 16, v42
  v_mul_f32 v48, v42, v40
  v_mul_f32 v49, v42, v41
  v_mul_f32 v48, s76, v48
  v_mul_f32 v49, 0.15915494, v49
  v_exp_f32 v48, v48
  v_rndne_f32 v50, v49
  v_sub_f32 v49, v49, v50
  v_cos_f32 v50, v49
  v_sin_f32 v51, v49
  v_mul_f32 v52, v40, v40
  v_mul_f32 v14, v48, v50
  v_mul_f32 v15, v48, v51
  v_fma_f32 v52, v41, v41, v52
  v_rcp_f32 v52, v52
  v_add_f32 v48, -1.0, v14
  v_add_f32 v52, v52, v52
  v_mul_f32 v50, v40, v52
  v_mul_f32 v51, -v41, v52
  v_mul_f32 v24, v48, v50
  v_mul_f32 v25, v48, v51
  v_fma_f32 v24, -v15, v51, v24
  v_fma_f32 v25, v15, v50, v25
  v_mul_f32 v54, v14, v14
  v_mul_f32 v55, v14, v15
  v_fma_f32 v54, -v15, v15, v54
  v_fma_f32 v55, v15, v14, v55
  v_mul_f32 v56, v54, v54
  v_mul_f32 v57, v54, v55
  v_fma_f32 v56, -v55, v55, v56
  v_fma_f32 v57, v55, v54, v57
  v_mul_f32 v58, v56, v56
  v_mul_f32 v59, v56, v57
  v_fma_f32 v58, -v57, v57, v58
  v_fma_f32 v59, v57, v56, v59
  v_mul_f32 v16, v58, v58
  v_mul_f32 v17, v58, v59
  v_fma_f32 v16, -v59, v59, v16
  v_fma_f32 v17, v59, v58, v17
  v_mul_f32 v60, v16, v16
  v_mul_f32 v61, v16, v17
  v_fma_f32 v60, -v17, v17, v60
  v_fma_f32 v61, v17, v16, v61
  v_mul_f32 v18, v60, v60
  v_mul_f32 v19, v60, v61
  v_fma_f32 v18, -v61, v61, v18
  v_fma_f32 v19, v61, v60, v19
  v_mul_f32 v62, v18, v18
  v_mul_f32 v63, v18, v19
  v_fma_f32 v62, -v19, v19, v62
  v_fma_f32 v63, v19, v18, v63
  v_mul_f32 v64, v62, v62
  v_mul_f32 v65, v62, v63
  v_fma_f32 v64, -v63, v63, v64
  v_fma_f32 v65, v63, v62, v65
  v_mul_f32 v66, v64, v64
  v_mul_f32 v67, v64, v65
  v_fma_f32 v66, -v65, v65, v66
  v_fma_f32 v67, v65, v64, v67
  v_mul_f32 v68, v66, v66
  v_mul_f32 v69, v66, v67
  v_fma_f32 v68, -v67, v67, v68
  v_fma_f32 v69, v67, v66, v69
  v_mul_f32 v48, v66, v68
  v_mul_f32 v49, v66, v69
  v_fma_f32 v48, -v67, v69, v48
  v_fma_f32 v49, v67, v68, v49
  v_cndmask_b32 v20, 1.0, v66, s[70:71]
  v_cndmask_b32 v20, v20, v68, s[72:73]
  v_cndmask_b32 v20, v20, v48, s[74:75]
  v_cndmask_b32 v21, 0, v67, s[70:71]
  v_cndmask_b32 v21, v21, v69, s[72:73]
  v_cndmask_b32 v21, v21, v49, s[74:75]
  v_mul_f32 v48, v16, v60
  v_mul_f32 v49, v16, v61
  v_fma_f32 v48, -v17, v61, v48
  v_fma_f32 v49, v17, v60, v49
  v_cndmask_b32 v22, 1.0, v16, s[70:71]
  v_cndmask_b32 v22, v22, v60, s[72:73]
  v_cndmask_b32 v22, v22, v48, s[74:75]
  v_cndmask_b32 v23, 0, v17, s[70:71]
  v_cndmask_b32 v23, v23, v61, s[72:73]
  v_cndmask_b32 v23, v23, v49, s[74:75]
  s_waitcnt lgkmcnt(0)
  s_mul_i32 s6, s6, 0x41c64e6d
  s_add_u32 s6, s6, 0x7f4a7c15
  s_lshl_b32 s80, s3, 2
  s_add_u32 s80, s80, s5
  s_mul_i32 s81, s80, 385024
  s_lshl_b32 s12, s4, 14
  s_add_u32 s78, s12, 17301504
  s_lshl_b32 s12, s80, 8
  s_add_u32 s82, s12, s78
  s_add_u32 s83, s82, 8192
  s_lshl_b32 s12, s80, 5
  s_add_u32 s12, s12, s4
  s_lshl_b32 s12, s12, 4
  s_add_u32 s94, s12, 17956864
  s_lshr_b32 s12, s9, 1
  s_add_u32 s12, s12, 40
  s_lshl_b32 s12, s12, 12
  s_add_u32 s66, s12, s81
  s_add_u32 s67, s66, 4096
  v_lshrrev_b32 v36, 4, v0
  v_lshlrev_b32 v36, 3, v36
  s_sub_u32 s12, s80, 8
  v_sub_u32 v36, s12, v36
  v_and_b32 v37, 15, v0
  v_lshlrev_b32 v37, 4, v37
  v_lshl_add_u32 v37, v36, 8, v37
  v_add_u32 v37, s78, v37
  v_cmp_le_i32 s[16:17], 0, v36
  v_cmp_le_i32 s[18:19], -1, v36
  v_cmp_le_i32 s[20:21], -2, v36
  v_cmp_le_i32 s[22:23], -3, v36
  v_cmp_le_i32 s[24:25], -4, v36
  v_cmp_le_i32 s[26:27], -5, v36
  v_cmp_le_i32 s[28:29], -6, v36
  v_cmp_le_i32 s[30:31], -7, v36
  v_lshl_add_u32 v34, v0, 5, s90
  v_lshrrev_b32 v38, 5, v0
  v_lshlrev_b32 v35, 11, v38
  v_bfe_u32 v38, v0, 4, 1
  v_lshl_add_u32 v35, v38, 8, v35
  v_bfe_u32 v38, v0, 2, 2
  v_lshl_add_u32 v35, v38, 5, v35
  v_and_b32 v38, 1, v0
  v_lshl_add_u32 v35, v38, 10, v35
  v_bfe_u32 v38, v0, 1, 1
  v_lshl_add_u32 v35, v38, 3, v35
  v_add_u32 v35, s90, v35
  s_mov_b32 s14, 0
  s_mov_b32 s15, 0
  s_barrier
  ds_read_b128 v[40:43], v2 offset:0
  ds_read_b128 v[44:47], v2 offset:4096
  ds_read_b128 v[48:51], v6 offset:0
  ds_read_b64_tr_b16 v[52:53], v10 offset:0
  ds_read_b64_tr_b16 v[54:55], v10 offset:512
  ds_read_b64_tr_b16 v[56:57], v11 offset:0
  ds_read_b64_tr_b16 v[58:59], v11 offset:512
  ds_read_b64_tr_b16 v[60:61], v12 offset:0
  ds_read_b64_tr_b16 v[62:63], v12 offset:512
  ds_read_b64_tr_b16 v[64:65], v13 offset:0
  ds_read_b64_tr_b16 v[66:67], v13 offset:512
  s_waitcnt lgkmcnt(0)
  v_mfma_f32_32x32x16_bf16 v[96:111], v[40:43], v[48:51], 0
  ds_read_b128 v[68:71], v3 offset:0
  ds_read_b128 v[72:75], v3 offset:4096
  v_mfma_f32_32x32x16_bf16 v[112:127], v[44:47], v[48:51], 0
  ds_read_b128 v[76:79], v7 offset:0
  ds_read_b64_tr_b16 v[80:81], v10 offset:2048
  v_mfma_f32_32x32x16_bf16 v[128:143], v[52:55], v[40:43], 0
  ds_read_b64_tr_b16 v[82:83], v10 offset:2560
  ds_read_b64_tr_b16 v[84:85], v11 offset:2048
  v_mfma_f32_32x32x16_bf16 v[144:159], v[52:55], v[44:47], 0
  ds_read_b64_tr_b16 v[86:87], v11 offset:2560
  ds_read_b64_tr_b16 v[88:89], v12 offset:2048
  v_mfma_f32_32x32x16_bf16 v[160:175], v[56:59], v[40:43], 0
  ds_read_b64_tr_b16 v[90:91], v12 offset:2560
  ds_read_b64_tr_b16 v[92:93], v13 offset:2048
  v_mfma_f32_32x32x16_bf16 v[176:191], v[56:59], v[44:47], 0
  ds_read_b64_tr_b16 v[94:95], v13 offset:2560
  v_mfma_f32_32x32x16_bf16 v[192:207], v[60:63], v[40:43], 0
  v_mfma_f32_32x32x16_bf16 v[208:223], v[60:63], v[44:47], 0
  v_mfma_f32_32x32x16_bf16 v[224:239], v[64:67], v[40:43], 0
  v_mfma_f32_32x32x16_bf16 v[240:255], v[64:67], v[44:47], 0
  s_branch Ca_L1
Ca_LOOP:
  s_waitcnt lgkmcnt(0)
  v_mfma_f32_32x32x16_bf16 v[96:111], v[40:43], v[48:51], v[96:111]
  ds_read_b128 v[68:71], v3 offset:0
  ds_read_b128 v[72:75], v3 offset:4096
  v_mfma_f32_32x32x16_bf16 v[112:127], v[44:47], v[48:51], v[112:127]
  ds_read_b128 v[76:79], v7 offset:0
  ds_read_b64_tr_b16 v[80:81], v10 offset:2048
  v_mfma_f32_32x32x16_bf16 v[128:143], v[52:55], v[40:43], v[128:143]
  ds_read_b64_tr_b16 v[82:83], v10 offset:2560
  ds_read_b64_tr_b16 v[84:85], v11 offset:2048
  v_mfma_f32_32x32x16_bf16 v[144:159], v[52:55], v[44:47], v[144:159]
  ds_read_b64_tr_b16 v[86:87], v11 offset:2560
  ds_read_b64_tr_b16 v[88:89], v12 offset:2048
  v_mfma_f32_32x32x16_bf16 v[160:175], v[56:59], v[40:43], v[160:175]
  ds_read_b64_tr_b16 v[90:91], v12 offset:2560
  ds_read_b64_tr_b16 v[92:93], v13 offset:2048
  v_mfma_f32_32x32x16_bf16 v[176:191], v[56:59], v[44:47], v[176:191]
  ds_read_b64_tr_b16 v[94:95], v13 offset:2560
  v_mfma_f32_32x32x16_bf16 v[192:207], v[60:63], v[40:43], v[192:207]
  v_mfma_f32_32x32x16_bf16 v[208:223], v[60:63], v[44:47], v[208:223]
  v_mfma_f32_32x32x16_bf16 v[224:239], v[64:67], v[40:43], v[224:239]
  v_mfma_f32_32x32x16_bf16 v[240:255], v[64:67], v[44:47], v[240:255]
Ca_L1:
  s_waitcnt lgkmcnt(0)
  v_mfma_f32_32x32x16_bf16 v[96:111], v[68:71], v[76:79], v[96:111]
  ds_read_b128 v[40:43], v4 offset:0
  ds_read_b128 v[44:47], v4 offset:4096
  v_mfma_f32_32x32x16_bf16 v[112:127], v[72:75], v[76:79], v[112:127]
  ds_read_b128 v[48:51], v8 offset:0
  ds_read_b64_tr_b16 v[52:53], v10 offset:4096
  v_mfma_f32_32x32x16_bf16 v[128:143], v[80:83], v[68:71], v[128:143]
  ds_read_b64_tr_b16 v[54:55], v10 offset:4608
  ds_read_b64_tr_b16 v[56:57], v11 offset:4096
  v_mfma_f32_32x32x16_bf16 v[144:159], v[80:83], v[72:75], v[144:159]
  ds_read_b64_tr_b16 v[58:59], v11 offset:4608
  ds_read_b64_tr_b16 v[60:61], v12 offset:4096
  v_mfma_f32_32x32x16_bf16 v[160:175], v[84:87], v[68:71], v[160:175]
  ds_read_b64_tr_b16 v[62:63], v12 offset:4608
  ds_read_b64_tr_b16 v[64:65], v13 offset:4096
  v_mfma_f32_32x32x16_bf16 v[176:191], v[84:87], v[72:75], v[176:191]
  ds_read_b64_tr_b16 v[66:67], v13 offset:4608
  v_mfma_f32_32x32x16_bf16 v[192:207], v[88:91], v[68:71], v[192:207]
  v_mfma_f32_32x32x16_bf16 v[208:223], v[88:91], v[72:75], v[208:223]
  v_mfma_f32_32x32x16_bf16 v[224:239], v[92:95], v[68:71], v[224:239]
  v_mfma_f32_32x32x16_bf16 v[240:255], v[92:95], v[72:75], v[240:255]
  s_waitcnt lgkmcnt(0)
  v_mfma_f32_32x32x16_bf16 v[96:111], v[40:43], v[48:51], v[96:111]
  ds_read_b128 v[68:71], v5 offset:0
  ds_read_b128 v[72:75], v5 offset:4096
  v_mfma_f32_32x32x16_bf16 v[112:127], v[44:47], v[48:51], v[112:127]
  ds_read_b128 v[76:79], v9 offset:0
  ds_read_b64_tr_b16 v[80:81], v10 offset:6144
  v_mfma_f32_32x32x16_bf16 v[128:143], v[52:55], v[40:43], v[128:143]
  ds_read_b64_tr_b16 v[82:83], v10 offset:6656
  ds_read_b64_tr_b16 v[84:85], v11 offset:6144
  v_mfma_f32_32x32x16_bf16 v[144:159], v[52:55], v[44:47], v[144:159]
  ds_read_b64_tr_b16 v[86:87], v11 offset:6656
  ds_read_b64_tr_b16 v[88:89], v12 offset:6144
  v_mfma_f32_32x32x16_bf16 v[160:175], v[56:59], v[40:43], v[160:175]
  ds_read_b64_tr_b16 v[90:91], v12 offset:6656
  ds_read_b64_tr_b16 v[92:93], v13 offset:6144
  v_mfma_f32_32x32x16_bf16 v[176:191], v[56:59], v[44:47], v[176:191]
  ds_read_b64_tr_b16 v[94:95], v13 offset:6656
  v_mfma_f32_32x32x16_bf16 v[192:207], v[60:63], v[40:43], v[192:207]
  v_mfma_f32_32x32x16_bf16 v[208:223], v[60:63], v[44:47], v[208:223]
  v_mfma_f32_32x32x16_bf16 v[224:239], v[64:67], v[40:43], v[224:239]
  v_mfma_f32_32x32x16_bf16 v[240:255], v[64:67], v[44:47], v[240:255]
  s_add_u32 s14, s14, 1
  s_add_u32 s15, s15, 1
  s_cmp_eq_u32 s15, 3
  s_cselect_b32 s13, -2, 1
  s_cselect_b32 s15, 0, s15
  s_mul_i32 s13, s13, 53248
  s_cmp_eq_u32 s14, 9
  s_cbranch_scc1 Ca_LAST
  s_waitcnt lgkmcnt(0)
  v_mfma_f32_32x32x16_bf16 v[96:111], v[68:71], v[76:79], v[96:111]
  v_add_u32 v2, s13, v2
  v_add_u32 v6, s13, v6
  v_add_u32 v10, s13, v10
  v_add_u32 v11, s13, v11
  v_add_u32 v12, s13, v12
  v_add_u32 v13, s13, v13
  s_barrier
  ds_read_b128 v[40:43], v2 offset:0
  ds_read_b128 v[44:47], v2 offset:4096
  v_mfma_f32_32x32x16_bf16 v[112:127], v[72:75], v[76:79], v[112:127]
  ds_read_b128 v[48:51], v6 offset:0
  ds_read_b64_tr_b16 v[52:53], v10 offset:0
  v_mfma_f32_32x32x16_bf16 v[128:143], v[80:83], v[68:71], v[128:143]
  ds_read_b64_tr_b16 v[54:55], v10 offset:512
  ds_read_b64_tr_b16 v[56:57], v11 offset:0
  v_mfma_f32_32x32x16_bf16 v[144:159], v[80:83], v[72:75], v[144:159]
  ds_read_b64_tr_b16 v[58:59], v11 offset:512
  ds_read_b64_tr_b16 v[60:61], v12 offset:0
  v_mfma_f32_32x32x16_bf16 v[160:175], v[84:87], v[68:71], v[160:175]
  ds_read_b64_tr_b16 v[62:63], v12 offset:512
  ds_read_b64_tr_b16 v[64:65], v13 offset:0
  v_mfma_f32_32x32x16_bf16 v[176:191], v[84:87], v[72:75], v[176:191]
  ds_read_b64_tr_b16 v[66:67], v13 offset:512
  v_add_u32 v3, s13, v3
  v_mfma_f32_32x32x16_bf16 v[192:207], v[88:91], v[68:71], v[192:207]
  v_add_u32 v4, s13, v4
  v_add_u32 v5, s13, v5
  v_mfma_f32_32x32x16_bf16 v[208:223], v[88:91], v[72:75], v[208:223]
  v_add_u32 v7, s13, v7
  v_add_u32 v8, s13, v8
  v_mfma_f32_32x32x16_bf16 v[224:239], v[92:95], v[68:71], v[224:239]
  v_add_u32 v9, s13, v9
  v_mfma_f32_32x32x16_bf16 v[240:255], v[92:95], v[72:75], v[240:255]
  s_branch Ca_LOOP
Ca_LAST:
  s_waitcnt lgkmcnt(0)
  v_mfma_f32_32x32x16_bf16 v[96:111], v[68:71], v[76:79], v[96:111]
  v_add_u32 v2, s13, v2
  v_add_u32 v6, s13, v6
  v_add_u32 v10, s13, v10
  v_add_u32 v11, s13, v11
  v_add_u32 v12, s13, v12
  v_add_u32 v13, s13, v13
  v_add_u32 v3, s13, v3
  v_add_u32 v4, s13, v4
  v_add_u32 v5, s13, v5
  v_add_u32 v7, s13, v7
  v_add_u32 v8, s13, v8
  v_add_u32 v9, s13, v9
  s_barrier
  ds_read_b128 v[40:43], v2 offset:0
  ds_read_b128 v[44:47], v2 offset:4096
  v_mfma_f32_32x32x16_bf16 v[112:127], v[72:75], v[76:79], v[112:127]
  ds_read_b128 v[48:51], v6 offset:0
  ds_read_b128 v[52:55], v3 offset:0
  v_mfma_f32_32x32x16_bf16 v[128:143], v[80:83], v[68:71], v[128:143]
  ds_read_b128 v[56:59], v3 offset:4096
  ds_read_b128 v[60:63], v7 offset:0
  v_mfma_f32_32x32x16_bf16 v[144:159], v[80:83], v[72:75], v[144:159]
  v_mfma_f32_32x32x16_bf16 v[160:175], v[84:87], v[68:71], v[160:175]
  v_mfma_f32_32x32x16_bf16 v[176:191], v[84:87], v[72:75], v[176:191]
  v_mfma_f32_32x32x16_bf16 v[192:207], v[88:91], v[68:71], v[192:207]
  v_mfma_f32_32x32x16_bf16 v[208:223], v[88:91], v[72:75], v[208:223]
  v_mfma_f32_32x32x16_bf16 v[224:239], v[92:95], v[68:71], v[224:239]
  v_mfma_f32_32x32x16_bf16 v[240:255], v[92:95], v[72:75], v[240:255]
  s_waitcnt lgkmcnt(0)
  v_mfma_f32_32x32x16_bf16 v[96:111], v[40:43], v[48:51], v[96:111]
  ds_read_b128 v[68:71], v4 offset:0
  ds_read_b128 v[72:75], v4 offset:4096
  ds_read_b128 v[76:79], v8 offset:0
  v_mfma_f32_32x32x16_bf16 v[112:127], v[44:47], v[48:51], v[112:127]
  ds_read_b128 v[80:83], v5 offset:0
  ds_read_b128 v[84:87], v5 offset:4096
  ds_read_b128 v[88:91], v9 offset:0
  v_mfma_f32_32x32x16_bf16 v[96:111], v[52:55], v[60:63], v[96:111]
  v_mfma_f32_32x32x16_bf16 v[112:127], v[56:59], v[60:63], v[112:127]
  s_waitcnt lgkmcnt(0)
  v_mfma_f32_32x32x16_bf16 v[96:111], v[68:71], v[76:79], v[96:111]
  ds_read_b128 v[40:43], v28
  ds_read_b128 v[44:47], v29
  ds_read_b128 v[48:51], v30 offset:0
  v_mfma_f32_32x32x16_bf16 v[112:127], v[72:75], v[76:79], v[112:127]
  ds_read_b128 v[52:55], v30 offset:512
  ds_read_b128 v[56:59], v30 offset:1024
  ds_read_b128 v[60:63], v30 offset:1536
  v_mfma_f32_32x32x16_bf16 v[96:111], v[80:83], v[88:91], v[96:111]
  ds_read_b128 v[64:67], v30 offset:2048
  v_mfma_f32_32x32x16_bf16 v[112:127], v[84:87], v[88:91], v[112:127]
  s_waitcnt lgkmcnt(0)
  v_mfma_f32_32x32x16_bf16 v[96:111], v[40:43], v[48:51], v[96:111]
  ds_read_b128 v[68:71], v2 offset:0
  ds_read_b128 v[72:75], v2 offset:4096
  v_mfma_f32_32x32x16_bf16 v[112:127], v[44:47], v[48:51], v[112:127]
  ds_read_b64_tr_b16 v[80:81], v10 offset:0
  ds_read_b64_tr_b16 v[82:83], v10 offset:512
  v_mfma_f32_32x32x16_bf16 v[128:143], v[52:55], v[40:43], v[128:143]
  ds_read_b64_tr_b16 v[84:85], v11 offset:0
  ds_read_b64_tr_b16 v[86:87], v11 offset:512
  v_mfma_f32_32x32x16_bf16 v[144:159], v[52:55], v[44:47], v[144:159]
  ds_read_b64_tr_b16 v[88:89], v12 offset:0
  ds_read_b64_tr_b16 v[90:91], v12 offset:512
  v_mfma_f32_32x32x16_bf16 v[160:175], v[56:59], v[40:43], v[160:175]
  ds_read_b64_tr_b16 v[92:93], v13 offset:0
  ds_read_b64_tr_b16 v[94:95], v13 offset:512
  v_mfma_f32_32x32x16_bf16 v[176:191], v[56:59], v[44:47], v[176:191]
  ds_read_b128 v[76:79], v31 offset:0
  ds_read_b128 v[48:51], v31 offset:16
  v_mfma_f32_32x32x16_bf16 v[192:207], v[60:63], v[40:43], v[192:207]
  v_permlane16_swap_b32 v96, v112
  v_permlane16_swap_b32 v97, v113
  v_permlane16_swap_b32 v98, v114
  v_permlane16_swap_b32 v99, v115
  v_mfma_f32_32x32x16_bf16 v[208:223], v[60:63], v[44:47], v[208:223]
  v_permlane16_swap_b32 v100, v116
  v_permlane16_swap_b32 v101, v117
  v_permlane16_swap_b32 v102, v118
  v_permlane16_swap_b32 v103, v119
  v_mfma_f32_32x32x16_bf16 v[224:239], v[64:67], v[40:43], v[224:239]
  v_permlane16_swap_b32 v104, v120
  v_permlane16_swap_b32 v105, v121
  v_permlane16_swap_b32 v106, v122
  v_permlane16_swap_b32 v107, v123
  v_mfma_f32_32x32x16_bf16 v[240:255], v[64:67], v[44:47], v[240:255]
  v_permlane16_swap_b32 v108, v124
  v_permlane16_swap_b32 v109, v125
  v_permlane16_swap_b32 v110, v126
  v_permlane16_swap_b32 v111, v127
  s_waitcnt lgkmcnt(0)
  v_mfma_f32_32x32x16_bf16 v[128:143], v[80:83], v[68:71], v[128:143]
  ds_read_b128 v[40:43], v3 offset:0
  ds_read_b128 v[44:47], v3 offset:4096
  v_mul_f32 v96, v96, v76
  v_mul_f32 v112, v112, v76
  v_mul_f32 v97, v97, v77
  v_mul_f32 v113, v113, v77
  v_mfma_f32_32x32x16_bf16 v[144:159], v[80:83], v[72:75], v[144:159]
  ds_read_b64_tr_b16 v[52:53], v10 offset:2048
  ds_read_b64_tr_b16 v[54:55], v10 offset:2560
  v_mul_f32 v98, v98, v78
  v_mul_f32 v114, v114, v78
  v_mul_f32 v99, v99, v79
  v_mul_f32 v115, v115, v79
  v_mfma_f32_32x32x16_bf16 v[160:175], v[84:87], v[68:71], v[160:175]
  ds_read_b64_tr_b16 v[56:57], v11 offset:2048
  ds_read_b64_tr_b16 v[58:59], v11 offset:2560
  v_mul_f32 v100, v100, v48
  v_mul_f32 v116, v116, v48
  v_mul_f32 v101, v101, v49
  v_mul_f32 v117, v117, v49
  v_mfma_f32_32x32x16_bf16 v[176:191], v[84:87], v[72:75], v[176:191]
  ds_read_b64_tr_b16 v[60:61], v12 offset:2048
  ds_read_b64_tr_b16 v[62:63], v12 offset:2560
  v_mul_f32 v102, v102, v50
  v_mul_f32 v118, v118, v50
  v_mul_f32 v103, v103, v51
  v_mul_f32 v119, v119, v51
  v_mfma_f32_32x32x16_bf16 v[192:207], v[88:91], v[68:71], v[192:207]
  ds_read_b64_tr_b16 v[64:65], v13 offset:2048
  ds_read_b64_tr_b16 v[66:67], v13 offset:2560
  ds_read_b128 v[76:79], v31 offset:32
  ds_read_b128 v[48:51], v31 offset:48
  v_fma_f32 v8, v14, v96, v97
  v_fma_f32 v9, v14, v112, v113
  v_mfma_f32_32x32x16_bf16 v[208:223], v[88:91], v[72:75], v[208:223]
  v_fma_f32 v8, -v15, v112, v8
  v_fma_f32 v9, v15, v96, v9
  v_fma_f32 v6, v14, v8, v98
  v_fma_f32 v7, v14, v9, v114
  v_mfma_f32_32x32x16_bf16 v[224:239], v[92:95], v[68:71], v[224:239]
  v_fma_f32 v6, -v15, v9, v6
  v_fma_f32 v7, v15, v8, v7
  v_fma_f32 v8, v14, v6, v99
  v_fma_f32 v9, v14, v7, v115
  v_mfma_f32_32x32x16_bf16 v[240:255], v[92:95], v[72:75], v[240:255]
  v_fma_f32 v8, -v15, v7, v8
  v_fma_f32 v9, v15, v6, v9
  s_waitcnt lgkmcnt(0)
  v_mfma_f32_32x32x16_bf16 v[128:143], v[52:55], v[40:43], v[128:143]
  ds_read_b128 v[68:71], v4 offset:0
  ds_read_b128 v[72:75], v4 offset:4096
  v_mul_f32 v104, v104, v76
  v_mul_f32 v120, v120, v76
  v_mul_f32 v105, v105, v77
  v_mul_f32 v121, v121, v77
  v_mfma_f32_32x32x16_bf16 v[144:159], v[52:55], v[44:47], v[144:159]
  ds_read_b64_tr_b16 v[80:81], v10 offset:4096
  ds_read_b64_tr_b16 v[82:83], v10 offset:4608
  v_mul_f32 v106, v106, v78
  v_mul_f32 v122, v122, v78
  v_mul_f32 v107, v107, v79
  v_mul_f32 v123, v123, v79
  v_mfma_f32_32x32x16_bf16 v[160:175], v[56:59], v[40:43], v[160:175]
  ds_read_b64_tr_b16 v[84:85], v11 offset:4096
  ds_read_b64_tr_b16 v[86:87], v11 offset:4608
  v_mul_f32 v108, v108, v48
  v_mul_f32 v124, v124, v48
  v_mul_f32 v109, v109, v49
  v_mul_f32 v125, v125, v49
  v_mfma_f32_32x32x16_bf16 v[176:191], v[56:59], v[44:47], v[176:191]
  ds_read_b64_tr_b16 v[88:89], v12 offset:4096
  ds_read_b64_tr_b16 v[90:91], v12 offset:4608
  v_mul_f32 v110, v110, v50
  v_mul_f32 v126, v126, v50
  v_mul_f32 v111, v111, v51
  v_mul_f32 v127, v127, v51
  v_mfma_f32_32x32x16_bf16 v[192:207], v[60:63], v[40:43], v[192:207]
  ds_read_b64_tr_b16 v[92:93], v13 offset:4096
  ds_read_b64_tr_b16 v[94:95], v13 offset:4608
  v_fma_f32 v6, v14, v8, v100
  v_fma_f32 v7, v14, v9, v116
  v_fma_f32 v6, -v15, v9, v6
  v_fma_f32 v7, v15, v8, v7
  v_mfma_f32_32x32x16_bf16 v[208:223], v[60:63], v[44:47], v[208:223]
  v_fma_f32 v8, v14, v6, v101
  v_fma_f32 v9, v14, v7, v117
  v_fma_f32 v8, -v15, v7, v8
  v_fma_f32 v9, v15, v6, v9
  v_mfma_f32_32x32x16_bf16 v[224:239], v[64:67], v[40:43], v[224:239]
  v_fma_f32 v6, v14, v8, v102
  v_fma_f32 v7, v14, v9, v118
  v_fma_f32 v6, -v15, v9, v6
  v_fma_f32 v7, v15, v8, v7
  v_mfma_f32_32x32x16_bf16 v[240:255], v[64:67], v[44:47], v[240:255]
  v_fma_f32 v8, v14, v6, v103
  v_fma_f32 v9, v14, v7, v119
  v_fma_f32 v8, -v15, v7, v8
  v_fma_f32 v9, v15, v6, v9
  s_waitcnt lgkmcnt(0)
  v_mfma_f32_32x32x16_bf16 v[128:143], v[80:83], v[68:71], v[128:143]
  ds_read_b128 v[40:43], v5 offset:0
  ds_read_b128 v[44:47], v5 offset:4096
  v_fma_f32 v6, v14, v8, v104
  v_fma_f32 v7, v14, v9, v120
  v_fma_f32 v6, -v15, v9, v6
  v_fma_f32 v7, v15, v8, v7
  v_mfma_f32_32x32x16_bf16 v[144:159], v[80:83], v[72:75], v[144:159]
  ds_read_b64_tr_b16 v[52:53], v10 offset:6144
  ds_read_b64_tr_b16 v[54:55], v10 offset:6656
  v_fma_f32 v8, v14, v6, v105
  v_fma_f32 v9, v14, v7, v121
  v_fma_f32 v8, -v15, v7, v8
  v_fma_f32 v9, v15, v6, v9
  v_mfma_f32_32x32x16_bf16 v[160:175], v[84:87], v[68:71], v[160:175]
  ds_read_b64_tr_b16 v[56:57], v11 offset:6144
  ds_read_b64_tr_b16 v[58:59], v11 offset:6656
  v_fma_f32 v6, v14, v8, v106
  v_fma_f32 v7, v14, v9, v122
  v_fma_f32 v6, -v15, v9, v6
  v_fma_f32 v7, v15, v8, v7
  v_mfma_f32_32x32x16_bf16 v[176:191], v[84:87], v[72:75], v[176:191]
  ds_read_b64_tr_b16 v[60:61], v12 offset:6144
  ds_read_b64_tr_b16 v[62:63], v12 offset:6656
  v_fma_f32 v8, v14, v6, v107
  v_fma_f32 v9, v14, v7, v123
  v_fma_f32 v8, -v15, v7, v8
  v_fma_f32 v9, v15, v6, v9
  v_mfma_f32_32x32x16_bf16 v[192:207], v[88:91], v[68:71], v[192:207]
  ds_read_b64_tr_b16 v[64:65], v13 offset:6144
  ds_read_b64_tr_b16 v[66:67], v13 offset:6656
  v_fma_f32 v6, v14, v8, v108
  v_fma_f32 v7, v14, v9, v124
  v_fma_f32 v6, -v15, v9, v6
  v_fma_f32 v7, v15, v8, v7
  v_mfma_f32_32x32x16_bf16 v[208:223], v[88:91], v[72:75], v[208:223]
  v_fma_f32 v8, v14, v6, v109
  v_fma_f32 v9, v14, v7, v125
  v_fma_f32 v8, -v15, v7, v8
  v_fma_f32 v9, v15, v6, v9
  v_mfma_f32_32x32x16_bf16 v[224:239], v[92:95], v[68:71], v[224:239]
  v_fma_f32 v6, v14, v8, v110
  v_fma_f32 v7, v14, v9, v126
  v_fma_f32 v6, -v15, v9, v6
  v_fma_f32 v7, v15, v8, v7
  v_mfma_f32_32x32x16_bf16 v[240:255], v[92:95], v[72:75], v[240:255]
  v_fma_f32 v8, v14, v6, v111
  v_fma_f32 v9, v14, v7, v127
  v_fma_f32 v8, -v15, v7, v8
  v_fma_f32 v9, v15, v6, v9
  s_waitcnt lgkmcnt(0)
  v_mfma_f32_32x32x16_bf16 v[128:143], v[52:55], v[40:43], v[128:143]
  s_barrier
  v_mov_b32 v72, v8
  v_mov_b32 v73, v8
  v_mov_b32 v76, v9
  v_mov_b32 v77, v9
  s_nop 1
  v_permlane16_swap_b32 v72, v73
  v_mfma_f32_32x32x16_bf16 v[144:159], v[52:55], v[44:47], v[144:159]
  v_permlane16_swap_b32 v76, v77
  s_nop 1
  v_mov_b32 v74, v72
  v_mov_b32 v75, v73
  v_mov_b32 v78, v76
  v_mov_b32 v79, v77
  v_mfma_f32_32x32x16_bf16 v[160:175], v[56:59], v[40:43], v[160:175]
  s_nop 1
  v_permlane32_swap_b32 v72, v74
  v_permlane32_swap_b32 v73, v75
  v_permlane32_swap_b32 v76, v78
  v_permlane32_swap_b32 v77, v79
  s_nop 1
  v_mfma_f32_32x32x16_bf16 v[176:191], v[56:59], v[44:47], v[176:191]
  v_fma_f32 v68, v16, v72, v73
  v_fma_f32 v69, v16, v76, v77
  v_fma_f32 v68, -v17, v76, v68
  v_fma_f32 v69, v17, v72, v69
  v_fma_f32 v70, v16, v68, v74
  v_fma_f32 v71, v16, v69, v78
  v_mfma_f32_32x32x16_bf16 v[192:207], v[60:63], v[40:43], v[192:207]
  v_fma_f32 v70, -v17, v69, v70
  v_fma_f32 v71, v17, v68, v71
  v_fma_f32 v80, v16, v70, v75
  v_fma_f32 v82, v16, v71, v79
  v_fma_f32 v80, -v17, v71, v80
  v_fma_f32 v82, v17, v70, v82
  v_mfma_f32_32x32x16_bf16 v[208:223], v[60:63], v[44:47], v[208:223]
  v_mov_b32 v81, s6
  v_mov_b32 v83, s6
  s_mov_b64 exec, 0xffff
  buffer_store_dwordx4 v[80:83], v27, s[48:51], s82 offen sc1
  s_mov_b64 exec, -1
  v_cndmask_b32 v32, 0, v72, s[70:71]
  v_mfma_f32_32x32x16_bf16 v[224:239], v[64:67], v[40:43], v[224:239]
  v_cndmask_b32 v32, v32, v68, s[72:73]
  v_cndmask_b32 v32, v32, v70, s[74:75]
  v_cndmask_b32 v33, 0, v76, s[70:71]
  v_cndmask_b32 v33, v33, v69, s[72:73]
  v_cndmask_b32 v33, v33, v71, s[74:75]
  v_mfma_f32_32x32x16_bf16 v[240:255], v[64:67], v[44:47], v[240:255]
  s_nop 3
  s_nop 3
  v_add_u32 v2, 1024, v27
  v_add_u32 v3, 8192, v37
  v_max_f32 v128, 0, v128
  v_max_f32 v129, 0, v129
  v_max_f32 v130, 0, v130
  v_max_f32 v131, 0, v131
  v_max_f32 v132, 0, v132
  v_max_f32 v133, 0, v133
  v_max_f32 v134, 0, v134
  v_max_f32 v135, 0, v135
  v_pk_mul_f32 v[128:129], v[128:129], v[136:137]
  v_pk_mul_f32 v[130:131], v[130:131], v[138:139]
  v_pk_mul_f32 v[132:133], v[132:133], v[140:141]
  v_pk_mul_f32 v[134:135], v[134:135], v[142:143]
  v_cvt_pk_bf16_f32 v136, v128, v129
  v_cvt_pk_bf16_f32 v137, v130, v131
  v_cvt_pk_bf16_f32 v138, v132, v133
  v_cvt_pk_bf16_f32 v139, v134, v135
  buffer_store_dwordx4 v[136:139], v26, s[48:51], s66 offen offset:0 sc1
  v_max_f32 v144, 0, v144
  v_max_f32 v145, 0, v145
  v_max_f32 v146, 0, v146
  v_max_f32 v147, 0, v147
  v_max_f32 v148, 0, v148
  v_max_f32 v149, 0, v149
  v_max_f32 v150, 0, v150
  v_max_f32 v151, 0, v151
  v_pk_mul_f32 v[144:145], v[144:145], v[152:153]
  v_pk_mul_f32 v[146:147], v[146:147], v[154:155]
  v_pk_mul_f32 v[148:149], v[148:149], v[156:157]
  v_pk_mul_f32 v[150:151], v[150:151], v[158:159]
  v_cvt_pk_bf16_f32 v152, v144, v145
  v_cvt_pk_bf16_f32 v153, v146, v147
  v_cvt_pk_bf16_f32 v154, v148, v149
  v_cvt_pk_bf16_f32 v155, v150, v151
  buffer_store_dwordx4 v[152:155], v26, s[48:51], s66 offen offset:2048 sc1
  v_max_f32 v160, 0, v160
  v_max_f32 v161, 0, v161
  v_max_f32 v162, 0, v162
  v_max_f32 v163, 0, v163
  v_max_f32 v164, 0, v164
  v_max_f32 v165, 0, v165
  v_max_f32 v166, 0, v166
  v_max_f32 v167, 0, v167
  v_pk_mul_f32 v[160:161], v[160:161], v[168:169]
  v_pk_mul_f32 v[162:163], v[162:163], v[170:171]
  v_pk_mul_f32 v[164:165], v[164:165], v[172:173]
  v_pk_mul_f32 v[166:167], v[166:167], v[174:175]
  v_cvt_pk_bf16_f32 v168, v160, v161
  v_cvt_pk_bf16_f32 v169, v162, v163
  v_cvt_pk_bf16_f32 v170, v164, v165
  v_cvt_pk_bf16_f32 v171, v166, v167
  buffer_store_dwordx4 v[168:171], v26, s[48:51], s66 offen offset:512 sc1
  v_max_f32 v176, 0, v176
  v_max_f32 v177, 0, v177
  v_max_f32 v178, 0, v178
  v_max_f32 v179, 0, v179
  v_max_f32 v180, 0, v180
  v_max_f32 v181, 0, v181
  v_max_f32 v182, 0, v182
  v_max_f32 v183, 0, v183
  v_pk_mul_f32 v[176:177], v[176:177], v[184:185]
  v_pk_mul_f32 v[178:179], v[178:179], v[186:187]
  v_pk_mul_f32 v[180:181], v[180:181], v[188:189]
  v_pk_mul_f32 v[182:183], v[182:183], v[190:191]
  v_cvt_pk_bf16_f32 v184, v176, v177
  v_cvt_pk_bf16_f32 v185, v178, v179
  v_cvt_pk_bf16_f32 v186, v180, v181
  v_cvt_pk_bf16_f32 v187, v182, v183
  buffer_store_dwordx4 v[184:187], v26, s[48:51], s66 offen offset:2560 sc1
  v_max_f32 v192, 0, v192
  v_max_f32 v193, 0, v193
  v_max_f32 v194, 0, v194
  v_max_f32 v195, 0, v195
  v_max_f32 v196, 0, v196
  v_max_f32 v197, 0, v197
  v_max_f32 v198, 0, v198
  v_max_f32 v199, 0, v199
  v_pk_mul_f32 v[192:193], v[192:193], v[200:201]
  v_pk_mul_f32 v[194:195], v[194:195], v[202:203]
  v_pk_mul_f32 v[196:197], v[196:197], v[204:205]
  v_pk_mul_f32 v[198:199], v[198:199], v[206:207]
  v_cvt_pk_bf16_f32 v200, v192, v193
  v_cvt_pk_bf16_f32 v201, v194, v195
  v_cvt_pk_bf16_f32 v202, v196, v197
  v_cvt_pk_bf16_f32 v203, v198, v199
  buffer_store_dwordx4 v[200:203], v26, s[48:51], s67 offen offset:0 sc1
  v_max_f32 v208, 0, v208
  v_max_f32 v209, 0, v209
  v_max_f32 v210, 0, v210
  v_max_f32 v211, 0, v211
  v_max_f32 v212, 0, v212
  v_max_f32 v213, 0, v213
  v_max_f32 v214, 0, v214
  v_max_f32 v215, 0, v215
  v_pk_mul_f32 v[208:209], v[208:209], v[216:217]
  v_pk_mul_f32 v[210:211], v[210:211], v[218:219]
  v_pk_mul_f32 v[212:213], v[212:213], v[220:221]
  v_pk_mul_f32 v[214:215], v[214:215], v[222:223]
  v_cvt_pk_bf16_f32 v216, v208, v209
  v_cvt_pk_bf16_f32 v217, v210, v211
  v_cvt_pk_bf16_f32 v218, v212, v213
  v_cvt_pk_bf16_f32 v219, v214, v215
  buffer_store_dwordx4 v[216:219], v26, s[48:51], s67 offen offset:2048 sc1
  v_max_f32 v224, 0, v224
  v_max_f32 v225, 0, v225
  v_max_f32 v226, 0, v226
  v_max_f32 v227, 0, v227
  v_max_f32 v228, 0, v228
  v_max_f32 v229, 0, v229
  v_max_f32 v230, 0, v230
  v_max_f32 v231, 0, v231
  v_pk_mul_f32 v[224:225], v[224:225], v[232:233]
  v_pk_mul_f32 v[226:227], v[226:227], v[234:235]
  v_pk_mul_f32 v[228:229], v[228:229], v[236:237]
  v_pk_mul_f32 v[230:231], v[230:231], v[238:239]
  v_cvt_pk_bf16_f32 v232, v224, v225
  v_cvt_pk_bf16_f32 v233, v226, v227
  v_cvt_pk_bf16_f32 v234, v228, v229
  v_cvt_pk_bf16_f32 v235, v230, v231
  buffer_store_dwordx4 v[232:235], v26, s[48:51], s67 offen offset:512 sc1
  v_max_f32 v240, 0, v240
  v_max_f32 v241, 0, v241
  v_max_f32 v242, 0, v242
  v_max_f32 v243, 0, v243
  v_max_f32 v244, 0, v244
  v_max_f32 v245, 0, v245
  v_max_f32 v246, 0, v246
  v_max_f32 v247, 0, v247
  v_pk_mul_f32 v[240:241], v[240:241], v[248:249]
  v_pk_mul_f32 v[242:243], v[242:243], v[250:251]
  v_pk_mul_f32 v[244:245], v[244:245], v[252:253]
  v_pk_mul_f32 v[246:247], v[246:247], v[254:255]
  v_cvt_pk_bf16_f32 v248, v240, v241
  v_cvt_pk_bf16_f32 v249, v242, v243
  v_cvt_pk_bf16_f32 v250, v244, v245
  v_cvt_pk_bf16_f32 v251, v246, v247
  buffer_store_dwordx4 v[248:251], v26, s[48:51], s67 offen offset:2560 sc1
  s_waitcnt lgkmcnt(0)
  v_pk_mul_f32 v[40:41], v[96:97], v[24:25] op_sel:[0,1] op_sel_hi:[1,1]
  v_pk_mul_f32 v[96:97], v[96:97], v[24:25] op_sel:[0,0] op_sel_hi:[1,0]
  v_pk_fma_f32 v[96:97], v[112:113], v[24:25], v[96:97] op_sel:[0,1,0] op_sel_hi:[1,1,1] neg_lo:[1,0,0] neg_hi:[1,0,0]
  v_pk_fma_f32 v[112:113], v[112:113], v[24:25], v[40:41] op_sel:[0,0,0] op_sel_hi:[1,0,1]
  v_pk_mul_f32 v[42:43], v[98:99], v[24:25] op_sel:[0,1] op_sel_hi:[1,1]
  v_pk_mul_f32 v[98:99], v[98:99], v[24:25] op_sel:[0,0] op_sel_hi:[1,0]
  v_pk_fma_f32 v[98:99], v[114:115], v[24:25], v[98:99] op_sel:[0,1,0] op_sel_hi:[1,1,1] neg_lo:[1,0,0] neg_hi:[1,0,0]
  v_pk_fma_f32 v[114:115], v[114:115], v[24:25], v[42:43] op_sel:[0,0,0] op_sel_hi:[1,0,1]
  v_pk_mul_f32 v[40:41], v[100:101], v[24:25] op_sel:[0,1] op_sel_hi:[1,1]
  v_pk_mul_f32 v[100:101], v[100:101], v[24:25] op_sel:[0,0] op_sel_hi:[1,0]
  v_pk_fma_f32 v[100:101], v[116:117], v[24:25], v[100:101] op_sel:[0,1,0] op_sel_hi:[1,1,1] neg_lo:[1,0,0] neg_hi:[1,0,0]
  v_pk_fma_f32 v[116:117], v[116:117], v[24:25], v[40:41] op_sel:[0,0,0] op_sel_hi:[1,0,1]
  v_pk_mul_f32 v[42:43], v[102:103], v[24:25] op_sel:[0,1] op_sel_hi:[1,1]
  v_pk_mul_f32 v[102:103], v[102:103], v[24:25] op_sel:[0,0] op_sel_hi:[1,0]
  v_pk_fma_f32 v[102:103], v[118:119], v[24:25], v[102:103] op_sel:[0,1,0] op_sel_hi:[1,1,1] neg_lo:[1,0,0] neg_hi:[1,0,0]
  v_pk_fma_f32 v[118:119], v[118:119], v[24:25], v[42:43] op_sel:[0,0,0] op_sel_hi:[1,0,1]
  v_pk_mul_f32 v[40:41], v[104:105], v[24:25] op_sel:[0,1] op_sel_hi:[1,1]
  v_pk_mul_f32 v[104:105], v[104:105], v[24:25] op_sel:[0,0] op_sel_hi:[1,0]
  v_pk_fma_f32 v[104:105], v[120:121], v[24:25], v[104:105] op_sel:[0,1,0] op_sel_hi:[1,1,1] neg_lo:[1,0,0] neg_hi:[1,0,0]
  v_pk_fma_f32 v[120:121], v[120:121], v[24:25], v[40:41] op_sel:[0,0,0] op_sel_hi:[1,0,1]
  v_pk_mul_f32 v[42:43], v[106:107], v[24:25] op_sel:[0,1] op_sel_hi:[1,1]
  v_pk_mul_f32 v[106:107], v[106:107], v[24:25] op_sel:[0,0] op_sel_hi:[1,0]
  v_pk_fma_f32 v[106:107], v[122:123], v[24:25], v[106:107] op_sel:[0,1,0] op_sel_hi:[1,1,1] neg_lo:[1,0,0] neg_hi:[1,0,0]
  v_pk_fma_f32 v[122:123], v[122:123], v[24:25], v[42:43] op_sel:[0,0,0] op_sel_hi:[1,0,1]
  v_pk_mul_f32 v[40:41], v[108:109], v[24:25] op_sel:[0,1] op_sel_hi:[1,1]
  v_pk_mul_f32 v[108:109], v[108:109], v[24:25] op_sel:[0,0] op_sel_hi:[1,0]
  v_pk_fma_f32 v[108:109], v[124:125], v[24:25], v[108:109] op_sel:[0,1,0] op_sel_hi:[1,1,1] neg_lo:[1,0,0] neg_hi:[1,0,0]
  v_pk_fma_f32 v[124:125], v[124:125], v[24:25], v[40:41] op_sel:[0,0,0] op_sel_hi:[1,0,1]
  v_pk_mul_f32 v[42:43], v[110:111], v[24:25] op_sel:[0,1] op_sel_hi:[1,1]
  v_pk_mul_f32 v[110:111], v[110:111], v[24:25] op_sel:[0,0] op_sel_hi:[1,0]
  v_pk_fma_f32 v[110:111], v[126:127], v[24:25], v[110:111] op_sel:[0,1,0] op_sel_hi:[1,1,1] neg_lo:[1,0,0] neg_hi:[1,0,0]
  v_pk_fma_f32 v[126:127], v[126:127], v[24:25], v[42:43] op_sel:[0,0,0] op_sel_hi:[1,0,1]
  v_mov_b32 v128, v14
  v_mov_b32 v144, v15
  v_fma_f32 v97, v14, v96, v97
  v_mul_f32 v129, v14, v128
  v_fma_f32 v113, v14, v112, v113
  v_mul_f32 v145, v14, v144
  v_fma_f32 v97, -v15, v112, v97
  v_fma_f32 v129, -v15, v144, v129
  v_fma_f32 v113, v15, v96, v113
  v_fma_f32 v145, v15, v128, v145
  v_fma_f32 v98, v14, v97, v98
  v_mul_f32 v130, v14, v129
  v_fma_f32 v114, v14, v113, v114
  v_mul_f32 v146, v14, v145
  v_fma_f32 v98, -v15, v113, v98
  v_fma_f32 v130, -v15, v145, v130
  v_fma_f32 v114, v15, v97, v114
  v_fma_f32 v146, v15, v129, v146
  v_fma_f32 v99, v14, v98, v99
  v_mul_f32 v131, v14, v130
  v_fma_f32 v115, v14, v114, v115
  v_mul_f32 v147, v14, v146
  v_fma_f32 v99, -v15, v114, v99
  v_fma_f32 v131, -v15, v146, v131
  v_fma_f32 v115, v15, v98, v115
  v_fma_f32 v147, v15, v130, v147
  v_fma_f32 v100, v14, v99, v100
  v_mul_f32 v132, v14, v131
  v_fma_f32 v116, v14, v115, v116
  v_mul_f32 v148, v14, v147
  v_fma_f32 v100, -v15, v115, v100
  v_fma_f32 v132, -v15, v147, v132
  v_fma_f32 v116, v15, v99, v116
  v_fma_f32 v148, v15, v131, v148
  v_fma_f32 v101, v14, v100, v101
  v_mul_f32 v133, v14, v132
  v_fma_f32 v117, v14, v116, v117
  v_mul_f32 v149, v14, v148
  v_fma_f32 v101, -v15, v116, v101
  v_fma_f32 v133, -v15, v148, v133
  v_fma_f32 v117, v15, v100, v117
  v_fma_f32 v149, v15, v132, v149
  v_fma_f32 v102, v14, v101, v102
  v_mul_f32 v134, v14, v133
  v_fma_f32 v118, v14, v117, v118
  v_mul_f32 v150, v14, v149
  v_fma_f32 v102, -v15, v117, v102
  v_fma_f32 v134, -v15, v149, v134
  v_fma_f32 v118, v15, v101, v118
  v_fma_f32 v150, v15, v133, v150
  v_fma_f32 v103, v14, v102, v103
  v_mul_f32 v135, v14, v134
  v_fma_f32 v119, v14, v118, v119
  v_mul_f32 v151, v14, v150
  v_fma_f32 v103, -v15, v118, v103
  v_fma_f32 v135, -v15, v150, v135
  v_fma_f32 v119, v15, v102, v119
  v_fma_f32 v151, v15, v134, v151
  v_fma_f32 v104, v14, v103, v104
  v_mul_f32 v136, v14, v135
  v_fma_f32 v120, v14, v119, v120
  v_mul_f32 v152, v14, v151
  v_fma_f32 v104, -v15, v119, v104
  v_fma_f32 v136, -v15, v151, v136
  v_fma_f32 v120, v15, v103, v120
  v_fma_f32 v152, v15, v135, v152
  v_fma_f32 v105, v14, v104, v105
  v_mul_f32 v137, v14, v136
  v_fma_f32 v121, v14, v120, v121
  v_mul_f32 v153, v14, v152
  v_fma_f32 v105, -v15, v120, v105
  v_fma_f32 v137, -v15, v152, v137
  v_fma_f32 v121, v15, v104, v121
  v_fma_f32 v153, v15, v136, v153
  v_fma_f32 v106, v14, v105, v106
  v_mul_f32 v138, v14, v137
  v_fma_f32 v122, v14, v121, v122
  v_mul_f32 v154, v14, v153
  v_fma_f32 v106, -v15, v121, v106
  v_fma_f32 v138, -v15, v153, v138
  v_fma_f32 v122, v15, v105, v122
  v_fma_f32 v154, v15, v137, v154
  v_fma_f32 v107, v14, v106, v107
  v_mul_f32 v139, v14, v138
  v_fma_f32 v123, v14, v122, v123
  v_mul_f32 v155, v14, v154
  v_fma_f32 v107, -v15, v122, v107
  v_fma_f32 v139, -v15, v154, v139
  v_fma_f32 v123, v15, v106, v123
  v_fma_f32 v155, v15, v138, v155
  v_fma_f32 v108, v14, v107, v108
  v_mul_f32 v140, v14, v139
  v_fma_f32 v124, v14, v123, v124
  v_mul_f32 v156, v14, v155
  v_fma_f32 v108, -v15, v123, v108
  v_fma_f32 v140, -v15, v155, v140
  v_fma_f32 v124, v15, v107, v124
  v_fma_f32 v156, v15, v139, v156
  v_fma_f32 v109, v14, v108, v109
  v_mul_f32 v141, v14, v140
  v_fma_f32 v125, v14, v124, v125
  v_mul_f32 v157, v14, v156
  v_fma_f32 v109, -v15, v124, v109
  v_fma_f32 v141, -v15, v156, v141
  v_fma_f32 v125, v15, v108, v125
  v_fma_f32 v157, v15, v140, v157
  v_fma_f32 v110, v14, v109, v110
  v_mul_f32 v142, v14, v141
  v_fma_f32 v126, v14, v125, v126
  v_mul_f32 v158, v14, v157
  v_fma_f32 v110, -v15, v125, v110
  v_fma_f32 v142, -v15, v157, v142
  v_fma_f32 v126, v15, v109, v126
  v_fma_f32 v158, v15, v141, v158
  v_fma_f32 v111, v14, v110, v111
  v_mul_f32 v143, v14, v142
  v_fma_f32 v127, v14, v126, v127
  v_mul_f32 v159, v14, v158
  v_fma_f32 v111, -v15, v126, v111
  v_fma_f32 v143, -v15, v158, v143
  v_fma_f32 v127, v15, v110, v127
  v_fma_f32 v159, v15, v142, v159
  v_mov_b32 v38, s6
  s_waitcnt vmcnt(0)
  s_mov_b64 exec, 1
  buffer_store_dword v38, off, s[48:51], s94 sc1
  s_mov_b64 exec, -1
  v_mov_b32 v36, 20971520
  v_cndmask_b32 v38, v36, v37, s[16:17]
  buffer_load_dwordx4 v[44:47], v38, s[48:51], 0 offen offset:0 sc1
  v_cndmask_b32 v39, v36, v37, s[18:19]
  buffer_load_dwordx4 v[48:51], v39, s[48:51], 0 offen offset:256 sc1
  v_cndmask_b32 v38, v36, v37, s[20:21]
  buffer_load_dwordx4 v[52:55], v38, s[48:51], 0 offen offset:512 sc1
  v_cndmask_b32 v39, v36, v37, s[22:23]
  buffer_load_dwordx4 v[56:59], v39, s[48:51], 0 offen offset:768 sc1
  v_cndmask_b32 v38, v36, v37, s[24:25]
  buffer_load_dwordx4 v[60:63], v38, s[48:51], 0 offen offset:1024 sc1
  v_cndmask_b32 v39, v36, v37, s[26:27]
  buffer_load_dwordx4 v[64:67], v39, s[48:51], 0 offen offset:1280 sc1
  v_cndmask_b32 v38, v36, v37, s[28:29]
  buffer_load_dwordx4 v[68:71], v38, s[48:51], 0 offen offset:1536 sc1
  v_cndmask_b32 v39, v36, v37, s[30:31]
  buffer_load_dwordx4 v[72:75], v39, s[48:51], 0 offen offset:1792 sc1
  s_add_u32 s91, s88, 102400
  s_add_u32 m0, s90, 4096
  s_add_u32 s68, s91, 0
  buffer_load_dwordx4 v27, s[48:51], s68 offen sc1 lds
  s_add_u32 m0, s90, 5120
  s_add_u32 s68, s91, 1024
  buffer_load_dwordx4 v27, s[48:51], s68 offen sc1 lds
  s_add_u32 m0, s90, 6144
  s_add_u32 s68, s91, 2048
  buffer_load_dwordx4 v27, s[48:51], s68 offen sc1 lds
  s_add_u32 m0, s90, 7168
  s_add_u32 s68, s91, 3072
  buffer_load_dwordx4 v27, s[48:51], s68 offen sc1 lds
  s_add_u32 m0, s90, 8192
  s_add_u32 s68, s91, 4096
  buffer_load_dwordx4 v27, s[48:51], s68 offen sc1 lds
  s_add_u32 s91, s88, 143360
  s_add_u32 m0, s90, 9216
  s_add_u32 s68, s91, 0
  buffer_load_dwordx4 v27, s[48:51], s68 offen sc1 lds
  s_add_u32 m0, s90, 10240
  s_add_u32 s68, s91, 1024
  buffer_load_dwordx4 v27, s[48:51], s68 offen sc1 lds
  s_add_u32 m0, s90, 11264
  s_add_u32 s68, s91, 2048
  buffer_load_dwordx4 v27, s[48:51], s68 offen sc1 lds
  s_add_u32 m0, s90, 12288
  s_add_u32 s68, s91, 3072
  buffer_load_dwordx4 v27, s[48:51], s68 offen sc1 lds
  s_add_u32 m0, s90, 13312
  s_add_u32 s68, s91, 4096
  buffer_load_dwordx4 v27, s[48:51], s68 offen sc1 lds
  s_mov_b32 s77, 0
  s_waitcnt vmcnt(10)
  s_branch Ca_POLL1
Ca_POLL:
  s_sleep 8
  v_mov_b32 v36, 20971520
  v_cndmask_b32 v38, v36, v37, s[16:17]
  buffer_load_dwordx4 v[44:47], v38, s[48:51], 0 offen offset:0 sc1
  v_cndmask_b32 v39, v36, v37, s[18:19]
  buffer_load_dwordx4 v[48:51], v39, s[48:51], 0 offen offset:256 sc1
  v_cndmask_b32 v38, v36, v37, s[20:21]
  buffer_load_dwordx4 v[52:55], v38, s[48:51], 0 offen offset:512 sc1
  v_cndmask_b32 v39, v36, v37, s[22:23]
  buffer_load_dwordx4 v[56:59], v39, s[48:51], 0 offen offset:768 sc1
  v_cndmask_b32 v38, v36, v37, s[24:25]
  buffer_load_dwordx4 v[60:63], v38, s[48:51], 0 offen offset:1024 sc1
  v_cndmask_b32 v39, v36, v37, s[26:27]
  buffer_load_dwordx4 v[64:67], v39, s[48:51], 0 offen offset:1280 sc1
  v_cndmask_b32 v38, v36, v37, s[28:29]
  buffer_load_dwordx4 v[68:71], v38, s[48:51], 0 offen offset:1536 sc1
  v_cndmask_b32 v39, v36, v37, s[30:31]
  buffer_load_dwordx4 v[72:75], v39, s[48:51], 0 offen offset:1792 sc1
  s_waitcnt vmcnt(0)
Ca_POLL1:
  v_mov_b32 v1, s6
  v_mov_b32 v36, s6
  v_mov_b32 v39, s6
  v_cndmask_b32 v45, v39, v45, s[16:17]
  v_cndmask_b32 v47, v39, v47, s[16:17]
  v_min3_u32 v1, v1, v45, v47
  v_max3_u32 v36, v36, v45, v47
  v_cndmask_b32 v49, v39, v49, s[18:19]
  v_cndmask_b32 v51, v39, v51, s[18:19]
  v_min3_u32 v1, v1, v49, v51
  v_max3_u32 v36, v36, v49, v51
  v_cndmask_b32 v53, v39, v53, s[20:21]
  v_cndmask_b32 v55, v39, v55, s[20:21]
  v_min3_u32 v1, v1, v53, v55
  v_max3_u32 v36, v36, v53, v55
  v_cndmask_b32 v57, v39, v57, s[22:23]
  v_cndmask_b32 v59, v39, v59, s[22:23]
  v_min3_u32 v1, v1, v57, v59
  v_max3_u32 v36, v36, v57, v59
  v_cndmask_b32 v61, v39, v61, s[24:25]
  v_cndmask_b32 v63, v39, v63, s[24:25]
  v_min3_u32 v1, v1, v61, v63
  v_max3_u32 v36, v36, v61, v63
  v_cndmask_b32 v65, v39, v65, s[26:27]
  v_cndmask_b32 v67, v39, v67, s[26:27]
  v_min3_u32 v1, v1, v65, v67
  v_max3_u32 v36, v36, v65, v67
  v_cndmask_b32 v69, v39, v69, s[28:29]
  v_cndmask_b32 v71, v39, v71, s[28:29]
  v_min3_u32 v1, v1, v69, v71
  v_max3_u32 v36, v36, v69, v71
  v_cndmask_b32 v73, v39, v73, s[30:31]
  v_cndmask_b32 v75, v39, v75, s[30:31]
  v_min3_u32 v1, v1, v73, v75
  v_max3_u32 v36, v36, v73, v75
  v_cmp_ne_u32 vcc, v36, v1
  s_add_u32 s77, s77, 1
  s_cmp_lt_u32 s77, 20000
  s_cselect_b64 s[12:13], -1, 0
  s_nop 1
  s_and_b64 vcc, vcc, s[12:13]
  s_cbranch_scc1 Ca_POLL
  v_and_b32 v4, 31, v0
  v_lshlrev_b32 v4, 4, v4
  s_lshl_b32 s10, s86, 9
  s_add_u32 s10, s10, 17956864
  v_mov_b32 v5, s6
  s_cmp_eq_u32 s7, 0
  s_cbranch_scc0 Ca_G0
  buffer_load_dword v5, v4, s[48:51], s10 offen sc1
Ca_G0:
  v_fma_f32 v48, v18, v44, v48
  v_fma_f32 v50, v18, v46, v50
  v_fma_f32 v48, -v19, v46, v48
  v_fma_f32 v50, v19, v44, v50
  v_fma_f32 v52, v18, v48, v52
  v_fma_f32 v54, v18, v50, v54
  v_fma_f32 v52, -v19, v50, v52
  v_fma_f32 v54, v19, v48, v54
  v_fma_f32 v56, v18, v52, v56
  v_fma_f32 v58, v18, v54, v58
  v_fma_f32 v56, -v19, v54, v56
  v_fma_f32 v58, v19, v52, v58
  v_fma_f32 v60, v18, v56, v60
  v_fma_f32 v62, v18, v58, v62
  v_fma_f32 v60, -v19, v58, v60
  v_fma_f32 v62, v19, v56, v62
  v_fma_f32 v64, v18, v60, v64
  v_fma_f32 v66, v18, v62, v66
  v_fma_f32 v64, -v19, v62, v64
  v_fma_f32 v66, v19, v60, v66
  v_fma_f32 v68, v18, v64, v68
  v_fma_f32 v70, v18, v66, v70
  v_fma_f32 v68, -v19, v66, v68
  v_fma_f32 v70, v19, v64, v70
  v_fma_f32 v72, v18, v68, v72
  v_fma_f32 v74, v18, v70, v74
  v_fma_f32 v72, -v19, v70, v72
  v_fma_f32 v74, v19, v68, v74
  v_mul_f32 v40, v20, v72
  v_mul_f32 v41, v20, v74
  v_fma_f32 v40, -v21, v74, v40
  v_fma_f32 v41, v21, v72, v41
  v_mov_b32 v42, v40
  v_mov_b32 v43, v41
  s_nop 1
  v_permlane16_swap_b32 v40, v42
  v_permlane16_swap_b32 v41, v43
  s_nop 1
  v_add_f32 v40, v40, v42
  v_add_f32 v41, v41, v43
  v_mov_b32 v42, v40
  v_mov_b32 v43, v41
  s_nop 1
  v_permlane32_swap_b32 v40, v42
  v_permlane32_swap_b32 v41, v43
  s_nop 1
  v_add_f32 v40, v40, v42
  v_add_f32 v41, v41, v43
  v_fma_f32 v42, v22, v40, v32
  v_fma_f32 v43, v22, v41, v33
  v_fma_f32 v42, -v23, v41, v42
  v_fma_f32 v43, v23, v40, v43
  v_mul_f32 v40, v24, v42
  v_mul_f32 v41, v24, v43
  v_fma_f32 v40, -v25, v43, v40
  v_fma_f32 v41, v25, v42, v41
  v_pk_fma_f32 v[96:97], v[128:129], v[40:41], v[96:97] op_sel:[0,0,0] op_sel_hi:[1,0,1]
  v_pk_fma_f32 v[112:113], v[128:129], v[40:41], v[112:113] op_sel:[0,1,0] op_sel_hi:[1,1,1]
  v_pk_fma_f32 v[96:97], v[144:145], v[40:41], v[96:97] op_sel:[0,1,0] op_sel_hi:[1,1,1] neg_lo:[1,0,0] neg_hi:[1,0,0]
  v_pk_fma_f32 v[112:113], v[144:145], v[40:41], v[112:113] op_sel:[0,0,0] op_sel_hi:[1,0,1]
  v_pk_fma_f32 v[98:99], v[130:131], v[40:41], v[98:99] op_sel:[0,0,0] op_sel_hi:[1,0,1]
  v_pk_fma_f32 v[114:115], v[130:131], v[40:41], v[114:115] op_sel:[0,1,0] op_sel_hi:[1,1,1]
  v_pk_fma_f32 v[98:99], v[146:147], v[40:41], v[98:99] op_sel:[0,1,0] op_sel_hi:[1,1,1] neg_lo:[1,0,0] neg_hi:[1,0,0]
  v_pk_fma_f32 v[114:115], v[146:147], v[40:41], v[114:115] op_sel:[0,0,0] op_sel_hi:[1,0,1]
  v_pk_fma_f32 v[100:101], v[132:133], v[40:41], v[100:101] op_sel:[0,0,0] op_sel_hi:[1,0,1]
  v_pk_fma_f32 v[116:117], v[132:133], v[40:41], v[116:117] op_sel:[0,1,0] op_sel_hi:[1,1,1]
  v_pk_fma_f32 v[100:101], v[148:149], v[40:41], v[100:101] op_sel:[0,1,0] op_sel_hi:[1,1,1] neg_lo:[1,0,0] neg_hi:[1,0,0]
  v_pk_fma_f32 v[116:117], v[148:149], v[40:41], v[116:117] op_sel:[0,0,0] op_sel_hi:[1,0,1]
  v_pk_fma_f32 v[102:103], v[134:135], v[40:41], v[102:103] op_sel:[0,0,0] op_sel_hi:[1,0,1]
  v_pk_fma_f32 v[118:119], v[134:135], v[40:41], v[118:119] op_sel:[0,1,0] op_sel_hi:[1,1,1]
  v_pk_fma_f32 v[102:103], v[150:151], v[40:41], v[102:103] op_sel:[0,1,0] op_sel_hi:[1,1,1] neg_lo:[1,0,0] neg_hi:[1,0,0]
  v_pk_fma_f32 v[118:119], v[150:151], v[40:41], v[118:119] op_sel:[0,0,0] op_sel_hi:[1,0,1]
  v_pk_fma_f32 v[104:105], v[136:137], v[40:41], v[104:105] op_sel:[0,0,0] op_sel_hi:[1,0,1]
  v_pk_fma_f32 v[120:121], v[136:137], v[40:41], v[120:121] op_sel:[0,1,0] op_sel_hi:[1,1,1]
  v_pk_fma_f32 v[104:105], v[152:153], v[40:41], v[104:105] op_sel:[0,1,0] op_sel_hi:[1,1,1] neg_lo:[1,0,0] neg_hi:[1,0,0]
  v_pk_fma_f32 v[120:121], v[152:153], v[40:41], v[120:121] op_sel:[0,0,0] op_sel_hi:[1,0,1]
  v_pk_fma_f32 v[106:107], v[138:139], v[40:41], v[106:107] op_sel:[0,0,0] op_sel_hi:[1,0,1]
  v_pk_fma_f32 v[122:123], v[138:139], v[40:41], v[122:123] op_sel:[0,1,0] op_sel_hi:[1,1,1]
  v_pk_fma_f32 v[106:107], v[154:155], v[40:41], v[106:107] op_sel:[0,1,0] op_sel_hi:[1,1,1] neg_lo:[1,0,0] neg_hi:[1,0,0]
  v_pk_fma_f32 v[122:123], v[154:155], v[40:41], v[122:123] op_sel:[0,0,0] op_sel_hi:[1,0,1]
  v_pk_fma_f32 v[108:109], v[140:141], v[40:41], v[108:109] op_sel:[0,0,0] op_sel_hi:[1,0,1]
  v_pk_fma_f32 v[124:125], v[140:141], v[40:41], v[124:125] op_sel:[0,1,0] op_sel_hi:[1,1,1]
  v_pk_fma_f32 v[108:109], v[156:157], v[40:41], v[108:109] op_sel:[0,1,0] op_sel_hi:[1,1,1] neg_lo:[1,0,0] neg_hi:[1,0,0]
  v_pk_fma_f32 v[124:125], v[156:157], v[40:41], v[124:125] op_sel:[0,0,0] op_sel_hi:[1,0,1]
  v_pk_fma_f32 v[110:111], v[142:143], v[40:41], v[110:111] op_sel:[0,0,0] op_sel_hi:[1,0,1]
  v_pk_fma_f32 v[126:127], v[142:143], v[40:41], v[126:127] op_sel:[0,1,0] op_sel_hi:[1,1,1]
  v_pk_fma_f32 v[110:111], v[158:159], v[40:41], v[110:111] op_sel:[0,1,0] op_sel_hi:[1,1,1] neg_lo:[1,0,0] neg_hi:[1,0,0]
  v_pk_fma_f32 v[126:127], v[158:159], v[40:41], v[126:127] op_sel:[0,0,0] op_sel_hi:[1,0,1]
  v_cvt_pk_bf16_f32 v44, v96, v97
  v_cvt_pk_bf16_f32 v52, -v112, -v113
  v_cvt_pk_bf16_f32 v45, v98, v99
  v_cvt_pk_bf16_f32 v53, -v114, -v115
  v_cvt_pk_bf16_f32 v46, v100, v101
  v_cvt_pk_bf16_f32 v54, -v116, -v117
  v_cvt_pk_bf16_f32 v47, v102, v103
  v_cvt_pk_bf16_f32 v55, -v118, -v119
  v_cvt_pk_bf16_f32 v48, v104, v105
  v_cvt_pk_bf16_f32 v56, -v120, -v121
  v_cvt_pk_bf16_f32 v49, v106, v107
  v_cvt_pk_bf16_f32 v57, -v122, -v123
  v_cvt_pk_bf16_f32 v50, v108, v109
  v_cvt_pk_bf16_f32 v58, -v124, -v125
  v_cvt_pk_bf16_f32 v51, v110, v111
  v_cvt_pk_bf16_f32 v59, -v126, -v127
  ds_write_b128 v34, v[44:47] offset:0
  ds_write_b128 v34, v[48:51] offset:16
  ds_write_b128 v34, v[52:55] offset:2048
  ds_write_b128 v34, v[56:59] offset:2064
  s_add_u32 s12, s8, 0
  s_lshl_b32 s12, s12, 12
  s_add_u32 s12, s12, s81
  s_waitcnt lgkmcnt(0)
  ds_read_b64_tr_b16 v[96:97], v35 offset:0
  ds_read_b64_tr_b16 v[98:99], v35 offset:128
  ds_read_b64_tr_b16 v[100:101], v35 offset:16
  ds_read_b64_tr_b16 v[102:103], v35 offset:144
  ds_read_b64_tr_b16 v[104:105], v35 offset:512
  ds_read_b64_tr_b16 v[106:107], v35 offset:640
  ds_read_b64_tr_b16 v[108:109], v35 offset:528
  ds_read_b64_tr_b16 v[110:111], v35 offset:656
  s_waitcnt lgkmcnt(6)
  buffer_store_dwordx4 v[96:99], v27, s[48:51], s12 offen offset:0 sc1
  s_waitcnt lgkmcnt(4)
  buffer_store_dwordx4 v[100:103], v27, s[48:51], s12 offen offset:1024 sc1
  s_waitcnt lgkmcnt(2)
  buffer_store_dwordx4 v[104:107], v27, s[48:51], s12 offen offset:2048 sc1
  s_waitcnt lgkmcnt(0)
  buffer_store_dwordx4 v[108:111], v27, s[48:51], s12 offen offset:3072 sc1
  s_waitcnt vmcnt(4)
  v_cmp_ne_u32 vcc, s6, v5
  s_nop 4
  s_cbranch_vccz Ca_G1
  s_mov_b32 s85, 0
  s_branch Ca_GP_1
Ca_GP:
  s_sleep 16
Ca_GP_1:
  buffer_load_dword v5, v4, s[48:51], s10 offen sc1
  s_waitcnt vmcnt(0)
  v_xor_b32 v5, s6, v5
  v_cmp_ne_u32 vcc, 0, v5
  s_add_u32 s85, s85, 1
  s_cmp_lt_u32 s85, 20000
  s_cselect_b64 s[12:13], -1, 0
  s_nop 1
  s_and_b64 vcc, vcc, s[12:13]
  s_cbranch_scc1 Ca_GP
Ca_G1:
  s_barrier
  v_mov_b32 v1, s6
  s_add_u32 s94, s94, 131072
  s_waitcnt vmcnt(0)
  s_mov_b64 exec, 1
  buffer_store_dword v1, off, s[48:51], s94 sc1
  s_lshl_b32 s12, s4, 5
  s_add_u32 s12, s12, s80
  s_cmp_eq_u32 s12, 31
  s_cbranch_scc0 Ca_END
  s_mov_b32 s12, 17825792
  buffer_store_dword v1, off, s[48:51], s12 sc1
Ca_END:
  s_mov_b64 exec, -1
  s_branch P2_C
K1_B:
  s_lshl_b32 s10, s4, 1
  s_sub_u32 s8, s10, 23
  s_min_u32 s8, s8, 38
  s_add_u32 s9, s10, 46
  s_min_u32 s9, s9, 106
  s_cmp_ge_u32 s5, 4
  s_cbranch_scc1 K1_HB
  s_mov_b32 s7, s5
  s_mov_b32 s56, s18
  s_and_b32 s57, s19, 0xffff
  s_mov_b32 s58, 1280
  s_mov_b32 s59, 0x20000
  s_mov_b32 s60, s20
  s_and_b32 s61, s21, 0xffff
  s_mov_b32 s62, 1280
  s_mov_b32 s63, 0x20000
  s_mov_b32 s64, s30
  s_and_b32 s65, s31, 0xffff
  s_mov_b32 s66, 1280
  s_mov_b32 s67, 0x20000
  v_and_b32 v1, 15, v0
  s_add_u32 s12, s8, 0
  s_lshl_b32 s12, s12, 5
  v_lshlrev_b32 v1, 1, v1
  buffer_load_ushort v40, v1, s[56:59], s12 offen
  buffer_load_ushort v41, v1, s[60:63], s12 offen
  buffer_load_ushort v42, v1, s[64:67], s12 offen
  v_and_b32 v1, 15, v0
  s_add_u32 s12, s8, 1
  s_lshl_b32 s12, s12, 5
  v_lshlrev_b32 v1, 1, v1
  buffer_load_ushort v44, v1, s[56:59], s12 offen
  buffer_load_ushort v45, v1, s[60:63], s12 offen
  buffer_load_ushort v46, v1, s[64:67], s12 offen
  s_and_b32 s10, s2, 7
  s_lshr_b32 s11, s2, 3
  s_lshl_b32 s86, s10, 2
  s_and_b32 s12, s11, 3
  s_add_u32 s86, s86, s12
  s_lshr_b32 s87, s11, 2
  s_mul_i32 s89, s86, 94
  s_add_u32 s89, s89, s7
  s_add_u32 s89, s89, 0
  s_lshl_b32 s89, s89, 12
  s_mul_i32 s88, s87, 94
  s_add_u32 s88, s88, s7
  s_add_u32 s88, s88, 0
  s_mul_i32 s88, s88, 5120
  s_add_u32 s88, s88, 12582912
  s_mul_i32 s90, s7, 17408
  s_cmp_eq_u32 s7, 3
  s_cselect_b32 s90, 145408, s90
  s_mul_i32 s99, s87, 0
  s_lshr_b32 s99, s99, 3
  s_and_b32 s12, s86, 3
  s_mul_i32 s12, s12, 0
  s_add_u32 s99, s99, s12
  s_cmp_ge_u32 s99, 10
  s_cselect_b32 s12, 10, 0
  s_sub_u32 s99, s99, s12
  s_getpc_b64 s[12:13]
Cb_PC:
  s_lshr_b32 s10, s2, 3
  s_lshl_b32 s10, s10, 2
  s_add_u32 s10, s10, s7
  s_lshl_b32 s10, s10, 9
  v_lshl_add_u32 v100, v0, 7, s10
  v_min_u32 v100, K1_END-K1_BEG, v100
  s_sub_u32 s12, s12, Cb_PC-K1_BEG
  s_subb_u32 s13, s13, 0
  v_mov_b32 v101, s13
  v_add_co_u32 v100, vcc, s12, v100
  s_nop 1
  v_addc_co_u32 v101, vcc, 0, v101, vcc
  s_mov_b64 exec, 15
  global_load_dword v102, v[100:101], off
  s_mov_b64 exec, -1
  v_and_b32 v36, 31, v0
  v_lshrrev_b32 v37, 5, v0
  v_bfe_u32 v38, v0, 1, 3
  v_xor_b32 v38, v38, v37
  v_lshlrev_b32 v36, 7, v36
  v_xor_b32 v39, 0, v38
  v_lshl_add_u32 v6, v39, 4, v36
  v_xor_b32 v39, 2, v38
  v_lshl_add_u32 v7, v39, 4, v36
  v_xor_b32 v39, 4, v38
  v_lshl_add_u32 v8, v39, 4, v36
  v_xor_b32 v39, 6, v38
  v_lshl_add_u32 v9, v39, 4, v36
  v_bfe_u32 v36, v0, 2, 2
  v_lshl_add_u32 v36, v37, 3, v36
  v_lshlrev_b32 v36, 6, v36
  v_bfe_u32 v38, v0, 4, 1
  v_lshl_add_u32 v36, v38, 12, v36
  v_bfe_u32 v39, v0, 1, 1
  v_lshl_add_u32 v36, v39, 3, v36
  v_add_u32 v36, 40960, v36
  v_and_b32 v39, 1, v0
  v_lshlrev_b32 v38, 1, v38
  v_xor_b32 v38, v38, v39
  v_xor_b32 v39, 0, v38
  v_lshl_add_u32 v10, v39, 4, v36
  v_xor_b32 v39, 2, v38
  v_lshl_add_u32 v11, v39, 4, v36
  s_lshl_b32 s12, s5, 13
  v_add_u32 v2, s12, v6
  v_add_u32 v6, 32768, v6
  v_add_u32 v3, s12, v7
  v_add_u32 v7, 32768, v7
  v_add_u32 v4, s12, v8
  v_add_u32 v8, 32768, v8
  v_add_u32 v5, s12, v9
  v_add_u32 v9, 32768, v9
  v_and_b32 v36, 31, v0
  v_lshlrev_b32 v36, 4, v36
  v_add_u32 v30, 57856, v36
  s_lshl_b32 s12, s5, 10
  s_add_u32 s12, s12, 53248
  v_add_u32 v28, s12, v36
  v_add_u32 v29, 512, v28
  v_cmp_gt_u32 vcc, 32, v0
  v_mov_b32 v37, 57344
  v_lshrrev_b32 v38, 4, v0
  v_cndmask_b32 v28, v37, v28, vcc
  v_cndmask_b32 v29, v37, v29, vcc
  s_lshl_b32 s12, s5, 8
  s_add_u32 s12, s12, 61440
  v_lshl_add_u32 v31, v38, 6, s12
  v_lshlrev_b32 v27, 4, v0
  v_bfe_u32 v36, v0, 4, 1
  v_lshlrev_b32 v26, 10, v36
  v_lshrrev_b32 v36, 5, v0
  v_lshl_add_u32 v26, v36, 8, v26
  v_and_b32 v36, 15, v0
  v_lshl_add_u32 v26, v36, 4, v26
  s_mov_b32 s70, 0xffff0000
  s_mov_b32 s71, -1
  s_mov_b32 s72, 0
  s_mov_b32 s73, -1
  s_mov_b32 s74, 0
  s_mov_b32 s75, 0xffff0000
  s_mov_b32 s76, 0x3fb8aa3b
  s_waitcnt vmcnt(0)
  v_lshlrev_b32 v40, 16, v40
  v_lshlrev_b32 v41, 16, v41
  v_lshlrev_b32 v42, 16, v42
  v_mul_f32 v42, s76, v42
  v_exp_f32 v42, v42
  s_nop 0
  v_cvt_pk_bf16_f32 v42, v42, v42
  v_lshlrev_b32 v42, 16, v42
  v_mul_f32 v48, v42, v40
  v_mul_f32 v49, v42, v41
  v_mul_f32 v48, s76, v48
  v_mul_f32 v49, 0.15915494, v49
  v_exp_f32 v48, v48
  v_rndne_f32 v50, v49
  v_sub_f32 v49, v49, v50
  v_cos_f32 v50, v49
  v_sin_f32 v51, v49
  v_mul_f32 v52, v40, v40
  v_mul_f32 v14, v48, v50
  v_mul_f32 v15, v48, v51
  v_fma_f32 v52, v41, v41, v52
  v_rcp_f32 v52, v52
  v_add_f32 v48, -1.0, v14
  v_add_f32 v52, v52, v52
  v_mul_f32 v50, v40, v52
  v_mul_f32 v51, -v41, v52
  v_mul_f32 v24, v48, v50
  v_mul_f32 v25, v48, v51
  v_fma_f32 v24, -v15, v51, v24
  v_fma_f32 v25, v15, v50, v25
  v_mul_f32 v54, v14, v14
  v_mul_f32 v55, v14, v15
  v_fma_f32 v54, -v15, v15, v54
  v_fma_f32 v55, v15, v14, v55
  v_mul_f32 v56, v54, v54
  v_mul_f32 v57, v54, v55
  v_fma_f32 v56, -v55, v55, v56
  v_fma_f32 v57, v55, v54, v57
  v_mul_f32 v58, v56, v56
  v_mul_f32 v59, v56, v57
  v_fma_f32 v58, -v57, v57, v58
  v_fma_f32 v59, v57, v56, v59
  v_mul_f32 v16, v58, v58
  v_mul_f32 v17, v58, v59
  v_fma_f32 v16, -v59, v59, v16
  v_fma_f32 v17, v59, v58, v17
  v_mul_f32 v60, v16, v16
  v_mul_f32 v61, v16, v17
  v_fma_f32 v60, -v17, v17, v60
  v_fma_f32 v61, v17, v16, v61
  v_mul_f32 v18, v60, v60
  v_mul_f32 v19, v60, v61
  v_fma_f32 v18, -v61, v61, v18
  v_fma_f32 v19, v61, v60, v19
  v_mul_f32 v62, v18, v18
  v_mul_f32 v63, v18, v19
  v_fma_f32 v62, -v19, v19, v62
  v_fma_f32 v63, v19, v18, v63
  v_mul_f32 v64, v62, v62
  v_mul_f32 v65, v62, v63
  v_fma_f32 v64, -v63, v63, v64
  v_fma_f32 v65, v63, v62, v65
  v_mul_f32 v66, v64, v64
  v_mul_f32 v67, v64, v65
  v_fma_f32 v66, -v65, v65, v66
  v_fma_f32 v67, v65, v64, v67
  v_mul_f32 v68, v66, v66
  v_mul_f32 v69, v66, v67
  v_fma_f32 v68, -v67, v67, v68
  v_fma_f32 v69, v67, v66, v69
  v_mul_f32 v48, v66, v68
  v_mul_f32 v49, v66, v69
  v_fma_f32 v48, -v67, v69, v48
  v_fma_f32 v49, v67, v68, v49
  v_cndmask_b32 v20, 1.0, v66, s[70:71]
  v_cndmask_b32 v20, v20, v68, s[72:73]
  v_cndmask_b32 v20, v20, v48, s[74:75]
  v_cndmask_b32 v21, 0, v67, s[70:71]
  v_cndmask_b32 v21, v21, v69, s[72:73]
  v_cndmask_b32 v21, v21, v49, s[74:75]
  v_mul_f32 v48, v16, v60
  v_mul_f32 v49, v16, v61
  v_fma_f32 v48, -v17, v61, v48
  v_fma_f32 v49, v17, v60, v49
  v_cndmask_b32 v22, 1.0, v16, s[70:71]
  v_cndmask_b32 v22, v22, v60, s[72:73]
  v_cndmask_b32 v22, v22, v48, s[74:75]
  v_cndmask_b32 v23, 0, v17, s[70:71]
  v_cndmask_b32 v23, v23, v61, s[72:73]
  v_cndmask_b32 v23, v23, v49, s[74:75]
  v_lshlrev_b32 v44, 16, v44
  v_lshlrev_b32 v45, 16, v45
  v_lshlrev_b32 v46, 16, v46
  v_mul_f32 v46, s76, v46
  v_exp_f32 v46, v46
  s_nop 0
  v_cvt_pk_bf16_f32 v46, v46, v46
  v_lshlrev_b32 v46, 16, v46
  v_mul_f32 v48, v46, v44
  v_mul_f32 v49, v46, v45
  v_mul_f32 v48, s76, v48
  v_mul_f32 v49, 0.15915494, v49
  v_exp_f32 v48, v48
  v_rndne_f32 v50, v49
  v_sub_f32 v49, v49, v50
  v_cos_f32 v50, v49
  v_sin_f32 v51, v49
  v_mul_f32 v52, v44, v44
  v_mul_f32 v240, v48, v50
  v_mul_f32 v241, v48, v51
  v_fma_f32 v52, v45, v45, v52
  v_rcp_f32 v52, v52
  v_add_f32 v48, -1.0, v240
  v_add_f32 v52, v52, v52
  v_mul_f32 v50, v44, v52
  v_mul_f32 v51, -v45, v52
  v_mul_f32 v250, v48, v50
  v_mul_f32 v251, v48, v51
  v_fma_f32 v250, -v241, v51, v250
  v_fma_f32 v251, v241, v50, v251
  v_mul_f32 v54, v240, v240
  v_mul_f32 v55, v240, v241
  v_fma_f32 v54, -v241, v241, v54
  v_fma_f32 v55, v241, v240, v55
  v_mul_f32 v56, v54, v54
  v_mul_f32 v57, v54, v55
  v_fma_f32 v56, -v55, v55, v56
  v_fma_f32 v57, v55, v54, v57
  v_mul_f32 v58, v56, v56
  v_mul_f32 v59, v56, v57
  v_fma_f32 v58, -v57, v57, v58
  v_fma_f32 v59, v57, v56, v59
  v_mul_f32 v242, v58, v58
  v_mul_f32 v243, v58, v59
  v_fma_f32 v242, -v59, v59, v242
  v_fma_f32 v243, v59, v58, v243
  v_mul_f32 v60, v242, v242
  v_mul_f32 v61, v242, v243
  v_fma_f32 v60, -v243, v243, v60
  v_fma_f32 v61, v243, v242, v61
  v_mul_f32 v244, v60, v60
  v_mul_f32 v245, v60, v61
  v_fma_f32 v244, -v61, v61, v244
  v_fma_f32 v245, v61, v60, v245
  v_mul_f32 v62, v244, v244
  v_mul_f32 v63, v244, v245
  v_fma_f32 v62, -v245, v245, v62
  v_fma_f32 v63, v245, v244, v63
  v_mul_f32 v64, v62, v62
  v_mul_f32 v65, v62, v63
  v_fma_f32 v64, -v63, v63, v64
  v_fma_f32 v65, v63, v62, v65
  v_mul_f32 v66, v64, v64
  v_mul_f32 v67, v64, v65
  v_fma_f32 v66, -v65, v65, v66
  v_fma_f32 v67, v65, v64, v67
  v_mul_f32 v68, v66, v66
  v_mul_f32 v69, v66, v67
  v_fma_f32 v68, -v67, v67, v68
  v_fma_f32 v69, v67, v66, v69
  v_mul_f32 v48, v66, v68
  v_mul_f32 v49, v66, v69
  v_fma_f32 v48, -v67, v69, v48
  v_fma_f32 v49, v67, v68, v49
  v_cndmask_b32 v246, 1.0, v66, s[70:71]
  v_cndmask_b32 v246, v246, v68, s[72:73]
  v_cndmask_b32 v246, v246, v48, s[74:75]
  v_cndmask_b32 v247, 0, v67, s[70:71]
  v_cndmask_b32 v247, v247, v69, s[72:73]
  v_cndmask_b32 v247, v247, v49, s[74:75]
  v_mul_f32 v48, v242, v60
  v_mul_f32 v49, v242, v61
  v_fma_f32 v48, -v243, v61, v48
  v_fma_f32 v49, v243, v60, v49
  v_cndmask_b32 v248, 1.0, v242, s[70:71]
  v_cndmask_b32 v248, v248, v60, s[72:73]
  v_cndmask_b32 v248, v248, v48, s[74:75]
  v_cndmask_b32 v249, 0, v243, s[70:71]
  v_cndmask_b32 v249, v249, v61, s[72:73]
  v_cndmask_b32 v249, v249, v49, s[74:75]
  s_waitcnt lgkmcnt(0)
  s_mul_i32 s6, s6, 0x41c64e6d
  s_add_u32 s6, s6, 0x7f4a7c15
  s_lshl_b32 s80, s3, 2
  s_add_u32 s80, s80, s5
  s_mul_i32 s81, s80, 385024
  s_lshl_b32 s12, s4, 14
  s_add_u32 s78, s12, 17301504
  s_lshl_b32 s12, s80, 8
  s_add_u32 s82, s12, s78
  s_add_u32 s83, s82, 8192
  s_lshl_b32 s12, s80, 5
  s_add_u32 s12, s12, s4
  s_lshl_b32 s12, s12, 4
  s_add_u32 s94, s12, 17956864
  s_lshr_b32 s12, s9, 1
  s_add_u32 s12, s12, 40
  s_lshl_b32 s12, s12, 12
  s_add_u32 s66, s12, s81
  s_add_u32 s67, s66, 4096
  s_cmp_eq_u32 s4, 31
  s_cselect_b32 s66, 20971520, s66
  v_lshrrev_b32 v36, 4, v0
  v_lshlrev_b32 v36, 3, v36
  s_sub_u32 s12, s80, 8
  v_sub_u32 v36, s12, v36
  v_and_b32 v37, 15, v0
  v_lshlrev_b32 v37, 4, v37
  v_lshl_add_u32 v37, v36, 8, v37
  v_add_u32 v37, s78, v37
  v_cmp_le_i32 s[16:17], 0, v36
  v_cmp_le_i32 s[18:19], -1, v36
  v_cmp_le_i32 s[20:21], -2, v36
  v_cmp_le_i32 s[22:23], -3, v36
  v_cmp_le_i32 s[24:25], -4, v36
  v_cmp_le_i32 s[26:27], -5, v36
  v_cmp_le_i32 s[28:29], -6, v36
  v_cmp_le_i32 s[30:31], -7, v36
  v_lshl_add_u32 v34, v0, 5, s90
  v_lshrrev_b32 v38, 5, v0
  v_lshlrev_b32 v35, 11, v38
  v_bfe_u32 v38, v0, 4, 1
  v_lshl_add_u32 v35, v38, 8, v35
  v_bfe_u32 v38, v0, 2, 2
  v_lshl_add_u32 v35, v38, 5, v35
  v_and_b32 v38, 1, v0
  v_lshl_add_u32 v35, v38, 10, v35
  v_bfe_u32 v38, v0, 1, 1
  v_lshl_add_u32 v35, v38, 3, v35
  v_add_u32 v35, s90, v35
  s_mov_b32 s14, 0
  s_mov_b32 s15, 0
  s_barrier
  ds_read_b128 v[40:43], v2 offset:0
  ds_read_b128 v[44:47], v2 offset:4096
  ds_read_b128 v[48:51], v6 offset:0
  ds_read_b128 v[52:55], v6 offset:4096
  ds_read_b64_tr_b16 v[56:57], v10 offset:0
  ds_read_b64_tr_b16 v[58:59], v10 offset:256
  ds_read_b64_tr_b16 v[60:61], v11 offset:0
  ds_read_b64_tr_b16 v[62:63], v11 offset:256
  s_waitcnt lgkmcnt(0)
  v_mfma_f32_32x32x16_bf16 v[96:111], v[40:43], v[48:51], 0
  ds_read_b128 v[68:71], v3 offset:0
  ds_read_b128 v[72:75], v3 offset:4096
  v_mfma_f32_32x32x16_bf16 v[112:127], v[44:47], v[48:51], 0
  ds_read_b128 v[76:79], v7 offset:0
  ds_read_b128 v[80:83], v7 offset:4096
  v_mfma_f32_32x32x16_bf16 v[128:143], v[40:43], v[52:55], 0
  ds_read_b64_tr_b16 v[84:85], v10 offset:1024
  ds_read_b64_tr_b16 v[86:87], v10 offset:1280
  v_mfma_f32_32x32x16_bf16 v[144:159], v[44:47], v[52:55], 0
  ds_read_b64_tr_b16 v[88:89], v11 offset:1024
  ds_read_b64_tr_b16 v[90:91], v11 offset:1280
  v_mfma_f32_32x32x16_bf16 v[160:175], v[56:59], v[40:43], 0
  v_mfma_f32_32x32x16_bf16 v[176:191], v[56:59], v[44:47], 0
  v_mfma_f32_32x32x16_bf16 v[192:207], v[60:63], v[40:43], 0
  v_mfma_f32_32x32x16_bf16 v[208:223], v[60:63], v[44:47], 0
  s_branch Cb_L1
Cb_LOOP:
  s_waitcnt lgkmcnt(0)
  v_mfma_f32_32x32x16_bf16 v[96:111], v[40:43], v[48:51], v[96:111]
  ds_read_b128 v[68:71], v3 offset:0
  ds_read_b128 v[72:75], v3 offset:4096
  v_mfma_f32_32x32x16_bf16 v[112:127], v[44:47], v[48:51], v[112:127]
  ds_read_b128 v[76:79], v7 offset:0
  ds_read_b128 v[80:83], v7 offset:4096
  v_mfma_f32_32x32x16_bf16 v[128:143], v[40:43], v[52:55], v[128:143]
  ds_read_b64_tr_b16 v[84:85], v10 offset:1024
  ds_read_b64_tr_b16 v[86:87], v10 offset:1280
  v_mfma_f32_32x32x16_bf16 v[144:159], v[44:47], v[52:55], v[144:159]
  ds_read_b64_tr_b16 v[88:89], v11 offset:1024
  ds_read_b64_tr_b16 v[90:91], v11 offset:1280
  v_mfma_f32_32x32x16_bf16 v[160:175], v[56:59], v[40:43], v[160:175]
  v_mfma_f32_32x32x16_bf16 v[176:191], v[56:59], v[44:47], v[176:191]
  v_mfma_f32_32x32x16_bf16 v[192:207], v[60:63], v[40:43], v[192:207]
  v_mfma_f32_32x32x16_bf16 v[208:223], v[60:63], v[44:47], v[208:223]
Cb_L1:
  s_waitcnt lgkmcnt(0)
  v_mfma_f32_32x32x16_bf16 v[96:111], v[68:71], v[76:79], v[96:111]
  ds_read_b128 v[40:43], v4 offset:0
  ds_read_b128 v[44:47], v4 offset:4096
  v_mfma_f32_32x32x16_bf16 v[112:127], v[72:75], v[76:79], v[112:127]
  ds_read_b128 v[48:51], v8 offset:0
  ds_read_b128 v[52:55], v8 offset:4096
  v_mfma_f32_32x32x16_bf16 v[128:143], v[68:71], v[80:83], v[128:143]
  ds_read_b64_tr_b16 v[56:57], v10 offset:2048
  ds_read_b64_tr_b16 v[58:59], v10 offset:2304
  v_mfma_f32_32x32x16_bf16 v[144:159], v[72:75], v[80:83], v[144:159]
  ds_read_b64_tr_b16 v[60:61], v11 offset:2048
  ds_read_b64_tr_b16 v[62:63], v11 offset:2304
  v_mfma_f32_32x32x16_bf16 v[160:175], v[84:87], v[68:71], v[160:175]
  v_mfma_f32_32x32x16_bf16 v[176:191], v[84:87], v[72:75], v[176:191]
  v_mfma_f32_32x32x16_bf16 v[192:207], v[88:91], v[68:71], v[192:207]
  v_mfma_f32_32x32x16_bf16 v[208:223], v[88:91], v[72:75], v[208:223]
  s_waitcnt lgkmcnt(0)
  v_mfma_f32_32x32x16_bf16 v[96:111], v[40:43], v[48:51], v[96:111]
  ds_read_b128 v[68:71], v5 offset:0
  ds_read_b128 v[72:75], v5 offset:4096
  v_mfma_f32_32x32x16_bf16 v[112:127], v[44:47], v[48:51], v[112:127]
  ds_read_b128 v[76:79], v9 offset:0
  ds_read_b128 v[80:83], v9 offset:4096
  v_mfma_f32_32x32x16_bf16 v[128:143], v[40:43], v[52:55], v[128:143]
  ds_read_b64_tr_b16 v[84:85], v10 offset:3072
  ds_read_b64_tr_b16 v[86:87], v10 offset:3328
  v_mfma_f32_32x32x16_bf16 v[144:159], v[44:47], v[52:55], v[144:159]
  ds_read_b64_tr_b16 v[88:89], v11 offset:3072
  ds_read_b64_tr_b16 v[90:91], v11 offset:3328
  v_mfma_f32_32x32x16_bf16 v[160:175], v[56:59], v[40:43], v[160:175]
  v_mfma_f32_32x32x16_bf16 v[176:191], v[56:59], v[44:47], v[176:191]
  v_mfma_f32_32x32x16_bf16 v[192:207], v[60:63], v[40:43], v[192:207]
  v_mfma_f32_32x32x16_bf16 v[208:223], v[60:63], v[44:47], v[208:223]
  s_add_u32 s14, s14, 1
  s_add_u32 s15, s15, 1
  s_cmp_eq_u32 s15, 3
  s_cselect_b32 s13, -2, 1
  s_cselect_b32 s15, 0, s15
  s_mul_i32 s13, s13, 53248
  s_cmp_eq_u32 s14, 9
  s_cbranch_scc1 Cb_LAST
  s_waitcnt lgkmcnt(0)
  v_mfma_f32_32x32x16_bf16 v[96:111], v[68:71], v[76:79], v[96:111]
  v_add_u32 v2, s13, v2
  v_add_u32 v6, s13, v6
  v_add_u32 v10, s13, v10
  v_add_u32 v11, s13, v11
  s_barrier
  ds_read_b128 v[40:43], v2 offset:0
  ds_read_b128 v[44:47], v2 offset:4096
  v_mfma_f32_32x32x16_bf16 v[112:127], v[72:75], v[76:79], v[112:127]
  ds_read_b128 v[48:51], v6 offset:0
  ds_read_b128 v[52:55], v6 offset:4096
  v_mfma_f32_32x32x16_bf16 v[128:143], v[68:71], v[80:83], v[128:143]
  ds_read_b64_tr_b16 v[56:57], v10 offset:0
  ds_read_b64_tr_b16 v[58:59], v10 offset:256
  v_mfma_f32_32x32x16_bf16 v[144:159], v[72:75], v[80:83], v[144:159]
  ds_read_b64_tr_b16 v[60:61], v11 offset:0
  ds_read_b64_tr_b16 v[62:63], v11 offset:256
  v_mfma_f32_32x32x16_bf16 v[160:175], v[84:87], v[68:71], v[160:175]
  v_add_u32 v3, s13, v3
  v_add_u32 v4, s13, v4
  v_mfma_f32_32x32x16_bf16 v[176:191], v[84:87], v[72:75], v[176:191]
  v_add_u32 v5, s13, v5
  v_add_u32 v7, s13, v7
  v_mfma_f32_32x32x16_bf16 v[192:207], v[88:91], v[68:71], v[192:207]
  v_add_u32 v8, s13, v8
  v_add_u32 v9, s13, v9
  v_mfma_f32_32x32x16_bf16 v[208:223], v[88:91], v[72:75], v[208:223]
  s_branch Cb_LOOP
Cb_LAST:
  s_waitcnt lgkmcnt(0)
  v_mfma_f32_32x32x16_bf16 v[96:111], v[68:71], v[76:79], v[96:111]
  v_add_u32 v2, s13, v2
  v_add_u32 v6, s13, v6
  v_add_u32 v10, s13, v10
  v_add_u32 v11, s13, v11
  v_add_u32 v3, s13, v3
  v_add_u32 v4, s13, v4
  v_add_u32 v5, s13, v5
  v_add_u32 v7, s13, v7
  v_add_u32 v8, s13, v8
  v_add_u32 v9, s13, v9
  s_barrier
  ds_read_b128 v[40:43], v2 offset:0
  ds_read_b128 v[44:47], v2 offset:4096
  v_mfma_f32_32x32x16_bf16 v[112:127], v[72:75], v[76:79], v[112:127]
  ds_read_b128 v[48:51], v6 offset:0
  ds_read_b128 v[224:227], v6 offset:4096
  v_mfma_f32_32x32x16_bf16 v[128:143], v[68:71], v[80:83], v[128:143]
  ds_read_b128 v[52:55], v3 offset:0
  ds_read_b128 v[56:59], v3 offset:4096
  v_mfma_f32_32x32x16_bf16 v[144:159], v[72:75], v[80:83], v[144:159]
  ds_read_b128 v[60:63], v7 offset:0
  ds_read_b128 v[228:231], v7 offset:4096
  v_mfma_f32_32x32x16_bf16 v[160:175], v[84:87], v[68:71], v[160:175]
  v_mfma_f32_32x32x16_bf16 v[176:191], v[84:87], v[72:75], v[176:191]
  v_mfma_f32_32x32x16_bf16 v[192:207], v[88:91], v[68:71], v[192:207]
  v_mfma_f32_32x32x16_bf16 v[208:223], v[88:91], v[72:75], v[208:223]
  s_waitcnt lgkmcnt(0)
  v_mfma_f32_32x32x16_bf16 v[96:111], v[40:43], v[48:51], v[96:111]
  ds_read_b128 v[68:71], v4 offset:0
  ds_read_b128 v[72:75], v4 offset:4096
  ds_read_b128 v[76:79], v8 offset:0
  v_mfma_f32_32x32x16_bf16 v[112:127], v[44:47], v[48:51], v[112:127]
  ds_read_b128 v[232:235], v8 offset:4096
  ds_read_b128 v[80:83], v5 offset:0
  ds_read_b128 v[84:87], v5 offset:4096
  v_mfma_f32_32x32x16_bf16 v[128:143], v[40:43], v[224:227], v[128:143]
  ds_read_b128 v[88:91], v9 offset:0
  ds_read_b128 v[236:239], v9 offset:4096
  v_mfma_f32_32x32x16_bf16 v[144:159], v[44:47], v[224:227], v[144:159]
  v_mfma_f32_32x32x16_bf16 v[96:111], v[52:55], v[60:63], v[96:111]
  v_mfma_f32_32x32x16_bf16 v[112:127], v[56:59], v[60:63], v[112:127]
  v_mfma_f32_32x32x16_bf16 v[128:143], v[52:55], v[228:231], v[128:143]
  v_mfma_f32_32x32x16_bf16 v[144:159], v[56:59], v[228:231], v[144:159]
  s_waitcnt lgkmcnt(0)
  v_mfma_f32_32x32x16_bf16 v[96:111], v[68:71], v[76:79], v[96:111]
  ds_read_b128 v[40:43], v28
  ds_read_b128 v[44:47], v29
  ds_read_b128 v[48:51], v30 offset:0
  v_mfma_f32_32x32x16_bf16 v[112:127], v[72:75], v[76:79], v[112:127]
  ds_read_b128 v[52:55], v30 offset:512
  ds_read_b128 v[56:59], v30 offset:1024
  ds_read_b128 v[60:63], v30 offset:1536
  v_mfma_f32_32x32x16_bf16 v[128:143], v[68:71], v[232:235], v[128:143]
  v_mfma_f32_32x32x16_bf16 v[144:159], v[72:75], v[232:235], v[144:159]
  v_mfma_f32_32x32x16_bf16 v[96:111], v[80:83], v[88:91], v[96:111]
  v_mfma_f32_32x32x16_bf16 v[112:127], v[84:87], v[88:91], v[112:127]
  v_mfma_f32_32x32x16_bf16 v[128:143], v[80:83], v[236:239], v[128:143]
  v_mfma_f32_32x32x16_bf16 v[144:159], v[84:87], v[236:239], v[144:159]
  s_waitcnt lgkmcnt(0)
  v_mfma_f32_32x32x16_bf16 v[96:111], v[40:43], v[48:51], v[96:111]
  ds_read_b128 v[68:71], v2 offset:0
  ds_read_b128 v[72:75], v2 offset:4096
  v_mfma_f32_32x32x16_bf16 v[112:127], v[44:47], v[48:51], v[112:127]
  ds_read_b64_tr_b16 v[84:85], v10 offset:0
  ds_read_b64_tr_b16 v[86:87], v10 offset:256
  v_mfma_f32_32x32x16_bf16 v[128:143], v[40:43], v[52:55], v[128:143]
  ds_read_b64_tr_b16 v[88:89], v11 offset:0
  ds_read_b64_tr_b16 v[90:91], v11 offset:256
  v_mfma_f32_32x32x16_bf16 v[144:159], v[44:47], v[52:55], v[144:159]
  ds_read_b128 v[224:227], v31 offset:0
  ds_read_b128 v[228:231], v31 offset:16
  v_mfma_f32_32x32x16_bf16 v[160:175], v[56:59], v[40:43], v[160:175]
  ds_read_b128 v[232:235], v31 offset:32
  ds_read_b128 v[236:239], v31 offset:48
  v_mfma_f32_32x32x16_bf16 v[176:191], v[56:59], v[44:47], v[176:191]
  v_mfma_f32_32x32x16_bf16 v[192:207], v[60:63], v[40:43], v[192:207]
  v_mfma_f32_32x32x16_bf16 v[208:223], v[60:63], v[44:47], v[208:223]
  s_nop 7
  v_permlane16_swap_b32 v96, v112
  v_permlane16_swap_b32 v97, v113
  v_permlane16_swap_b32 v98, v114
  v_permlane16_swap_b32 v99, v115
  v_permlane16_swap_b32 v100, v116
  v_permlane16_swap_b32 v101, v117
  v_permlane16_swap_b32 v102, v118
  v_permlane16_swap_b32 v103, v119
  v_permlane16_swap_b32 v104, v120
  v_permlane16_swap_b32 v105, v121
  v_permlane16_swap_b32 v106, v122
  v_permlane16_swap_b32 v107, v123
  v_permlane16_swap_b32 v108, v124
  v_permlane16_swap_b32 v109, v125
  v_permlane16_swap_b32 v110, v126
  v_permlane16_swap_b32 v111, v127
  v_permlane16_swap_b32 v128, v144
  v_permlane16_swap_b32 v129, v145
  v_permlane16_swap_b32 v130, v146
  v_permlane16_swap_b32 v131, v147
  v_permlane16_swap_b32 v132, v148
  v_permlane16_swap_b32 v133, v149
  v_permlane16_swap_b32 v134, v150
  v_permlane16_swap_b32 v135, v151
  v_permlane16_swap_b32 v136, v152
  v_permlane16_swap_b32 v137, v153
  v_permlane16_swap_b32 v138, v154
  v_permlane16_swap_b32 v139, v155
  v_permlane16_swap_b32 v140, v156
  v_permlane16_swap_b32 v141, v157
  v_permlane16_swap_b32 v142, v158
  v_permlane16_swap_b32 v143, v159
  s_waitcnt lgkmcnt(0)
  v_mfma_f32_32x32x16_bf16 v[160:175], v[84:87], v[68:71], v[160:175]
  ds_read_b128 v[40:43], v3 offset:0
  ds_read_b128 v[44:47], v3 offset:4096
  v_mul_f32 v96, v96, v224
  v_mul_f32 v112, v112, v224
  v_mul_f32 v97, v97, v225
  v_mul_f32 v113, v113, v225
  v_mul_f32 v98, v98, v226
  v_mul_f32 v114, v114, v226
  v_mul_f32 v99, v99, v227
  v_mul_f32 v115, v115, v227
  v_mul_f32 v100, v100, v228
  v_mul_f32 v116, v116, v228
  v_mul_f32 v101, v101, v229
  v_mul_f32 v117, v117, v229
  v_mul_f32 v102, v102, v230
  v_mul_f32 v118, v118, v230
  v_mul_f32 v103, v103, v231
  v_mul_f32 v119, v119, v231
  v_mfma_f32_32x32x16_bf16 v[176:191], v[84:87], v[72:75], v[176:191]
  ds_read_b64_tr_b16 v[56:57], v10 offset:1024
  ds_read_b64_tr_b16 v[58:59], v10 offset:1280
  v_mul_f32 v104, v104, v232
  v_mul_f32 v120, v120, v232
  v_mul_f32 v105, v105, v233
  v_mul_f32 v121, v121, v233
  v_mul_f32 v106, v106, v234
  v_mul_f32 v122, v122, v234
  v_mul_f32 v107, v107, v235
  v_mul_f32 v123, v123, v235
  v_mul_f32 v108, v108, v236
  v_mul_f32 v124, v124, v236
  v_mul_f32 v109, v109, v237
  v_mul_f32 v125, v125, v237
  v_mul_f32 v110, v110, v238
  v_mul_f32 v126, v126, v238
  v_mul_f32 v111, v111, v239
  v_mul_f32 v127, v127, v239
  v_mfma_f32_32x32x16_bf16 v[192:207], v[88:91], v[68:71], v[192:207]
  ds_read_b64_tr_b16 v[60:61], v11 offset:1024
  ds_read_b64_tr_b16 v[62:63], v11 offset:1280
  v_fma_f32 v8, v14, v96, v97
  v_fma_f32 v9, v14, v112, v113
  v_fma_f32 v8, -v15, v112, v8
  v_fma_f32 v9, v15, v96, v9
  v_fma_f32 v6, v14, v8, v98
  v_fma_f32 v7, v14, v9, v114
  v_fma_f32 v6, -v15, v9, v6
  v_fma_f32 v7, v15, v8, v7
  v_fma_f32 v8, v14, v6, v99
  v_fma_f32 v9, v14, v7, v115
  v_fma_f32 v8, -v15, v7, v8
  v_fma_f32 v9, v15, v6, v9
  v_fma_f32 v6, v14, v8, v100
  v_fma_f32 v7, v14, v9, v116
  v_fma_f32 v6, -v15, v9, v6
  v_fma_f32 v7, v15, v8, v7
  v_mfma_f32_32x32x16_bf16 v[208:223], v[88:91], v[72:75], v[208:223]
  v_fma_f32 v8, v14, v6, v101
  v_fma_f32 v9, v14, v7, v117
  v_fma_f32 v8, -v15, v7, v8
  v_fma_f32 v9, v15, v6, v9
  v_fma_f32 v6, v14, v8, v102
  v_fma_f32 v7, v14, v9, v118
  v_fma_f32 v6, -v15, v9, v6
  v_fma_f32 v7, v15, v8, v7
  v_fma_f32 v8, v14, v6, v103
  v_fma_f32 v9, v14, v7, v119
  v_fma_f32 v8, -v15, v7, v8
  v_fma_f32 v9, v15, v6, v9
  v_fma_f32 v6, v14, v8, v104
  s_waitcnt lgkmcnt(0)
  v_mfma_f32_32x32x16_bf16 v[160:175], v[56:59], v[40:43], v[160:175]
  ds_read_b128 v[68:71], v4 offset:0
  ds_read_b128 v[72:75], v4 offset:4096
  v_fma_f32 v7, v14, v9, v120
  v_fma_f32 v6, -v15, v9, v6
  v_fma_f32 v7, v15, v8, v7
  v_fma_f32 v8, v14, v6, v105
  v_fma_f32 v9, v14, v7, v121
  v_fma_f32 v8, -v15, v7, v8
  v_fma_f32 v9, v15, v6, v9
  v_fma_f32 v6, v14, v8, v106
  v_fma_f32 v7, v14, v9, v122
  v_fma_f32 v6, -v15, v9, v6
  v_fma_f32 v7, v15, v8, v7
  v_fma_f32 v8, v14, v6, v107
  v_fma_f32 v9, v14, v7, v123
  v_fma_f32 v8, -v15, v7, v8
  v_fma_f32 v9, v15, v6, v9
  v_fma_f32 v6, v14, v8, v108
  v_mfma_f32_32x32x16_bf16 v[176:191], v[56:59], v[44:47], v[176:191]
  ds_read_b64_tr_b16 v[84:85], v10 offset:2048
  ds_read_b64_tr_b16 v[86:87], v10 offset:2304
  v_fma_f32 v7, v14, v9, v124
  v_fma_f32 v6, -v15, v9, v6
  v_fma_f32 v7, v15, v8, v7
  v_fma_f32 v8, v14, v6, v109
  v_fma_f32 v9, v14, v7, v125
  v_fma_f32 v8, -v15, v7, v8
  v_fma_f32 v9, v15, v6, v9
  v_fma_f32 v6, v14, v8, v110
  v_fma_f32 v7, v14, v9, v126
  v_fma_f32 v6, -v15, v9, v6
  v_fma_f32 v7, v15, v8, v7
  v_fma_f32 v8, v14, v6, v111
  v_fma_f32 v9, v14, v7, v127
  v_fma_f32 v8, -v15, v7, v8
  v_fma_f32 v9, v15, v6, v9
  v_mul_f32 v128, v128, v224
  v_mfma_f32_32x32x16_bf16 v[192:207], v[60:63], v[40:43], v[192:207]
  ds_read_b64_tr_b16 v[88:89], v11 offset:2048
  ds_read_b64_tr_b16 v[90:91], v11 offset:2304
  v_mul_f32 v144, v144, v224
  v_mul_f32 v129, v129, v225
  v_mul_f32 v145, v145, v225
  v_mul_f32 v130, v130, v226
  v_mul_f32 v146, v146, v226
  v_mul_f32 v131, v131, v227
  v_mul_f32 v147, v147, v227
  v_mul_f32 v132, v132, v228
  v_mul_f32 v148, v148, v228
  v_mul_f32 v133, v133, v229
  v_mul_f32 v149, v149, v229
  v_mul_f32 v134, v134, v230
  v_mul_f32 v150, v150, v230
  v_mul_f32 v135, v135, v231
  v_mul_f32 v151, v151, v231
  v_mul_f32 v136, v136, v232
  v_mfma_f32_32x32x16_bf16 v[208:223], v[60:63], v[44:47], v[208:223]
  v_mul_f32 v152, v152, v232
  v_mul_f32 v137, v137, v233
  v_mul_f32 v153, v153, v233
  v_mul_f32 v138, v138, v234
  v_mul_f32 v154, v154, v234
  v_mul_f32 v139, v139, v235
  v_mul_f32 v155, v155, v235
  v_mul_f32 v140, v140, v236
  v_mul_f32 v156, v156, v236
  v_mul_f32 v141, v141, v237
  v_mul_f32 v157, v157, v237
  v_mul_f32 v142, v142, v238
  v_mul_f32 v158, v158, v238
  s_waitcnt lgkmcnt(0)
  v_mfma_f32_32x32x16_bf16 v[160:175], v[84:87], v[68:71], v[160:175]
  ds_read_b128 v[40:43], v5 offset:0
  ds_read_b128 v[44:47], v5 offset:4096
  v_mul_f32 v143, v143, v239
  v_mul_f32 v159, v159, v239
  v_fma_f32 v12, v240, v128, v129
  v_fma_f32 v13, v240, v144, v145
  v_fma_f32 v12, -v241, v144, v12
  v_fma_f32 v13, v241, v128, v13
  v_fma_f32 v6, v240, v12, v130
  v_fma_f32 v7, v240, v13, v146
  v_fma_f32 v6, -v241, v13, v6
  v_fma_f32 v7, v241, v12, v7
  v_fma_f32 v12, v240, v6, v131
  v_fma_f32 v13, v240, v7, v147
  v_fma_f32 v12, -v241, v7, v12
  v_fma_f32 v13, v241, v6, v13
  v_fma_f32 v6, v240, v12, v132
  v_fma_f32 v7, v240, v13, v148
  v_mfma_f32_32x32x16_bf16 v[176:191], v[84:87], v[72:75], v[176:191]
  ds_read_b64_tr_b16 v[56:57], v10 offset:3072
  ds_read_b64_tr_b16 v[58:59], v10 offset:3328
  v_fma_f32 v6, -v241, v13, v6
  v_fma_f32 v7, v241, v12, v7
  v_fma_f32 v12, v240, v6, v133
  v_fma_f32 v13, v240, v7, v149
  v_fma_f32 v12, -v241, v7, v12
  v_fma_f32 v13, v241, v6, v13
  v_fma_f32 v6, v240, v12, v134
  v_fma_f32 v7, v240, v13, v150
  v_fma_f32 v6, -v241, v13, v6
  v_fma_f32 v7, v241, v12, v7
  v_fma_f32 v12, v240, v6, v135
  v_fma_f32 v13, v240, v7, v151
  v_fma_f32 v12, -v241, v7, v12
  v_fma_f32 v13, v241, v6, v13
  v_fma_f32 v6, v240, v12, v136
  v_fma_f32 v7, v240, v13, v152
  v_mfma_f32_32x32x16_bf16 v[192:207], v[88:91], v[68:71], v[192:207]
  ds_read_b64_tr_b16 v[60:61], v11 offset:3072
  ds_read_b64_tr_b16 v[62:63], v11 offset:3328
  v_fma_f32 v6, -v241, v13, v6
  v_fma_f32 v7, v241, v12, v7
  v_fma_f32 v12, v240, v6, v137
  v_fma_f32 v13, v240, v7, v153
  v_fma_f32 v12, -v241, v7, v12
  v_fma_f32 v13, v241, v6, v13
  v_fma_f32 v6, v240, v12, v138
  v_fma_f32 v7, v240, v13, v154
  v_fma_f32 v6, -v241, v13, v6
  v_fma_f32 v7, v241, v12, v7
  v_fma_f32 v12, v240, v6, v139
  v_fma_f32 v13, v240, v7, v155
  v_fma_f32 v12, -v241, v7, v12
  v_fma_f32 v13, v241, v6, v13
  v_fma_f32 v6, v240, v12, v140
  v_fma_f32 v7, v240, v13, v156
  v_mfma_f32_32x32x16_bf16 v[208:223], v[88:91], v[72:75], v[208:223]
  v_fma_f32 v6, -v241, v13, v6
  v_fma_f32 v7, v241, v12, v7
  v_fma_f32 v12, v240, v6, v141
  v_fma_f32 v13, v240, v7, v157
  v_fma_f32 v12, -v241, v7, v12
  v_fma_f32 v13, v241, v6, v13
  v_fma_f32 v6, v240, v12, v142
  v_fma_f32 v7, v240, v13, v158
  v_fma_f32 v6, -v241, v13, v6
  v_fma_f32 v7, v241, v12, v7
  v_fma_f32 v12, v240, v6, v143
  v_fma_f32 v13, v240, v7, v159
  v_fma_f32 v12, -v241, v7, v12
  v_fma_f32 v13, v241, v6, v13
  s_waitcnt lgkmcnt(0)
  v_mfma_f32_32x32x16_bf16 v[160:175], v[56:59], v[40:43], v[160:175]
  s_barrier
  v_mov_b32 v72, v8
  v_mov_b32 v73, v8
  v_mov_b32 v76, v9
  v_mov_b32 v77, v9
  s_nop 1
  v_permlane16_swap_b32 v72, v73
  v_permlane16_swap_b32 v76, v77
  s_nop 1
  v_mov_b32 v74, v72
  v_mov_b32 v75, v73
  v_mov_b32 v78, v76
  v_mov_b32 v79, v77
  s_nop 1
  v_permlane32_swap_b32 v72, v74
  v_permlane32_swap_b32 v73, v75
  v_permlane32_swap_b32 v76, v78
  v_permlane32_swap_b32 v77, v79
  s_nop 1
  v_fma_f32 v68, v16, v72, v73
  v_fma_f32 v69, v16, v76, v77
  v_fma_f32 v68, -v17, v76, v68
  v_mfma_f32_32x32x16_bf16 v[176:191], v[56:59], v[44:47], v[176:191]
  v_fma_f32 v69, v17, v72, v69
  v_fma_f32 v70, v16, v68, v74
  v_fma_f32 v71, v16, v69, v78
  v_fma_f32 v70, -v17, v69, v70
  v_fma_f32 v71, v17, v68, v71
  v_fma_f32 v80, v16, v70, v75
  v_fma_f32 v82, v16, v71, v79
  v_fma_f32 v80, -v17, v71, v80
  v_fma_f32 v82, v17, v70, v82
  v_mov_b32 v81, s6
  v_mov_b32 v83, s6
  s_mov_b64 exec, 0xffff
  buffer_store_dwordx4 v[80:83], v27, s[48:51], s82 offen sc1
  s_mov_b64 exec, -1
  v_cndmask_b32 v32, 0, v72, s[70:71]
  v_cndmask_b32 v32, v32, v68, s[72:73]
  v_cndmask_b32 v32, v32, v70, s[74:75]
  v_cndmask_b32 v33, 0, v76, s[70:71]
  v_cndmask_b32 v33, v33, v69, s[72:73]
  v_cndmask_b32 v33, v33, v71, s[74:75]
  v_mov_b32 v72, v12
  v_mfma_f32_32x32x16_bf16 v[192:207], v[60:63], v[40:43], v[192:207]
  v_mov_b32 v73, v12
  v_mov_b32 v76, v13
  v_mov_b32 v77, v13
  s_nop 1
  v_permlane16_swap_b32 v72, v73
  v_permlane16_swap_b32 v76, v77
  s_nop 1
  v_mov_b32 v74, v72
  v_mov_b32 v75, v73
  v_mov_b32 v78, v76
  v_mov_b32 v79, v77
  s_nop 1
  v_permlane32_swap_b32 v72, v74
  v_permlane32_swap_b32 v73, v75
  v_permlane32_swap_b32 v76, v78
  v_permlane32_swap_b32 v77, v79
  s_nop 1
  v_fma_f32 v68, v242, v72, v73
  v_fma_f32 v69, v242, v76, v77
  v_fma_f32 v68, -v243, v76, v68
  v_fma_f32 v69, v243, v72, v69
  v_mfma_f32_32x32x16_bf16 v[208:223], v[60:63], v[44:47], v[208:223]
  v_fma_f32 v70, v242, v68, v74
  v_fma_f32 v71, v242, v69, v78
  v_fma_f32 v70, -v243, v69, v70
  v_fma_f32 v71, v243, v68, v71
  v_fma_f32 v80, v242, v70, v75
  v_fma_f32 v82, v242, v71, v79
  v_fma_f32 v80, -v243, v71, v80
  v_fma_f32 v82, v243, v70, v82
  v_mov_b32 v81, s6
  v_mov_b32 v83, s6
  s_mov_b64 exec, 0xffff
  buffer_store_dwordx4 v[80:83], v27, s[48:51], s83 offen sc1
  s_mov_b64 exec, -1
  v_cndmask_b32 v252, 0, v72, s[70:71]
  v_cndmask_b32 v252, v252, v68, s[72:73]
  v_cndmask_b32 v252, v252, v70, s[74:75]
  v_cndmask_b32 v253, 0, v76, s[70:71]
  v_cndmask_b32 v253, v253, v69, s[72:73]
  v_cndmask_b32 v253, v253, v71, s[74:75]
  s_nop 3
  s_nop 3
  v_add_u32 v2, 1024, v27
  v_add_u32 v3, 8192, v37
  v_max_f32 v160, 0, v160
  v_max_f32 v161, 0, v161
  v_max_f32 v162, 0, v162
  v_max_f32 v163, 0, v163
  v_max_f32 v164, 0, v164
  v_max_f32 v165, 0, v165
  v_max_f32 v166, 0, v166
  v_max_f32 v167, 0, v167
  v_pk_mul_f32 v[160:161], v[160:161], v[168:169]
  v_pk_mul_f32 v[162:163], v[162:163], v[170:171]
  v_pk_mul_f32 v[164:165], v[164:165], v[172:173]
  v_pk_mul_f32 v[166:167], v[166:167], v[174:175]
  v_cvt_pk_bf16_f32 v224, v160, v161
  v_cvt_pk_bf16_f32 v225, v162, v163
  v_cvt_pk_bf16_f32 v226, v164, v165
  v_cvt_pk_bf16_f32 v227, v166, v167
  buffer_store_dwordx4 v[224:227], v26, s[48:51], s66 offen offset:0 sc1
  v_max_f32 v176, 0, v176
  v_max_f32 v177, 0, v177
  v_max_f32 v178, 0, v178
  v_max_f32 v179, 0, v179
  v_max_f32 v180, 0, v180
  v_max_f32 v181, 0, v181
  v_max_f32 v182, 0, v182
  v_max_f32 v183, 0, v183
  v_pk_mul_f32 v[176:177], v[176:177], v[184:185]
  v_pk_mul_f32 v[178:179], v[178:179], v[186:187]
  v_pk_mul_f32 v[180:181], v[180:181], v[188:189]
  v_pk_mul_f32 v[182:183], v[182:183], v[190:191]
  v_cvt_pk_bf16_f32 v228, v176, v177
  v_cvt_pk_bf16_f32 v229, v178, v179
  v_cvt_pk_bf16_f32 v230, v180, v181
  v_cvt_pk_bf16_f32 v231, v182, v183
  buffer_store_dwordx4 v[228:231], v26, s[48:51], s66 offen offset:2048 sc1
  v_max_f32 v192, 0, v192
  v_max_f32 v193, 0, v193
  v_max_f32 v194, 0, v194
  v_max_f32 v195, 0, v195
  v_max_f32 v196, 0, v196
  v_max_f32 v197, 0, v197
  v_max_f32 v198, 0, v198
  v_max_f32 v199, 0, v199
  v_pk_mul_f32 v[192:193], v[192:193], v[200:201]
  v_pk_mul_f32 v[194:195], v[194:195], v[202:203]
  v_pk_mul_f32 v[196:197], v[196:197], v[204:205]
  v_pk_mul_f32 v[198:199], v[198:199], v[206:207]
  v_cvt_pk_bf16_f32 v232, v192, v193
  v_cvt_pk_bf16_f32 v233, v194, v195
  v_cvt_pk_bf16_f32 v234, v196, v197
  v_cvt_pk_bf16_f32 v235, v198, v199
  buffer_store_dwordx4 v[232:235], v26, s[48:51], s66 offen offset:512 sc1
  v_max_f32 v208, 0, v208
  v_max_f32 v209, 0, v209
  v_max_f32 v210, 0, v210
  v_max_f32 v211, 0, v211
  v_max_f32 v212, 0, v212
  v_max_f32 v213, 0, v213
  v_max_f32 v214, 0, v214
  v_max_f32 v215, 0, v215
  v_pk_mul_f32 v[208:209], v[208:209], v[216:217]
  v_pk_mul_f32 v[210:211], v[210:211], v[218:219]
  v_pk_mul_f32 v[212:213], v[212:213], v[220:221]
  v_pk_mul_f32 v[214:215], v[214:215], v[222:223]
  v_cvt_pk_bf16_f32 v236, v208, v209
  v_cvt_pk_bf16_f32 v237, v210, v211
  v_cvt_pk_bf16_f32 v238, v212, v213
  v_cvt_pk_bf16_f32 v239, v214, v215
  buffer_store_dwordx4 v[236:239], v26, s[48:51], s66 offen offset:2560 sc1
  s_waitcnt lgkmcnt(0)
  v_pk_mul_f32 v[40:41], v[96:97], v[24:25] op_sel:[0,1] op_sel_hi:[1,1]
  v_pk_mul_f32 v[96:97], v[96:97], v[24:25] op_sel:[0,0] op_sel_hi:[1,0]
  v_pk_fma_f32 v[96:97], v[112:113], v[24:25], v[96:97] op_sel:[0,1,0] op_sel_hi:[1,1,1] neg_lo:[1,0,0] neg_hi:[1,0,0]
  v_pk_fma_f32 v[112:113], v[112:113], v[24:25], v[40:41] op_sel:[0,0,0] op_sel_hi:[1,0,1]
  v_pk_mul_f32 v[42:43], v[98:99], v[24:25] op_sel:[0,1] op_sel_hi:[1,1]
  v_pk_mul_f32 v[98:99], v[98:99], v[24:25] op_sel:[0,0] op_sel_hi:[1,0]
  v_pk_fma_f32 v[98:99], v[114:115], v[24:25], v[98:99] op_sel:[0,1,0] op_sel_hi:[1,1,1] neg_lo:[1,0,0] neg_hi:[1,0,0]
  v_pk_fma_f32 v[114:115], v[114:115], v[24:25], v[42:43] op_sel:[0,0,0] op_sel_hi:[1,0,1]
  v_pk_mul_f32 v[40:41], v[100:101], v[24:25] op_sel:[0,1] op_sel_hi:[1,1]
  v_pk_mul_f32 v[100:101], v[100:101], v[24:25] op_sel:[0,0] op_sel_hi:[1,0]
  v_pk_fma_f32 v[100:101], v[116:117], v[24:25], v[100:101] op_sel:[0,1,0] op_sel_hi:[1,1,1] neg_lo:[1,0,0] neg_hi:[1,0,0]
  v_pk_fma_f32 v[116:117], v[116:117], v[24:25], v[40:41] op_sel:[0,0,0] op_sel_hi:[1,0,1]
  v_pk_mul_f32 v[42:43], v[102:103], v[24:25] op_sel:[0,1] op_sel_hi:[1,1]
  v_pk_mul_f32 v[102:103], v[102:103], v[24:25] op_sel:[0,0] op_sel_hi:[1,0]
  v_pk_fma_f32 v[102:103], v[118:119], v[24:25], v[102:103] op_sel:[0,1,0] op_sel_hi:[1,1,1] neg_lo:[1,0,0] neg_hi:[1,0,0]
  v_pk_fma_f32 v[118:119], v[118:119], v[24:25], v[42:43] op_sel:[0,0,0] op_sel_hi:[1,0,1]
  v_pk_mul_f32 v[40:41], v[104:105], v[24:25] op_sel:[0,1] op_sel_hi:[1,1]
  v_pk_mul_f32 v[104:105], v[104:105], v[24:25] op_sel:[0,0] op_sel_hi:[1,0]
  v_pk_fma_f32 v[104:105], v[120:121], v[24:25], v[104:105] op_sel:[0,1,0] op_sel_hi:[1,1,1] neg_lo:[1,0,0] neg_hi:[1,0,0]
  v_pk_fma_f32 v[120:121], v[120:121], v[24:25], v[40:41] op_sel:[0,0,0] op_sel_hi:[1,0,1]
  v_pk_mul_f32 v[42:43], v[106:107], v[24:25] op_sel:[0,1] op_sel_hi:[1,1]
  v_pk_mul_f32 v[106:107], v[106:107], v[24:25] op_sel:[0,0] op_sel_hi:[1,0]
  v_pk_fma_f32 v[106:107], v[122:123], v[24:25], v[106:107] op_sel:[0,1,0] op_sel_hi:[1,1,1] neg_lo:[1,0,0] neg_hi:[1,0,0]
  v_pk_fma_f32 v[122:123], v[122:123], v[24:25], v[42:43] op_sel:[0,0,0] op_sel_hi:[1,0,1]
  v_pk_mul_f32 v[40:41], v[108:109], v[24:25] op_sel:[0,1] op_sel_hi:[1,1]
  v_pk_mul_f32 v[108:109], v[108:109], v[24:25] op_sel:[0,0] op_sel_hi:[1,0]
  v_pk_fma_f32 v[108:109], v[124:125], v[24:25], v[108:109] op_sel:[0,1,0] op_sel_hi:[1,1,1] neg_lo:[1,0,0] neg_hi:[1,0,0]
  v_pk_fma_f32 v[124:125], v[124:125], v[24:25], v[40:41] op_sel:[0,0,0] op_sel_hi:[1,0,1]
  v_pk_mul_f32 v[42:43], v[110:111], v[24:25] op_sel:[0,1] op_sel_hi:[1,1]
  v_pk_mul_f32 v[110:111], v[110:111], v[24:25] op_sel:[0,0] op_sel_hi:[1,0]
  v_pk_fma_f32 v[110:111], v[126:127], v[24:25], v[110:111] op_sel:[0,1,0] op_sel_hi:[1,1,1] neg_lo:[1,0,0] neg_hi:[1,0,0]
  v_pk_fma_f32 v[126:127], v[126:127], v[24:25], v[42:43] op_sel:[0,0,0] op_sel_hi:[1,0,1]
  v_pk_mul_f32 v[40:41], v[128:129], v[250:251] op_sel:[0,1] op_sel_hi:[1,1]
  v_pk_mul_f32 v[128:129], v[128:129], v[250:251] op_sel:[0,0] op_sel_hi:[1,0]
  v_pk_fma_f32 v[128:129], v[144:145], v[250:251], v[128:129] op_sel:[0,1,0] op_sel_hi:[1,1,1] neg_lo:[1,0,0] neg_hi:[1,0,0]
  v_pk_fma_f32 v[144:145], v[144:145], v[250:251], v[40:41] op_sel:[0,0,0] op_sel_hi:[1,0,1]
  v_pk_mul_f32 v[42:43], v[130:131], v[250:251] op_sel:[0,1] op_sel_hi:[1,1]
  v_pk_mul_f32 v[130:131], v[130:131], v[250:251] op_sel:[0,0] op_sel_hi:[1,0]
  v_pk_fma_f32 v[130:131], v[146:147], v[250:251], v[130:131] op_sel:[0,1,0] op_sel_hi:[1,1,1] neg_lo:[1,0,0] neg_hi:[1,0,0]
  v_pk_fma_f32 v[146:147], v[146:147], v[250:251], v[42:43] op_sel:[0,0,0] op_sel_hi:[1,0,1]
  v_pk_mul_f32 v[40:41], v[132:133], v[250:251] op_sel:[0,1] op_sel_hi:[1,1]
  v_pk_mul_f32 v[132:133], v[132:133], v[250:251] op_sel:[0,0] op_sel_hi:[1,0]
  v_pk_fma_f32 v[132:133], v[148:149], v[250:251], v[132:133] op_sel:[0,1,0] op_sel_hi:[1,1,1] neg_lo:[1,0,0] neg_hi:[1,0,0]
  v_pk_fma_f32 v[148:149], v[148:149], v[250:251], v[40:41] op_sel:[0,0,0] op_sel_hi:[1,0,1]
  v_pk_mul_f32 v[42:43], v[134:135], v[250:251] op_sel:[0,1] op_sel_hi:[1,1]
  v_pk_mul_f32 v[134:135], v[134:135], v[250:251] op_sel:[0,0] op_sel_hi:[1,0]
  v_pk_fma_f32 v[134:135], v[150:151], v[250:251], v[134:135] op_sel:[0,1,0] op_sel_hi:[1,1,1] neg_lo:[1,0,0] neg_hi:[1,0,0]
  v_pk_fma_f32 v[150:151], v[150:151], v[250:251], v[42:43] op_sel:[0,0,0] op_sel_hi:[1,0,1]
  v_pk_mul_f32 v[40:41], v[136:137], v[250:251] op_sel:[0,1] op_sel_hi:[1,1]
  v_pk_mul_f32 v[136:137], v[136:137], v[250:251] op_sel:[0,0] op_sel_hi:[1,0]
  v_pk_fma_f32 v[136:137], v[152:153], v[250:251], v[136:137] op_sel:[0,1,0] op_sel_hi:[1,1,1] neg_lo:[1,0,0] neg_hi:[1,0,0]
  v_pk_fma_f32 v[152:153], v[152:153], v[250:251], v[40:41] op_sel:[0,0,0] op_sel_hi:[1,0,1]
  v_pk_mul_f32 v[42:43], v[138:139], v[250:251] op_sel:[0,1] op_sel_hi:[1,1]
  v_pk_mul_f32 v[138:139], v[138:139], v[250:251] op_sel:[0,0] op_sel_hi:[1,0]
  v_pk_fma_f32 v[138:139], v[154:155], v[250:251], v[138:139] op_sel:[0,1,0] op_sel_hi:[1,1,1] neg_lo:[1,0,0] neg_hi:[1,0,0]
  v_pk_fma_f32 v[154:155], v[154:155], v[250:251], v[42:43] op_sel:[0,0,0] op_sel_hi:[1,0,1]
  v_pk_mul_f32 v[40:41], v[140:141], v[250:251] op_sel:[0,1] op_sel_hi:[1,1]
  v_pk_mul_f32 v[140:141], v[140:141], v[250:251] op_sel:[0,0] op_sel_hi:[1,0]
  v_pk_fma_f32 v[140:141], v[156:157], v[250:251], v[140:141] op_sel:[0,1,0] op_sel_hi:[1,1,1] neg_lo:[1,0,0] neg_hi:[1,0,0]
  v_pk_fma_f32 v[156:157], v[156:157], v[250:251], v[40:41] op_sel:[0,0,0] op_sel_hi:[1,0,1]
  v_pk_mul_f32 v[42:43], v[142:143], v[250:251] op_sel:[0,1] op_sel_hi:[1,1]
  v_pk_mul_f32 v[142:143], v[142:143], v[250:251] op_sel:[0,0] op_sel_hi:[1,0]
  v_pk_fma_f32 v[142:143], v[158:159], v[250:251], v[142:143] op_sel:[0,1,0] op_sel_hi:[1,1,1] neg_lo:[1,0,0] neg_hi:[1,0,0]
  v_pk_fma_f32 v[158:159], v[158:159], v[250:251], v[42:43] op_sel:[0,0,0] op_sel_hi:[1,0,1]
  v_mov_b32 v192, v14
  v_mov_b32 v208, v15
  v_fma_f32 v97, v14, v96, v97
  v_mul_f32 v193, v14, v192
  v_fma_f32 v113, v14, v112, v113
  v_mul_f32 v209, v14, v208
  v_fma_f32 v97, -v15, v112, v97
  v_fma_f32 v193, -v15, v208, v193
  v_fma_f32 v113, v15, v96, v113
  v_fma_f32 v209, v15, v192, v209
  v_fma_f32 v98, v14, v97, v98
  v_mul_f32 v194, v14, v193
  v_fma_f32 v114, v14, v113, v114
  v_mul_f32 v210, v14, v209
  v_fma_f32 v98, -v15, v113, v98
  v_fma_f32 v194, -v15, v209, v194
  v_fma_f32 v114, v15, v97, v114
  v_fma_f32 v210, v15, v193, v210
  v_fma_f32 v99, v14, v98, v99
  v_mul_f32 v195, v14, v194
  v_fma_f32 v115, v14, v114, v115
  v_mul_f32 v211, v14, v210
  v_fma_f32 v99, -v15, v114, v99
  v_fma_f32 v195, -v15, v210, v195
  v_fma_f32 v115, v15, v98, v115
  v_fma_f32 v211, v15, v194, v211
  v_fma_f32 v100, v14, v99, v100
  v_mul_f32 v196, v14, v195
  v_fma_f32 v116, v14, v115, v116
  v_mul_f32 v212, v14, v211
  v_fma_f32 v100, -v15, v115, v100
  v_fma_f32 v196, -v15, v211, v196
  v_fma_f32 v116, v15, v99, v116
  v_fma_f32 v212, v15, v195, v212
  v_fma_f32 v101, v14, v100, v101
  v_mul_f32 v197, v14, v196
  v_fma_f32 v117, v14, v116, v117
  v_mul_f32 v213, v14, v212
  v_fma_f32 v101, -v15, v116, v101
  v_fma_f32 v197, -v15, v212, v197
  v_fma_f32 v117, v15, v100, v117
  v_fma_f32 v213, v15, v196, v213
  v_fma_f32 v102, v14, v101, v102
  v_mul_f32 v198, v14, v197
  v_fma_f32 v118, v14, v117, v118
  v_mul_f32 v214, v14, v213
  v_fma_f32 v102, -v15, v117, v102
  v_fma_f32 v198, -v15, v213, v198
  v_fma_f32 v118, v15, v101, v118
  v_fma_f32 v214, v15, v197, v214
  v_fma_f32 v103, v14, v102, v103
  v_mul_f32 v199, v14, v198
  v_fma_f32 v119, v14, v118, v119
  v_mul_f32 v215, v14, v214
  v_fma_f32 v103, -v15, v118, v103
  v_fma_f32 v199, -v15, v214, v199
  v_fma_f32 v119, v15, v102, v119
  v_fma_f32 v215, v15, v198, v215
  v_fma_f32 v104, v14, v103, v104
  v_mul_f32 v200, v14, v199
  v_fma_f32 v120, v14, v119, v120
  v_mul_f32 v216, v14, v215
  v_fma_f32 v104, -v15, v119, v104
  v_fma_f32 v200, -v15, v215, v200
  v_fma_f32 v120, v15, v103, v120
  v_fma_f32 v216, v15, v199, v216
  v_fma_f32 v105, v14, v104, v105
  v_mul_f32 v201, v14, v200
  v_fma_f32 v121, v14, v120, v121
  v_mul_f32 v217, v14, v216
  v_fma_f32 v105, -v15, v120, v105
  v_fma_f32 v201, -v15, v216, v201
  v_fma_f32 v121, v15, v104, v121
  v_fma_f32 v217, v15, v200, v217
  v_fma_f32 v106, v14, v105, v106
  v_mul_f32 v202, v14, v201
  v_fma_f32 v122, v14, v121, v122
  v_mul_f32 v218, v14, v217
  v_fma_f32 v106, -v15, v121, v106
  v_fma_f32 v202, -v15, v217, v202
  v_fma_f32 v122, v15, v105, v122
  v_fma_f32 v218, v15, v201, v218
  v_fma_f32 v107, v14, v106, v107
  v_mul_f32 v203, v14, v202
  v_fma_f32 v123, v14, v122, v123
  v_mul_f32 v219, v14, v218
  v_fma_f32 v107, -v15, v122, v107
  v_fma_f32 v203, -v15, v218, v203
  v_fma_f32 v123, v15, v106, v123
  v_fma_f32 v219, v15, v202, v219
  v_fma_f32 v108, v14, v107, v108
  v_mul_f32 v204, v14, v203
  v_fma_f32 v124, v14, v123, v124
  v_mul_f32 v220, v14, v219
  v_fma_f32 v108, -v15, v123, v108
  v_fma_f32 v204, -v15, v219, v204
  v_fma_f32 v124, v15, v107, v124
  v_fma_f32 v220, v15, v203, v220
  v_fma_f32 v109, v14, v108, v109
  v_mul_f32 v205, v14, v204
  v_fma_f32 v125, v14, v124, v125
  v_mul_f32 v221, v14, v220
  v_fma_f32 v109, -v15, v124, v109
  v_fma_f32 v205, -v15, v220, v205
  v_fma_f32 v125, v15, v108, v125
  v_fma_f32 v221, v15, v204, v221
  v_fma_f32 v110, v14, v109, v110
  v_mul_f32 v206, v14, v205
  v_fma_f32 v126, v14, v125, v126
  v_mul_f32 v222, v14, v221
  v_fma_f32 v110, -v15, v125, v110
  v_fma_f32 v206, -v15, v221, v206
  v_fma_f32 v126, v15, v109, v126
  v_fma_f32 v222, v15, v205, v222
  v_fma_f32 v111, v14, v110, v111
  v_mul_f32 v207, v14, v206
  v_fma_f32 v127, v14, v126, v127
  v_mul_f32 v223, v14, v222
  v_fma_f32 v111, -v15, v126, v111
  v_fma_f32 v207, -v15, v222, v207
  v_fma_f32 v127, v15, v110, v127
  v_fma_f32 v223, v15, v206, v223
  v_mov_b32 v38, s6
  s_waitcnt vmcnt(0)
  s_mov_b64 exec, 1
  buffer_store_dword v38, off, s[48:51], s94 sc1
  s_mov_b64 exec, -1
  v_mov_b32 v36, 20971520
  v_cndmask_b32 v38, v36, v37, s[16:17]
  buffer_load_dwordx4 v[44:47], v38, s[48:51], 0 offen offset:0 sc1
  v_cndmask_b32 v39, v36, v37, s[18:19]
  buffer_load_dwordx4 v[48:51], v39, s[48:51], 0 offen offset:256 sc1
  v_cndmask_b32 v38, v36, v37, s[20:21]
  buffer_load_dwordx4 v[52:55], v38, s[48:51], 0 offen offset:512 sc1
  v_cndmask_b32 v39, v36, v37, s[22:23]
  buffer_load_dwordx4 v[56:59], v39, s[48:51], 0 offen offset:768 sc1
  v_cndmask_b32 v38, v36, v37, s[24:25]
  buffer_load_dwordx4 v[60:63], v38, s[48:51], 0 offen offset:1024 sc1
  v_cndmask_b32 v39, v36, v37, s[26:27]
  buffer_load_dwordx4 v[64:67], v39, s[48:51], 0 offen offset:1280 sc1
  v_cndmask_b32 v38, v36, v37, s[28:29]
  buffer_load_dwordx4 v[68:71], v38, s[48:51], 0 offen offset:1536 sc1
  v_cndmask_b32 v39, v36, v37, s[30:31]
  buffer_load_dwordx4 v[72:75], v39, s[48:51], 0 offen offset:1792 sc1
  v_cndmask_b32 v38, v36, v3, s[16:17]
  buffer_load_dwordx4 v[160:163], v38, s[48:51], 0 offen offset:0 sc1
  v_cndmask_b32 v39, v36, v3, s[18:19]
  buffer_load_dwordx4 v[164:167], v39, s[48:51], 0 offen offset:256 sc1
  v_cndmask_b32 v38, v36, v3, s[20:21]
  buffer_load_dwordx4 v[168:171], v38, s[48:51], 0 offen offset:512 sc1
  v_cndmask_b32 v39, v36, v3, s[22:23]
  buffer_load_dwordx4 v[172:175], v39, s[48:51], 0 offen offset:768 sc1
  v_cndmask_b32 v38, v36, v3, s[24:25]
  buffer_load_dwordx4 v[176:179], v38, s[48:51], 0 offen offset:1024 sc1
  v_cndmask_b32 v39, v36, v3, s[26:27]
  buffer_load_dwordx4 v[180:183], v39, s[48:51], 0 offen offset:1280 sc1
  v_cndmask_b32 v38, v36, v3, s[28:29]
  buffer_load_dwordx4 v[184:187], v38, s[48:51], 0 offen offset:1536 sc1
  v_cndmask_b32 v39, v36, v3, s[30:31]
  buffer_load_dwordx4 v[188:191], v39, s[48:51], 0 offen offset:1792 sc1
  s_add_u32 s91, s88, 102400
  s_add_u32 m0, s90, 4096
  s_add_u32 s68, s91, 0
  buffer_load_dwordx4 v27, s[48:51], s68 offen sc1 lds
  s_add_u32 m0, s90, 5120
  s_add_u32 s68, s91, 1024
  buffer_load_dwordx4 v27, s[48:51], s68 offen sc1 lds
  s_add_u32 m0, s90, 6144
  s_add_u32 s68, s91, 2048
  buffer_load_dwordx4 v27, s[48:51], s68 offen sc1 lds
  s_add_u32 m0, s90, 7168
  s_add_u32 s68, s91, 3072
  buffer_load_dwordx4 v27, s[48:51], s68 offen sc1 lds
  s_add_u32 m0, s90, 8192
  s_add_u32 s68, s91, 4096
  buffer_load_dwordx4 v27, s[48:51], s68 offen sc1 lds
  s_add_u32 s91, s88, 143360
  s_add_u32 m0, s90, 9216
  s_add_u32 s68, s91, 0
  buffer_load_dwordx4 v27, s[48:51], s68 offen sc1 lds
  s_add_u32 m0, s90, 10240
  s_add_u32 s68, s91, 1024
  buffer_load_dwordx4 v27, s[48:51], s68 offen sc1 lds
  s_add_u32 m0, s90, 11264
  s_add_u32 s68, s91, 2048
  buffer_load_dwordx4 v27, s[48:51], s68 offen sc1 lds
  s_add_u32 m0, s90, 12288
  s_add_u32 s68, s91, 3072
  buffer_load_dwordx4 v27, s[48:51], s68 offen sc1 lds
  s_add_u32 m0, s90, 13312
  s_add_u32 s68, s91, 4096
  buffer_load_dwordx4 v27, s[48:51], s68 offen sc1 lds
  s_mov_b32 s77, 0
  s_waitcnt vmcnt(10)
  s_branch Cb_POLL1
Cb_POLL:
  s_sleep 8
  v_mov_b32 v36, 20971520
  v_cndmask_b32 v38, v36, v37, s[16:17]
  buffer_load_dwordx4 v[44:47], v38, s[48:51], 0 offen offset:0 sc1
  v_cndmask_b32 v39, v36, v37, s[18:19]
  buffer_load_dwordx4 v[48:51], v39, s[48:51], 0 offen offset:256 sc1
  v_cndmask_b32 v38, v36, v37, s[20:21]
  buffer_load_dwordx4 v[52:55], v38, s[48:51], 0 offen offset:512 sc1
  v_cndmask_b32 v39, v36, v37, s[22:23]
  buffer_load_dwordx4 v[56:59], v39, s[48:51], 0 offen offset:768 sc1
  v_cndmask_b32 v38, v36, v37, s[24:25]
  buffer_load_dwordx4 v[60:63], v38, s[48:51], 0 offen offset:1024 sc1
  v_cndmask_b32 v39, v36, v37, s[26:27]
  buffer_load_dwordx4 v[64:67], v39, s[48:51], 0 offen offset:1280 sc1
  v_cndmask_b32 v38, v36, v37, s[28:29]
  buffer_load_dwordx4 v[68:71], v38, s[48:51], 0 offen offset:1536 sc1
  v_cndmask_b32 v39, v36, v37, s[30:31]
  buffer_load_dwordx4 v[72:75], v39, s[48:51], 0 offen offset:1792 sc1
  v_cndmask_b32 v38, v36, v3, s[16:17]
  buffer_load_dwordx4 v[160:163], v38, s[48:51], 0 offen offset:0 sc1
  v_cndmask_b32 v39, v36, v3, s[18:19]
  buffer_load_dwordx4 v[164:167], v39, s[48:51], 0 offen offset:256 sc1
  v_cndmask_b32 v38, v36, v3, s[20:21]
  buffer_load_dwordx4 v[168:171], v38, s[48:51], 0 offen offset:512 sc1
  v_cndmask_b32 v39, v36, v3, s[22:23]
  buffer_load_dwordx4 v[172:175], v39, s[48:51], 0 offen offset:768 sc1
  v_cndmask_b32 v38, v36, v3, s[24:25]
  buffer_load_dwordx4 v[176:179], v38, s[48:51], 0 offen offset:1024 sc1
  v_cndmask_b32 v39, v36, v3, s[26:27]
  buffer_load_dwordx4 v[180:183], v39, s[48:51], 0 offen offset:1280 sc1
  v_cndmask_b32 v38, v36, v3, s[28:29]
  buffer_load_dwordx4 v[184:187], v38, s[48:51], 0 offen offset:1536 sc1
  v_cndmask_b32 v39, v36, v3, s[30:31]
  buffer_load_dwordx4 v[188:191], v39, s[48:51], 0 offen offset:1792 sc1
  s_waitcnt vmcnt(0)
Cb_POLL1:
  v_mov_b32 v1, s6
  v_mov_b32 v36, s6
  v_mov_b32 v39, s6
  v_cndmask_b32 v45, v39, v45, s[16:17]
  v_cndmask_b32 v47, v39, v47, s[16:17]
  v_min3_u32 v1, v1, v45, v47
  v_max3_u32 v36, v36, v45, v47
  v_cndmask_b32 v49, v39, v49, s[18:19]
  v_cndmask_b32 v51, v39, v51, s[18:19]
  v_min3_u32 v1, v1, v49, v51
  v_max3_u32 v36, v36, v49, v51
  v_cndmask_b32 v53, v39, v53, s[20:21]
  v_cndmask_b32 v55, v39, v55, s[20:21]
  v_min3_u32 v1, v1, v53, v55
  v_max3_u32 v36, v36, v53, v55
  v_cndmask_b32 v57, v39, v57, s[22:23]
  v_cndmask_b32 v59, v39, v59, s[22:23]
  v_min3_u32 v1, v1, v57, v59
  v_max3_u32 v36, v36, v57, v59
  v_cndmask_b32 v61, v39, v61, s[24:25]
  v_cndmask_b32 v63, v39, v63, s[24:25]
  v_min3_u32 v1, v1, v61, v63
  v_max3_u32 v36, v36, v61, v63
  v_cndmask_b32 v65, v39, v65, s[26:27]
  v_cndmask_b32 v67, v39, v67, s[26:27]
  v_min3_u32 v1, v1, v65, v67
  v_max3_u32 v36, v36, v65, v67
  v_cndmask_b32 v69, v39, v69, s[28:29]
  v_cndmask_b32 v71, v39, v71, s[28:29]
  v_min3_u32 v1, v1, v69, v71
  v_max3_u32 v36, v36, v69, v71
  v_cndmask_b32 v73, v39, v73, s[30:31]
  v_cndmask_b32 v75, v39, v75, s[30:31]
  v_min3_u32 v1, v1, v73, v75
  v_max3_u32 v36, v36, v73, v75
  v_cndmask_b32 v161, v39, v161, s[16:17]
  v_cndmask_b32 v163, v39, v163, s[16:17]
  v_min3_u32 v1, v1, v161, v163
  v_max3_u32 v36, v36, v161, v163
  v_cndmask_b32 v165, v39, v165, s[18:19]
  v_cndmask_b32 v167, v39, v167, s[18:19]
  v_min3_u32 v1, v1, v165, v167
  v_max3_u32 v36, v36, v165, v167
  v_cndmask_b32 v169, v39, v169, s[20:21]
  v_cndmask_b32 v171, v39, v171, s[20:21]
  v_min3_u32 v1, v1, v169, v171
  v_max3_u32 v36, v36, v169, v171
  v_cndmask_b32 v173, v39, v173, s[22:23]
  v_cndmask_b32 v175, v39, v175, s[22:23]
  v_min3_u32 v1, v1, v173, v175
  v_max3_u32 v36, v36, v173, v175
  v_cndmask_b32 v177, v39, v177, s[24:25]
  v_cndmask_b32 v179, v39, v179, s[24:25]
  v_min3_u32 v1, v1, v177, v179
  v_max3_u32 v36, v36, v177, v179
  v_cndmask_b32 v181, v39, v181, s[26:27]
  v_cndmask_b32 v183, v39, v183, s[26:27]
  v_min3_u32 v1, v1, v181, v183
  v_max3_u32 v36, v36, v181, v183
  v_cndmask_b32 v185, v39, v185, s[28:29]
  v_cndmask_b32 v187, v39, v187, s[28:29]
  v_min3_u32 v1, v1, v185, v187
  v_max3_u32 v36, v36, v185, v187
  v_cndmask_b32 v189, v39, v189, s[30:31]
  v_cndmask_b32 v191, v39, v191, s[30:31]
  v_min3_u32 v1, v1, v189, v191
  v_max3_u32 v36, v36, v189, v191
  v_cmp_ne_u32 vcc, v36, v1
  s_add_u32 s77, s77, 1
  s_cmp_lt_u32 s77, 20000
  s_cselect_b64 s[12:13], -1, 0
  s_nop 1
  s_and_b64 vcc, vcc, s[12:13]
  s_cbranch_scc1 Cb_POLL
  v_and_b32 v4, 31, v0
  v_lshlrev_b32 v4, 4, v4
  s_lshl_b32 s10, s86, 9
  s_add_u32 s10, s10, 17956864
  v_mov_b32 v5, s6
  s_cmp_eq_u32 s7, 0
  s_cbranch_scc0 Cb_G0
  buffer_load_dword v5, v4, s[48:51], s10 offen sc1
Cb_G0:
  v_fma_f32 v48, v18, v44, v48
  v_fma_f32 v50, v18, v46, v50
  v_fma_f32 v48, -v19, v46, v48
  v_fma_f32 v50, v19, v44, v50
  v_fma_f32 v52, v18, v48, v52
  v_fma_f32 v54, v18, v50, v54
  v_fma_f32 v52, -v19, v50, v52
  v_fma_f32 v54, v19, v48, v54
  v_fma_f32 v56, v18, v52, v56
  v_fma_f32 v58, v18, v54, v58
  v_fma_f32 v56, -v19, v54, v56
  v_fma_f32 v58, v19, v52, v58
  v_fma_f32 v60, v18, v56, v60
  v_fma_f32 v62, v18, v58, v62
  v_fma_f32 v60, -v19, v58, v60
  v_fma_f32 v62, v19, v56, v62
  v_fma_f32 v64, v18, v60, v64
  v_fma_f32 v66, v18, v62, v66
  v_fma_f32 v64, -v19, v62, v64
  v_fma_f32 v66, v19, v60, v66
  v_fma_f32 v68, v18, v64, v68
  v_fma_f32 v70, v18, v66, v70
  v_fma_f32 v68, -v19, v66, v68
  v_fma_f32 v70, v19, v64, v70
  v_fma_f32 v72, v18, v68, v72
  v_fma_f32 v74, v18, v70, v74
  v_fma_f32 v72, -v19, v70, v72
  v_fma_f32 v74, v19, v68, v74
  v_mul_f32 v40, v20, v72
  v_mul_f32 v41, v20, v74
  v_fma_f32 v40, -v21, v74, v40
  v_fma_f32 v41, v21, v72, v41
  v_mov_b32 v42, v40
  v_mov_b32 v43, v41
  s_nop 1
  v_permlane16_swap_b32 v40, v42
  v_permlane16_swap_b32 v41, v43
  s_nop 1
  v_add_f32 v40, v40, v42
  v_add_f32 v41, v41, v43
  v_mov_b32 v42, v40
  v_mov_b32 v43, v41
  s_nop 1
  v_permlane32_swap_b32 v40, v42
  v_permlane32_swap_b32 v41, v43
  s_nop 1
  v_add_f32 v40, v40, v42
  v_add_f32 v41, v41, v43
  v_fma_f32 v42, v22, v40, v32
  v_fma_f32 v43, v22, v41, v33
  v_fma_f32 v42, -v23, v41, v42
  v_fma_f32 v43, v23, v40, v43
  v_mul_f32 v40, v24, v42
  v_mul_f32 v41, v24, v43
  v_fma_f32 v40, -v25, v43, v40
  v_fma_f32 v41, v25, v42, v41
  v_pk_fma_f32 v[96:97], v[192:193], v[40:41], v[96:97] op_sel:[0,0,0] op_sel_hi:[1,0,1]
  v_pk_fma_f32 v[112:113], v[192:193], v[40:41], v[112:113] op_sel:[0,1,0] op_sel_hi:[1,1,1]
  v_pk_fma_f32 v[96:97], v[208:209], v[40:41], v[96:97] op_sel:[0,1,0] op_sel_hi:[1,1,1] neg_lo:[1,0,0] neg_hi:[1,0,0]
  v_pk_fma_f32 v[112:113], v[208:209], v[40:41], v[112:113] op_sel:[0,0,0] op_sel_hi:[1,0,1]
  v_pk_fma_f32 v[98:99], v[194:195], v[40:41], v[98:99] op_sel:[0,0,0] op_sel_hi:[1,0,1]
  v_pk_fma_f32 v[114:115], v[194:195], v[40:41], v[114:115] op_sel:[0,1,0] op_sel_hi:[1,1,1]
  v_pk_fma_f32 v[98:99], v[210:211], v[40:41], v[98:99] op_sel:[0,1,0] op_sel_hi:[1,1,1] neg_lo:[1,0,0] neg_hi:[1,0,0]
  v_pk_fma_f32 v[114:115], v[210:211], v[40:41], v[114:115] op_sel:[0,0,0] op_sel_hi:[1,0,1]
  v_pk_fma_f32 v[100:101], v[196:197], v[40:41], v[100:101] op_sel:[0,0,0] op_sel_hi:[1,0,1]
  v_pk_fma_f32 v[116:117], v[196:197], v[40:41], v[116:117] op_sel:[0,1,0] op_sel_hi:[1,1,1]
  v_pk_fma_f32 v[100:101], v[212:213], v[40:41], v[100:101] op_sel:[0,1,0] op_sel_hi:[1,1,1] neg_lo:[1,0,0] neg_hi:[1,0,0]
  v_pk_fma_f32 v[116:117], v[212:213], v[40:41], v[116:117] op_sel:[0,0,0] op_sel_hi:[1,0,1]
  v_pk_fma_f32 v[102:103], v[198:199], v[40:41], v[102:103] op_sel:[0,0,0] op_sel_hi:[1,0,1]
  v_pk_fma_f32 v[118:119], v[198:199], v[40:41], v[118:119] op_sel:[0,1,0] op_sel_hi:[1,1,1]
  v_pk_fma_f32 v[102:103], v[214:215], v[40:41], v[102:103] op_sel:[0,1,0] op_sel_hi:[1,1,1] neg_lo:[1,0,0] neg_hi:[1,0,0]
  v_pk_fma_f32 v[118:119], v[214:215], v[40:41], v[118:119] op_sel:[0,0,0] op_sel_hi:[1,0,1]
  v_pk_fma_f32 v[104:105], v[200:201], v[40:41], v[104:105] op_sel:[0,0,0] op_sel_hi:[1,0,1]
  v_pk_fma_f32 v[120:121], v[200:201], v[40:41], v[120:121] op_sel:[0,1,0] op_sel_hi:[1,1,1]
  v_pk_fma_f32 v[104:105], v[216:217], v[40:41], v[104:105] op_sel:[0,1,0] op_sel_hi:[1,1,1] neg_lo:[1,0,0] neg_hi:[1,0,0]
  v_pk_fma_f32 v[120:121], v[216:217], v[40:41], v[120:121] op_sel:[0,0,0] op_sel_hi:[1,0,1]
  v_pk_fma_f32 v[106:107], v[202:203], v[40:41], v[106:107] op_sel:[0,0,0] op_sel_hi:[1,0,1]
  v_pk_fma_f32 v[122:123], v[202:203], v[40:41], v[122:123] op_sel:[0,1,0] op_sel_hi:[1,1,1]
  v_pk_fma_f32 v[106:107], v[218:219], v[40:41], v[106:107] op_sel:[0,1,0] op_sel_hi:[1,1,1] neg_lo:[1,0,0] neg_hi:[1,0,0]
  v_pk_fma_f32 v[122:123], v[218:219], v[40:41], v[122:123] op_sel:[0,0,0] op_sel_hi:[1,0,1]
  v_pk_fma_f32 v[108:109], v[204:205], v[40:41], v[108:109] op_sel:[0,0,0] op_sel_hi:[1,0,1]
  v_pk_fma_f32 v[124:125], v[204:205], v[40:41], v[124:125] op_sel:[0,1,0] op_sel_hi:[1,1,1]
  v_pk_fma_f32 v[108:109], v[220:221], v[40:41], v[108:109] op_sel:[0,1,0] op_sel_hi:[1,1,1] neg_lo:[1,0,0] neg_hi:[1,0,0]
  v_pk_fma_f32 v[124:125], v[220:221], v[40:41], v[124:125] op_sel:[0,0,0] op_sel_hi:[1,0,1]
  v_pk_fma_f32 v[110:111], v[206:207], v[40:41], v[110:111] op_sel:[0,0,0] op_sel_hi:[1,0,1]
  v_pk_fma_f32 v[126:127], v[206:207], v[40:41], v[126:127] op_sel:[0,1,0] op_sel_hi:[1,1,1]
  v_pk_fma_f32 v[110:111], v[222:223], v[40:41], v[110:111] op_sel:[0,1,0] op_sel_hi:[1,1,1] neg_lo:[1,0,0] neg_hi:[1,0,0]
  v_pk_fma_f32 v[126:127], v[222:223], v[40:41], v[126:127] op_sel:[0,0,0] op_sel_hi:[1,0,1]
  v_cvt_pk_bf16_f32 v44, v96, v97
  v_cvt_pk_bf16_f32 v52, -v112, -v113
  v_cvt_pk_bf16_f32 v45, v98, v99
  v_cvt_pk_bf16_f32 v53, -v114, -v115
  v_cvt_pk_bf16_f32 v46, v100, v101
  v_cvt_pk_bf16_f32 v54, -v116, -v117
  v_cvt_pk_bf16_f32 v47, v102, v103
  v_cvt_pk_bf16_f32 v55, -v118, -v119
  v_cvt_pk_bf16_f32 v48, v104, v105
  v_cvt_pk_bf16_f32 v56, -v120, -v121
  v_cvt_pk_bf16_f32 v49, v106, v107
  v_cvt_pk_bf16_f32 v57, -v122, -v123
  v_cvt_pk_bf16_f32 v50, v108, v109
  v_cvt_pk_bf16_f32 v58, -v124, -v125
  v_cvt_pk_bf16_f32 v51, v110, v111
  v_cvt_pk_bf16_f32 v59, -v126, -v127
  ds_write_b128 v34, v[44:47] offset:0
  ds_write_b128 v34, v[48:51] offset:16
  ds_write_b128 v34, v[52:55] offset:2048
  ds_write_b128 v34, v[56:59] offset:2064
  s_add_u32 s12, s8, 0
  s_lshl_b32 s12, s12, 12
  s_add_u32 s12, s12, s81
  s_cmp_eq_u32 s4, 31
  s_cselect_b32 s12, 20971520, s12
  s_waitcnt lgkmcnt(0)
  ds_read_b64_tr_b16 v[96:97], v35 offset:0
  ds_read_b64_tr_b16 v[98:99], v35 offset:128
  ds_read_b64_tr_b16 v[100:101], v35 offset:16
  ds_read_b64_tr_b16 v[102:103], v35 offset:144
  ds_read_b64_tr_b16 v[104:105], v35 offset:512
  ds_read_b64_tr_b16 v[106:107], v35 offset:640
  ds_read_b64_tr_b16 v[108:109], v35 offset:528
  ds_read_b64_tr_b16 v[110:111], v35 offset:656
  s_waitcnt lgkmcnt(6)
  buffer_store_dwordx4 v[96:99], v27, s[48:51], s12 offen offset:0 sc1
  s_waitcnt lgkmcnt(4)
  buffer_store_dwordx4 v[100:103], v27, s[48:51], s12 offen offset:1024 sc1
  s_waitcnt lgkmcnt(2)
  buffer_store_dwordx4 v[104:107], v27, s[48:51], s12 offen offset:2048 sc1
  s_waitcnt lgkmcnt(0)
  buffer_store_dwordx4 v[108:111], v27, s[48:51], s12 offen offset:3072 sc1
  v_fma_f32 v164, v244, v160, v164
  v_fma_f32 v166, v244, v162, v166
  v_fma_f32 v164, -v245, v162, v164
  v_fma_f32 v166, v245, v160, v166
  v_fma_f32 v168, v244, v164, v168
  v_fma_f32 v170, v244, v166, v170
  v_fma_f32 v168, -v245, v166, v168
  v_fma_f32 v170, v245, v164, v170
  v_fma_f32 v172, v244, v168, v172
  v_fma_f32 v174, v244, v170, v174
  v_fma_f32 v172, -v245, v170, v172
  v_fma_f32 v174, v245, v168, v174
  v_fma_f32 v176, v244, v172, v176
  v_fma_f32 v178, v244, v174, v178
  v_fma_f32 v176, -v245, v174, v176
  v_fma_f32 v178, v245, v172, v178
  v_fma_f32 v180, v244, v176, v180
  v_fma_f32 v182, v244, v178, v182
  v_fma_f32 v180, -v245, v178, v180
  v_fma_f32 v182, v245, v176, v182
  v_fma_f32 v184, v244, v180, v184
  v_fma_f32 v186, v244, v182, v186
  v_fma_f32 v184, -v245, v182, v184
  v_fma_f32 v186, v245, v180, v186
  v_fma_f32 v188, v244, v184, v188
  v_fma_f32 v190, v244, v186, v190
  v_fma_f32 v188, -v245, v186, v188
  v_fma_f32 v190, v245, v184, v190
  v_mul_f32 v40, v246, v188
  v_mul_f32 v41, v246, v190
  v_fma_f32 v40, -v247, v190, v40
  v_fma_f32 v41, v247, v188, v41
  v_mov_b32 v42, v40
  v_mov_b32 v43, v41
  s_nop 1
  v_permlane16_swap_b32 v40, v42
  v_permlane16_swap_b32 v41, v43
  s_nop 1
  v_add_f32 v40, v40, v42
  v_add_f32 v41, v41, v43
  v_mov_b32 v42, v40
  v_mov_b32 v43, v41
  s_nop 1
  v_permlane32_swap_b32 v40, v42
  v_permlane32_swap_b32 v41, v43
  s_nop 1
  v_add_f32 v40, v40, v42
  v_add_f32 v41, v41, v43
  v_fma_f32 v42, v248, v40, v252
  v_fma_f32 v43, v248, v41, v253
  v_fma_f32 v42, -v249, v41, v42
  v_fma_f32 v43, v249, v40, v43
  v_mul_f32 v40, v250, v42
  v_mul_f32 v41, v250, v43
  v_fma_f32 v40, -v251, v43, v40
  v_fma_f32 v41, v251, v42, v41
  v_fma_f32 v128, v240, v40, v128
  v_fma_f32 v144, v240, v41, v144
  v_fma_f32 v128, -v241, v41, v128
  v_fma_f32 v144, v241, v40, v144
  v_fma_f32 v129, v240, v128, v129
  v_fma_f32 v145, v240, v144, v145
  v_fma_f32 v129, -v241, v144, v129
  v_fma_f32 v145, v241, v128, v145
  v_fma_f32 v130, v240, v129, v130
  v_fma_f32 v146, v240, v145, v146
  v_fma_f32 v130, -v241, v145, v130
  v_fma_f32 v146, v241, v129, v146
  v_fma_f32 v131, v240, v130, v131
  v_fma_f32 v147, v240, v146, v147
  v_fma_f32 v131, -v241, v146, v131
  v_fma_f32 v147, v241, v130, v147
  v_fma_f32 v132, v240, v131, v132
  v_fma_f32 v148, v240, v147, v148
  v_fma_f32 v132, -v241, v147, v132
  v_fma_f32 v148, v241, v131, v148
  v_fma_f32 v133, v240, v132, v133
  v_fma_f32 v149, v240, v148, v149
  v_fma_f32 v133, -v241, v148, v133
  v_fma_f32 v149, v241, v132, v149
  v_fma_f32 v134, v240, v133, v134
  v_fma_f32 v150, v240, v149, v150
  v_fma_f32 v134, -v241, v149, v134
  v_fma_f32 v150, v241, v133, v150
  v_fma_f32 v135, v240, v134, v135
  v_fma_f32 v151, v240, v150, v151
  v_fma_f32 v135, -v241, v150, v135
  v_fma_f32 v151, v241, v134, v151
  v_fma_f32 v136, v240, v135, v136
  v_fma_f32 v152, v240, v151, v152
  v_fma_f32 v136, -v241, v151, v136
  v_fma_f32 v152, v241, v135, v152
  v_fma_f32 v137, v240, v136, v137
  v_fma_f32 v153, v240, v152, v153
  v_fma_f32 v137, -v241, v152, v137
  v_fma_f32 v153, v241, v136, v153
  v_fma_f32 v138, v240, v137, v138
  v_fma_f32 v154, v240, v153, v154
  v_fma_f32 v138, -v241, v153, v138
  v_fma_f32 v154, v241, v137, v154
  v_fma_f32 v139, v240, v138, v139
  v_fma_f32 v155, v240, v154, v155
  v_fma_f32 v139, -v241, v154, v139
  v_fma_f32 v155, v241, v138, v155
  v_fma_f32 v140, v240, v139, v140
  v_fma_f32 v156, v240, v155, v156
  v_fma_f32 v140, -v241, v155, v140
  v_fma_f32 v156, v241, v139, v156
  v_fma_f32 v141, v240, v140, v141
  v_fma_f32 v157, v240, v156, v157
  v_fma_f32 v141, -v241, v156, v141
  v_fma_f32 v157, v241, v140, v157
  v_fma_f32 v142, v240, v141, v142
  v_fma_f32 v158, v240, v157, v158
  v_fma_f32 v142, -v241, v157, v142
  v_fma_f32 v158, v241, v141, v158
  v_fma_f32 v143, v240, v142, v143
  v_fma_f32 v159, v240, v158, v159
  v_fma_f32 v143, -v241, v158, v143
  v_fma_f32 v159, v241, v142, v159
  v_cvt_pk_bf16_f32 v44, v128, v129
  v_cvt_pk_bf16_f32 v52, -v144, -v145
  v_cvt_pk_bf16_f32 v45, v130, v131
  v_cvt_pk_bf16_f32 v53, -v146, -v147
  v_cvt_pk_bf16_f32 v46, v132, v133
  v_cvt_pk_bf16_f32 v54, -v148, -v149
  v_cvt_pk_bf16_f32 v47, v134, v135
  v_cvt_pk_bf16_f32 v55, -v150, -v151
  v_cvt_pk_bf16_f32 v48, v136, v137
  v_cvt_pk_bf16_f32 v56, -v152, -v153
  v_cvt_pk_bf16_f32 v49, v138, v139
  v_cvt_pk_bf16_f32 v57, -v154, -v155
  v_cvt_pk_bf16_f32 v50, v140, v141
  v_cvt_pk_bf16_f32 v58, -v156, -v157
  v_cvt_pk_bf16_f32 v51, v142, v143
  v_cvt_pk_bf16_f32 v59, -v158, -v159
  ds_write_b128 v34, v[44:47] offset:0
  ds_write_b128 v34, v[48:51] offset:16
  ds_write_b128 v34, v[52:55] offset:2048
  ds_write_b128 v34, v[56:59] offset:2064
  s_add_u32 s12, s8, 1
  s_lshl_b32 s12, s12, 12
  s_add_u32 s12, s12, s81
  s_waitcnt lgkmcnt(0)
  ds_read_b64_tr_b16 v[128:129], v35 offset:0
  ds_read_b64_tr_b16 v[130:131], v35 offset:128
  ds_read_b64_tr_b16 v[132:133], v35 offset:16
  ds_read_b64_tr_b16 v[134:135], v35 offset:144
  ds_read_b64_tr_b16 v[136:137], v35 offset:512
  ds_read_b64_tr_b16 v[138:139], v35 offset:640
  ds_read_b64_tr_b16 v[140:141], v35 offset:528
  ds_read_b64_tr_b16 v[142:143], v35 offset:656
  s_waitcnt lgkmcnt(6)
  buffer_store_dwordx4 v[128:131], v27, s[48:51], s12 offen offset:0 sc1
  s_waitcnt lgkmcnt(4)
  buffer_store_dwordx4 v[132:135], v27, s[48:51], s12 offen offset:1024 sc1
  s_waitcnt lgkmcnt(2)
  buffer_store_dwordx4 v[136:139], v27, s[48:51], s12 offen offset:2048 sc1
  s_waitcnt lgkmcnt(0)
  buffer_store_dwordx4 v[140:143], v27, s[48:51], s12 offen offset:3072 sc1
  s_waitcnt vmcnt(8)
  v_cmp_ne_u32 vcc, s6, v5
  s_nop 4
  s_cbranch_vccz Cb_G1
  s_mov_b32 s85, 0
  s_branch Cb_GP_1
Cb_GP:
  s_sleep 16
Cb_GP_1:
  buffer_load_dword v5, v4, s[48:51], s10 offen sc1
  s_waitcnt vmcnt(0)
  v_xor_b32 v5, s6, v5
  v_cmp_ne_u32 vcc, 0, v5
  s_add_u32 s85, s85, 1
  s_cmp_lt_u32 s85, 20000
  s_cselect_b64 s[12:13], -1, 0
  s_nop 1
  s_and_b64 vcc, vcc, s[12:13]
  s_cbranch_scc1 Cb_GP
Cb_G1:
  s_barrier
  v_mov_b32 v1, s6
  s_add_u32 s94, s94, 131072
  s_waitcnt vmcnt(0)
  s_mov_b64 exec, 1
  buffer_store_dword v1, off, s[48:51], s94 sc1
  s_lshl_b32 s12, s4, 5
  s_add_u32 s12, s12, s80
  s_cmp_eq_u32 s12, 31
  s_cbranch_scc0 Cb_END
  s_mov_b32 s12, 17825792
  buffer_store_dword v1, off, s[48:51], s12 sc1
Cb_END:
  s_mov_b64 exec, -1
  s_branch P2_C
K1_HB:
  s_cmp_ge_u32 s7, 2
  s_cselect_b64 s[10:11], s[24:25], s[22:23]
  s_cselect_b64 s[12:13], s[38:39], s[36:37]
  s_mov_b32 s56, s10
  s_and_b32 s57, s11, 0xffff
  s_mov_b32 s58, 819200
  s_mov_b32 s59, 0x20000
  s_mov_b32 s60, s12
  s_and_b32 s61, s13, 0xffff
  s_mov_b32 s62, 2211840
  s_mov_b32 s63, 0x20000
  v_mul_u32_u24 v39, 1280, v36
  v_add_u32 v4, v39, v38
  s_and_b32 s10, s7, 1
  s_lshl_b32 s11, s10, 6
  v_xor_b32 v4, s11, v4
  s_lshr_b32 s11, s7, 1
  s_lshl_b32 s11, s11, 1
  v_and_b32 v38, 3, v0
  v_xor_b32 v38, s11, v38
  v_lshrrev_b32 v39, 2, v0
  v_mul_u32_u24 v39, 3456, v39
  v_lshl_add_u32 v5, v38, 4, v39
  s_lshl_b32 s71, s8, 1
  s_add_u32 s71, s71, s10
  s_mul_i32 s71, s71, 10240
  s_mul_i32 s72, s10, 110592
  s_lshl_b32 s11, s9, 5
  s_add_u32 s72, s72, s11
  s_lshl_b32 s74, s7, 10
  s_lshl_b32 s75, s7, 11
  s_mov_b32 s77, s76
  s_lshl_b32 s10, s76, 7
  s_mul_i32 s11, s76, 221184
  s_add_u32 s12, s10, s70
  s_add_u32 s10, s10, s71
  s_add_u32 s11, s11, s72
  s_add_u32 m0, s74, 32768
  s_add_u32 s13, s10, 0
  buffer_load_dwordx4 v4, s[56:59], s13 offen lds
  s_add_u32 m0, s74, 36864
  s_add_u32 s13, s10, 20480
  buffer_load_dwordx4 v4, s[56:59], s13 offen lds
  s_add_u32 m0, s75, 40960
  s_add_u32 s13, s11, 0
  buffer_load_dwordx4 v5, s[60:63], s13 offen lds
  s_add_u32 m0, s75, 41984
  s_add_u32 s13, s11, 55296
  buffer_load_dwordx4 v5, s[60:63], s13 offen lds
  s_add_u32 s76, s76, 1
  s_cmp_eq_u32 s76, 10
  s_cselect_b32 s76, 0, s76
  s_lshl_b32 s10, s76, 7
  s_mul_i32 s11, s76, 221184
  s_add_u32 s12, s10, s70
  s_add_u32 s10, s10, s71
  s_add_u32 s11, s11, s72
  s_add_u32 m0, s74, 86016
  s_add_u32 s13, s10, 0
  buffer_load_dwordx4 v4, s[56:59], s13 offen lds
  s_add_u32 m0, s74, 90112
  s_add_u32 s13, s10, 20480
  buffer_load_dwordx4 v4, s[56:59], s13 offen lds
  s_add_u32 m0, s75, 94208
  s_add_u32 s13, s11, 0
  buffer_load_dwordx4 v5, s[60:63], s13 offen lds
  s_add_u32 m0, s75, 95232
  s_add_u32 s13, s11, 55296
  buffer_load_dwordx4 v5, s[60:63], s13 offen lds
  s_add_u32 m0, s73, 53248
  s_add_u32 s13, s12, 0
  buffer_load_dwordx4 v2, s[52:55], s13 offen lds
  s_add_u32 m0, s73, 54272
  s_add_u32 s13, s12, 5120
  buffer_load_dwordx4 v3, s[52:55], s13 offen lds
  s_add_u32 m0, s73, 55296
  s_add_u32 s13, s12, 10240
  buffer_load_dwordx4 v2, s[52:55], s13 offen lds
  s_add_u32 m0, s73, 56320
  s_add_u32 s13, s12, 15360
  buffer_load_dwordx4 v3, s[52:55], s13 offen lds
  s_waitcnt lgkmcnt(0)
  s_mul_i32 s6, s6, 0x41c64e6d
  s_add_u32 s6, s6, 0x7f4a7c15
  s_and_b32 s10, s2, 7
  s_lshr_b32 s11, s2, 3
  s_lshl_b32 s86, s10, 2
  s_and_b32 s12, s11, 3
  s_add_u32 s86, s86, s12
  s_lshr_b32 s87, s11, 2
  s_mul_i32 s89, s86, 94
  s_add_u32 s89, s89, s7
  s_add_u32 s89, s89, 40
  s_lshl_b32 s89, s89, 12
  s_mul_i32 s88, s87, 94
  s_add_u32 s88, s88, s7
  s_add_u32 s88, s88, 40
  s_mul_i32 s88, s88, 5120
  s_add_u32 s88, s88, 12582912
  s_mul_i32 s90, s7, 17408
  s_cmp_eq_u32 s7, 3
  s_cselect_b32 s90, 145408, s90
  s_mul_i32 s99, s87, 0
  s_lshr_b32 s99, s99, 3
  s_and_b32 s12, s86, 3
  s_mul_i32 s12, s12, 0
  s_add_u32 s99, s99, s12
  s_cmp_ge_u32 s99, 13
  s_cselect_b32 s12, 13, 0
  s_sub_u32 s99, s99, s12
  v_and_b32 v7, 31, v0
  v_lshlrev_b32 v7, 3, v7
  s_and_b32 s78, s7, 1
  s_lshl_b32 s10, s78, 1
  v_and_b32 v36, 31, v0
  v_lshrrev_b32 v37, 5, v0
  v_bfe_u32 v38, v0, 1, 3
  v_xor_b32 v38, v38, v37
  v_lshlrev_b32 v36, 7, v36
  v_xor_b32 v39, 0, v38
  v_lshl_add_u32 v20, v39, 4, v36
  v_xor_b32 v39, 2, v38
  v_lshl_add_u32 v21, v39, 4, v36
  v_xor_b32 v39, 4, v38
  v_lshl_add_u32 v22, v39, 4, v36
  v_xor_b32 v39, 6, v38
  v_lshl_add_u32 v23, v39, 4, v36
  v_bfe_u32 v36, v0, 2, 2
  v_lshl_add_u32 v36, v37, 3, v36
  v_lshlrev_b32 v36, 6, v36
  v_bfe_u32 v38, v0, 4, 1
  v_lshl_add_u32 v36, v38, 12, v36
  v_bfe_u32 v39, v0, 1, 1
  v_lshl_add_u32 v36, v39, 3, v36
  v_add_u32 v36, 40960, v36
  v_and_b32 v39, 1, v0
  v_lshlrev_b32 v38, 1, v38
  v_xor_b32 v38, v38, v39
  v_xor_b32 v39, s10, v38
  v_lshl_add_u32 v24, v39, 4, v36
  s_and_b32 s79, s7, 1
  s_lshl_b32 s10, s79, 12
  s_add_u32 s10, s10, 32768
  v_add_u32 v20, s10, v20
  v_mov_b32 v28, 0x3f803f80
  v_add_u32 v21, s10, v21
  v_mov_b32 v29, 0x3f803f80
  v_add_u32 v22, s10, v22
  v_mov_b32 v30, 0x3f803f80
  v_add_u32 v23, s10, v23
  v_mov_b32 v31, 0x3f803f80
  s_add_u32 s78, s78, 2
  s_lshl_b32 s78, s78, 8
  s_lshl_b32 s79, s79, 8
  s_mul_i32 s80, s4, 12800
  s_add_u32 s80, s80, 16842752
  s_lshl_b32 s10, s7, 6
  v_add_u32 v32, s10, v0
  v_min_u32 v33, 127, v32
  v_lshlrev_b32 v33, 3, v33
  v_bfe_u32 v36, v0, 2, 1
  v_lshl_add_u32 v34, v36, 5, s10
  v_lshrrev_b32 v36, 5, v0
  v_lshl_add_u32 v34, v36, 4, v34
  v_bfe_u32 v36, v0, 3, 2
  v_lshl_add_u32 v34, v36, 2, v34
  v_and_b32 v36, 3, v0
  v_add_lshl_u32 v34, v34, v36, 3
  s_lshl_b32 s81, s3, 11
  s_add_u32 s81, s81, 16777216
  v_lshlrev_b32 v27, 4, v0
  v_add_u32 v25, 1024, v27
  s_mul_i32 s95, s7, 5120
  s_mov_b32 s94, 17891328
  s_lshl_b32 s10, s3, 8
  s_lshl_b32 s11, s4, 3
  s_add_u32 s10, s10, s11
  s_lshl_b32 s11, s7, 1
  s_add_u32 s10, s10, s11
  v_lshrrev_b32 v36, 5, v0
  v_add_u32 v36, s10, v36
  v_lshlrev_b32 v160, 3, v36
  v_mul_u32_u24 v36, 1280, v36
  v_and_b32 v37, 31, v0
  v_lshl_add_u32 v161, v37, 3, v36
  v_lshrrev_b32 v36, 3, v0
  v_mul_u32_u24 v185, 1280, v36
  v_and_b32 v37, 7, v0
  v_lshl_add_u32 v185, v37, 4, v185
  s_lshl_b32 s13, s7, 10
  s_add_u32 s13, s13, 159744
  v_lshl_add_u32 v186, v0, 4, s13
  s_lshl_b32 s82, s2, 2
  s_add_u32 s82, s82, s7
  s_mov_b32 s21, s82
  s_min_u32 s82, s82, 939
  s_sub_u32 s10, s82, 400
  s_cmp_lt_u32 s82, 400
  s_cselect_b32 s10, s82, s10
  s_mul_i32 s14, s10, 6554
  s_lshr_b32 s14, s14, 16
  s_mul_i32 s11, s14, 10
  s_sub_u32 s15, s10, s11
  s_lshl_b32 s83, s15, 7
  s_lshl_b32 s15, s15, 2
  s_cmp_lt_u32 s82, 400
  s_cbranch_scc0 Hb_TW
  s_mov_b32 s64, s26
  s_and_b32 s65, s27, 0xffff
  s_mov_b32 s66, 819200
  s_mov_b32 s67, 0x20000
  s_mov_b32 s16, s28
  s_and_b32 s17, s29, 0xffff
  s_mov_b32 s18, 819200
  s_mov_b32 s19, 0x20000
  s_mul_i32 s10, s14, 20480
  s_add_u32 s83, s83, s10
  s_mov_b32 s20, s83
  v_lshl_add_u32 v187, v37, 7, s13
  v_lshl_add_u32 v187, v36, 4, v187
  v_lshrrev_b32 v38, 4, v0
  v_mul_u32_u24 v188, 5120, v38
  v_and_b32 v38, 1, v36
  v_lshl_add_u32 v188, v38, 8, v188
  v_lshl_add_u32 v188, v37, 4, v188
  s_mul_i32 s84, s14, 205
  s_lshr_b32 s84, s84, 10
  s_mul_i32 s84, s84, 465
  s_mul_i32 s11, s15, 5
  s_add_u32 s84, s84, s11
  s_add_u32 s84, s84, s14
  s_lshl_b32 s84, s84, 10
  s_branch Hb_TJ
Hb_TW:
  s_mov_b32 s64, s40
  s_and_b32 s65, s41, 0xffff
  s_mov_b32 s66, 2211840
  s_mov_b32 s67, 0x20000
  s_mov_b32 s16, s40
  s_and_b32 s17, s41, 0xffff
  s_mov_b32 s18, 2211840
  s_mov_b32 s19, 0x20000
  s_mul_i32 s10, s14, 40960
  s_add_u32 s83, s83, s10
  s_add_u32 s20, s83, 20480
  v_lshrrev_b32 v38, 4, v0
  v_lshl_add_u32 v187, v38, 5, s13
  v_bfe_u32 v37, v0, 2, 2
  v_lshl_add_u32 v187, v37, 7, v187
  v_and_b32 v37, 3, v0
  v_lshl_add_u32 v187, v37, 3, v187
  v_add_u32 v38, s15, v38
  v_mul_u32_u24 v37, 205, v38
  v_lshrrev_b32 v37, 10, v37
  v_mul_u32_u24 v37, 465, v37
  v_add_lshl_u32 v37, v37, v38, 10
  v_and_b32 v38, 15, v0
  v_lshl_add_u32 v188, v38, 4, v37
  s_add_u32 s84, s14, 40
  s_mul_i32 s84, s84, 5120
Hb_TJ:
  s_add_u32 s84, s84, 12582912
  s_cmp_gt_u32 s21, 939
  s_cselect_b32 s84, 20971520, s84
  s_cselect_b32 s83, 20971520, s83
  s_cselect_b32 s20, 20971520, s20
  s_waitcnt vmcnt(8)
  s_barrier
  s_lshl_b32 s10, s76, 7
  s_mul_i32 s11, s76, 221184
  s_add_u32 s12, s10, s70
  s_add_u32 s10, s10, s71
  s_add_u32 s11, s11, s72
  s_add_u32 m0, s73, 57344
  s_add_u32 s13, s12, 20480
  buffer_load_dwordx4 v2, s[52:55], s13 offen lds
  s_add_u32 m0, s73, 58368
  s_add_u32 s13, s12, 25600
  buffer_load_dwordx4 v3, s[52:55], s13 offen lds
  s_add_u32 m0, s73, 59392
  s_add_u32 s13, s12, 30720
  buffer_load_dwordx4 v2, s[52:55], s13 offen lds
  s_add_u32 m0, s73, 60416
  s_add_u32 s13, s12, 35840
  buffer_load_dwordx4 v3, s[52:55], s13 offen lds
  s_add_u32 s76, s76, 1
  s_cmp_eq_u32 s76, 10
  s_cselect_b32 s76, 0, s76
  buffer_load_dwordx2 v[170:171], v161, s[52:55], 0 offen offset:0
  buffer_load_dwordx2 v[172:173], v161, s[52:55], 0 offen offset:256
  buffer_load_dwordx2 v[174:175], v161, s[52:55], 0 offen offset:512
  buffer_load_dwordx2 v[176:177], v161, s[52:55], 0 offen offset:768
  buffer_load_dwordx2 v[178:179], v161, s[52:55], 0 offen offset:1024
  s_lshl_b32 s10, s76, 7
  s_mul_i32 s11, s76, 221184
  s_add_u32 s12, s10, s70
  s_add_u32 s10, s10, s71
  s_add_u32 s11, s11, s72
  s_add_u32 m0, s74, 139264
  s_add_u32 s13, s10, 0
  buffer_load_dwordx4 v4, s[56:59], s13 offen lds
  s_add_u32 m0, s74, 143360
  s_add_u32 s13, s10, 20480
  buffer_load_dwordx4 v4, s[56:59], s13 offen lds
  s_add_u32 m0, s75, 147456
  s_add_u32 s13, s11, 0
  buffer_load_dwordx4 v5, s[60:63], s13 offen lds
  s_add_u32 m0, s75, 148480
  s_add_u32 s13, s11, 55296
  buffer_load_dwordx4 v5, s[60:63], s13 offen lds
  s_add_u32 m0, s73, 106496
  s_add_u32 s13, s12, 0
  buffer_load_dwordx4 v2, s[52:55], s13 offen lds
  s_add_u32 m0, s73, 107520
  s_add_u32 s13, s12, 5120
  buffer_load_dwordx4 v3, s[52:55], s13 offen lds
  s_add_u32 m0, s73, 108544
  s_add_u32 s13, s12, 10240
  buffer_load_dwordx4 v2, s[52:55], s13 offen lds
  s_add_u32 m0, s73, 109568
  s_add_u32 s13, s12, 15360
  buffer_load_dwordx4 v3, s[52:55], s13 offen lds
  s_add_u32 m0, s73, 110592
  s_add_u32 s13, s12, 20480
  buffer_load_dwordx4 v2, s[52:55], s13 offen lds
  s_add_u32 m0, s73, 111616
  s_add_u32 s13, s12, 25600
  buffer_load_dwordx4 v3, s[52:55], s13 offen lds
  s_add_u32 m0, s73, 112640
  s_add_u32 s13, s12, 30720
  buffer_load_dwordx4 v2, s[52:55], s13 offen lds
  s_add_u32 m0, s73, 113664
  s_add_u32 s13, s12, 35840
  buffer_load_dwordx4 v3, s[52:55], s13 offen lds
  s_add_u32 s76, s76, 1
  s_cmp_eq_u32 s76, 10
  s_cselect_b32 s76, 0, s76
  s_and_b32 s10, s3, 3
  s_cmp_eq_u32 s10, 0
  s_cbranch_scc0 Hb_CS0
  v_add_u32 v58, 0, v20
  v_add_u32 v59, 0, v21
  v_add_u32 v60, 0, v22
  v_add_u32 v61, 0, v23
  v_add_u32 v62, 0, v24
  ds_read_b128 v[64:67], v58
  ds_read_b64_tr_b16 v[80:81], v62 offset:0
  ds_read_b64_tr_b16 v[82:83], v62 offset:256
  ds_read_b128 v[68:71], v59
  ds_read_b64_tr_b16 v[84:85], v62 offset:1024
  ds_read_b64_tr_b16 v[86:87], v62 offset:1280
  ds_read_b128 v[72:75], v60
  ds_read_b64_tr_b16 v[88:89], v62 offset:2048
  ds_read_b64_tr_b16 v[90:91], v62 offset:2304
  ds_read_b128 v[76:79], v61
  ds_read_b64_tr_b16 v[92:93], v62 offset:3072
  ds_read_b64_tr_b16 v[94:95], v62 offset:3328
  s_add_u32 s10, s77, 0
  s_mul_i32 s10, s10, 1280
  s_add_u32 s10, s10, s80
  s_add_u32 s11, s10, s78
  s_add_u32 s10, s10, s79
  s_waitcnt lgkmcnt(0)
  v_mfma_f32_32x32x16_bf16 v[96:111], v[28:31], v[64:67], 0
  v_mfma_f32_32x32x16_bf16 v[112:127], v[28:31], v[80:83], 0
  v_mfma_f32_32x32x16_bf16 v[96:111], v[28:31], v[68:71], v[96:111]
  v_mfma_f32_32x32x16_bf16 v[112:127], v[28:31], v[84:87], v[112:127]
  v_mfma_f32_32x32x16_bf16 v[96:111], v[28:31], v[72:75], v[96:111]
  v_mfma_f32_32x32x16_bf16 v[112:127], v[28:31], v[88:91], v[112:127]
  v_mfma_f32_32x32x16_bf16 v[96:111], v[28:31], v[76:79], v[96:111]
  v_mfma_f32_32x32x16_bf16 v[112:127], v[28:31], v[92:95], v[112:127]
  s_nop 13
  v_mov_b32 v97, s6
  v_mov_b32 v113, s6
  s_mov_b32 exec_hi, 0
  buffer_store_dwordx2 v[96:97], v7, s[48:51], s10 offen sc1
  buffer_store_dwordx2 v[112:113], v7, s[48:51], s11 offen sc1
  s_mov_b32 exec_hi, -1
Hb_CS0:
  s_waitcnt vmcnt(17)
  s_barrier
  s_lshl_b32 s10, s76, 7
  s_mul_i32 s11, s76, 221184
  s_add_u32 s12, s10, s70
  s_add_u32 s10, s10, s71
  s_add_u32 s11, s11, s72
  s_add_u32 m0, s74, 32768
  s_add_u32 s13, s10, 0
  buffer_load_dwordx4 v4, s[56:59], s13 offen lds
  s_add_u32 m0, s74, 36864
  s_add_u32 s13, s10, 20480
  buffer_load_dwordx4 v4, s[56:59], s13 offen lds
  s_add_u32 m0, s75, 40960
  s_add_u32 s13, s11, 0
  buffer_load_dwordx4 v5, s[60:63], s13 offen lds
  s_add_u32 m0, s75, 41984
  s_add_u32 s13, s11, 55296
  buffer_load_dwordx4 v5, s[60:63], s13 offen lds
  s_add_u32 m0, s73, 0
  s_add_u32 s13, s12, 0
  buffer_load_dwordx4 v2, s[52:55], s13 offen lds
  s_add_u32 m0, s73, 1024
  s_add_u32 s13, s12, 5120
  buffer_load_dwordx4 v3, s[52:55], s13 offen lds
  s_add_u32 m0, s73, 2048
  s_add_u32 s13, s12, 10240
  buffer_load_dwordx4 v2, s[52:55], s13 offen lds
  s_add_u32 m0, s73, 3072
  s_add_u32 s13, s12, 15360
  buffer_load_dwordx4 v3, s[52:55], s13 offen lds
  s_add_u32 m0, s73, 4096
  s_add_u32 s13, s12, 20480
  buffer_load_dwordx4 v2, s[52:55], s13 offen lds
  s_add_u32 m0, s73, 5120
  s_add_u32 s13, s12, 25600
  buffer_load_dwordx4 v3, s[52:55], s13 offen lds
  s_add_u32 m0, s73, 6144
  s_add_u32 s13, s12, 30720
  buffer_load_dwordx4 v2, s[52:55], s13 offen lds
  s_add_u32 m0, s73, 7168
  s_add_u32 s13, s12, 35840
  buffer_load_dwordx4 v3, s[52:55], s13 offen lds
  s_add_u32 s76, s76, 1
  s_cmp_eq_u32 s76, 10
  s_cselect_b32 s76, 0, s76
  s_and_b32 s10, s3, 3
  s_cmp_eq_u32 s10, 1
  s_cbranch_scc0 Hb_CS1
  v_add_u32 v58, 53248, v20
  v_add_u32 v59, 53248, v21
  v_add_u32 v60, 53248, v22
  v_add_u32 v61, 53248, v23
  v_add_u32 v62, 53248, v24
  ds_read_b128 v[64:67], v58
  ds_read_b64_tr_b16 v[80:81], v62 offset:0
  ds_read_b64_tr_b16 v[82:83], v62 offset:256
  ds_read_b128 v[68:71], v59
  ds_read_b64_tr_b16 v[84:85], v62 offset:1024
  ds_read_b64_tr_b16 v[86:87], v62 offset:1280
  ds_read_b128 v[72:75], v60
  ds_read_b64_tr_b16 v[88:89], v62 offset:2048
  ds_read_b64_tr_b16 v[90:91], v62 offset:2304
  ds_read_b128 v[76:79], v61
  ds_read_b64_tr_b16 v[92:93], v62 offset:3072
  ds_read_b64_tr_b16 v[94:95], v62 offset:3328
  s_add_u32 s10, s77, 1
  s_mul_i32 s10, s10, 1280
  s_add_u32 s10, s10, s80
  s_add_u32 s11, s10, s78
  s_add_u32 s10, s10, s79
  s_waitcnt lgkmcnt(0)
  v_mfma_f32_32x32x16_bf16 v[96:111], v[28:31], v[64:67], 0
  v_mfma_f32_32x32x16_bf16 v[112:127], v[28:31], v[80:83], 0
  v_mfma_f32_32x32x16_bf16 v[96:111], v[28:31], v[68:71], v[96:111]
  v_mfma_f32_32x32x16_bf16 v[112:127], v[28:31], v[84:87], v[112:127]
  v_mfma_f32_32x32x16_bf16 v[96:111], v[28:31], v[72:75], v[96:111]
  v_mfma_f32_32x32x16_bf16 v[112:127], v[28:31], v[88:91], v[112:127]
  v_mfma_f32_32x32x16_bf16 v[96:111], v[28:31], v[76:79], v[96:111]
  v_mfma_f32_32x32x16_bf16 v[112:127], v[28:31], v[92:95], v[112:127]
  s_nop 13
  v_mov_b32 v97, s6
  v_mov_b32 v113, s6
  s_mov_b32 exec_hi, 0
  buffer_store_dwordx2 v[96:97], v7, s[48:51], s10 offen sc1
  buffer_store_dwordx2 v[112:113], v7, s[48:51], s11 offen sc1
  s_mov_b32 exec_hi, -1
Hb_CS1:
  s_waitcnt vmcnt(24)
  v_lshlrev_b32 v210, 16, v170
  v_and_b32 v211, 0xffff0000, v170
  v_lshlrev_b32 v212, 16, v171
  v_and_b32 v213, 0xffff0000, v171
  v_lshlrev_b32 v214, 16, v172
  v_and_b32 v215, 0xffff0000, v172
  v_lshlrev_b32 v216, 16, v173
  v_and_b32 v217, 0xffff0000, v173
  v_lshlrev_b32 v218, 16, v174
  v_and_b32 v219, 0xffff0000, v174
  v_lshlrev_b32 v220, 16, v175
  v_and_b32 v221, 0xffff0000, v175
  v_lshlrev_b32 v222, 16, v176
  v_and_b32 v223, 0xffff0000, v176
  v_lshlrev_b32 v224, 16, v177
  v_and_b32 v225, 0xffff0000, v177
  v_lshlrev_b32 v226, 16, v178
  v_and_b32 v227, 0xffff0000, v178
  v_lshlrev_b32 v228, 16, v179
  v_and_b32 v229, 0xffff0000, v179
  v_add_f32 v162, v210, v211
  v_add_f32 v162, v162, v212
  v_add_f32 v162, v162, v213
  v_add_f32 v162, v162, v214
  v_add_f32 v162, v162, v215
  v_add_f32 v162, v162, v216
  v_add_f32 v162, v162, v217
  v_add_f32 v162, v162, v218
  v_add_f32 v162, v162, v219
  v_add_f32 v162, v162, v220
  v_add_f32 v162, v162, v221
  v_add_f32 v162, v162, v222
  v_add_f32 v162, v162, v223
  v_add_f32 v162, v162, v224
  v_add_f32 v162, v162, v225
  v_add_f32 v162, v162, v226
  v_add_f32 v162, v162, v227
  v_add_f32 v162, v162, v228
  v_add_f32 v162, v162, v229
  s_nop 1
  v_add_f32_dpp v162, v162, v162 row_ror:8 row_mask:0xf bank_mask:0xf
  s_nop 1
  v_add_f32_dpp v162, v162, v162 row_ror:4 row_mask:0xf bank_mask:0xf
  s_nop 1
  v_add_f32_dpp v162, v162, v162 row_ror:2 row_mask:0xf bank_mask:0xf
  s_nop 1
  v_add_f32_dpp v162, v162, v162 row_ror:1 row_mask:0xf bank_mask:0xf
  v_mov_b32 v163, v162
  s_nop 1
  v_permlane16_swap_b32 v162, v163
  s_nop 1
  v_add_f32 v162, v162, v163
  v_mul_f32 v162, 0x3acccccd, v162
  v_mov_b32 v164, 0
  v_sub_f32 v210, v210, v162
  v_fmac_f32 v164, v210, v210
  v_sub_f32 v211, v211, v162
  v_fmac_f32 v164, v211, v211
  v_sub_f32 v212, v212, v162
  v_fmac_f32 v164, v212, v212
  v_sub_f32 v213, v213, v162
  v_fmac_f32 v164, v213, v213
  v_sub_f32 v214, v214, v162
  v_fmac_f32 v164, v214, v214
  v_sub_f32 v215, v215, v162
  v_fmac_f32 v164, v215, v215
  v_sub_f32 v216, v216, v162
  v_fmac_f32 v164, v216, v216
  v_sub_f32 v217, v217, v162
  v_fmac_f32 v164, v217, v217
  v_sub_f32 v218, v218, v162
  v_fmac_f32 v164, v218, v218
  v_sub_f32 v219, v219, v162
  v_fmac_f32 v164, v219, v219
  v_sub_f32 v220, v220, v162
  v_fmac_f32 v164, v220, v220
  v_sub_f32 v221, v221, v162
  v_fmac_f32 v164, v221, v221
  v_sub_f32 v222, v222, v162
  v_fmac_f32 v164, v222, v222
  v_sub_f32 v223, v223, v162
  v_fmac_f32 v164, v223, v223
  v_sub_f32 v224, v224, v162
  v_fmac_f32 v164, v224, v224
  v_sub_f32 v225, v225, v162
  v_fmac_f32 v164, v225, v225
  v_sub_f32 v226, v226, v162
  v_fmac_f32 v164, v226, v226
  v_sub_f32 v227, v227, v162
  v_fmac_f32 v164, v227, v227
  v_sub_f32 v228, v228, v162
  v_fmac_f32 v164, v228, v228
  v_sub_f32 v229, v229, v162
  v_fmac_f32 v164, v229, v229
  s_nop 1
  v_add_f32_dpp v164, v164, v164 row_ror:8 row_mask:0xf bank_mask:0xf
  s_nop 1
  v_add_f32_dpp v164, v164, v164 row_ror:4 row_mask:0xf bank_mask:0xf
  s_nop 1
  v_add_f32_dpp v164, v164, v164 row_ror:2 row_mask:0xf bank_mask:0xf
  s_nop 1
  v_add_f32_dpp v164, v164, v164 row_ror:1 row_mask:0xf bank_mask:0xf
  v_mov_b32 v163, v164
  s_nop 1
  v_permlane16_swap_b32 v164, v163
  s_nop 1
  v_add_f32 v164, v164, v163
  v_mul_f32 v164, 0x3acccccd, v164
  v_cvt_pk_bf16_f32 v164, v164, v164
  v_lshlrev_b32 v164, 16, v164
  v_add_f32 v164, 0x3727c5ac, v164
  v_cvt_pk_bf16_f32 v164, v164, v164
  v_lshlrev_b32 v164, 16, v164
  v_sqrt_f32 v164, v164
  v_mov_b32 v163, s6
  v_cvt_pk_bf16_f32 v162, v162, v164
  s_mov_b32 s10, 16777216
  s_mov_b32 exec_lo, 1
  s_mov_b32 exec_hi, 1
  buffer_store_dwordx2 v[162:163], v160, s[48:51], s10 offen sc1
  s_mov_b64 exec, -1
  s_waitcnt vmcnt(13)
  s_barrier
  s_add_u32 s13, s83, 0
  buffer_load_dwordx4 v[192:195], v185, s[64:67], s13 offen
  s_add_u32 s13, s83, 10240
  buffer_load_dwordx4 v[196:199], v185, s[64:67], s13 offen
  s_add_u32 s13, s20, 0
  buffer_load_dwordx4 v[200:203], v185, s[16:19], s13 offen
  s_add_u32 s13, s20, 10240
  buffer_load_dwordx4 v[204:207], v185, s[16:19], s13 offen
  s_lshl_b32 s10, s76, 7
  s_mul_i32 s11, s76, 221184
  s_add_u32 s12, s10, s70
  s_add_u32 s10, s10, s71
  s_add_u32 s11, s11, s72
  s_add_u32 m0, s74, 86016
  s_add_u32 s13, s10, 0
  buffer_load_dwordx4 v4, s[56:59], s13 offen lds
  s_add_u32 m0, s74, 90112
  s_add_u32 s13, s10, 20480
  buffer_load_dwordx4 v4, s[56:59], s13 offen lds
  s_add_u32 m0, s75, 94208
  s_add_u32 s13, s11, 0
  buffer_load_dwordx4 v5, s[60:63], s13 offen lds
  s_add_u32 m0, s75, 95232
  s_add_u32 s13, s11, 55296
  buffer_load_dwordx4 v5, s[60:63], s13 offen lds
  s_add_u32 m0, s73, 53248
  s_add_u32 s13, s12, 0
  buffer_load_dwordx4 v2, s[52:55], s13 offen lds
  s_add_u32 m0, s73, 54272
  s_add_u32 s13, s12, 5120
  buffer_load_dwordx4 v3, s[52:55], s13 offen lds
  s_add_u32 m0, s73, 55296
  s_add_u32 s13, s12, 10240
  buffer_load_dwordx4 v2, s[52:55], s13 offen lds
  s_add_u32 m0, s73, 56320
  s_add_u32 s13, s12, 15360
  buffer_load_dwordx4 v3, s[52:55], s13 offen lds
  s_add_u32 m0, s73, 57344
  s_add_u32 s13, s12, 20480
  buffer_load_dwordx4 v2, s[52:55], s13 offen lds
  s_add_u32 m0, s73, 58368
  s_add_u32 s13, s12, 25600
  buffer_load_dwordx4 v3, s[52:55], s13 offen lds
  s_add_u32 m0, s73, 59392
  s_add_u32 s13, s12, 30720
  buffer_load_dwordx4 v2, s[52:55], s13 offen lds
  s_add_u32 m0, s73, 60416
  s_add_u32 s13, s12, 35840
  buffer_load_dwordx4 v3, s[52:55], s13 offen lds
  s_add_u32 s76, s76, 1
  s_cmp_eq_u32 s76, 10
  s_cselect_b32 s76, 0, s76
  s_and_b32 s10, s3, 3
  s_cmp_eq_u32 s10, 2
  s_cbranch_scc0 Hb_CS2
  v_add_u32 v58, 106496, v20
  v_add_u32 v59, 106496, v21
  v_add_u32 v60, 106496, v22
  v_add_u32 v61, 106496, v23
  v_add_u32 v62, 106496, v24
  ds_read_b128 v[64:67], v58
  ds_read_b64_tr_b16 v[80:81], v62 offset:0
  ds_read_b64_tr_b16 v[82:83], v62 offset:256
  ds_read_b128 v[68:71], v59
  ds_read_b64_tr_b16 v[84:85], v62 offset:1024
  ds_read_b64_tr_b16 v[86:87], v62 offset:1280
  ds_read_b128 v[72:75], v60
  ds_read_b64_tr_b16 v[88:89], v62 offset:2048
  ds_read_b64_tr_b16 v[90:91], v62 offset:2304
  ds_read_b128 v[76:79], v61
  ds_read_b64_tr_b16 v[92:93], v62 offset:3072
  ds_read_b64_tr_b16 v[94:95], v62 offset:3328
  s_add_u32 s10, s77, 2
  s_mul_i32 s10, s10, 1280
  s_add_u32 s10, s10, s80
  s_add_u32 s11, s10, s78
  s_add_u32 s10, s10, s79
  s_waitcnt lgkmcnt(0)
  v_mfma_f32_32x32x16_bf16 v[96:111], v[28:31], v[64:67], 0
  v_mfma_f32_32x32x16_bf16 v[112:127], v[28:31], v[80:83], 0
  v_mfma_f32_32x32x16_bf16 v[96:111], v[28:31], v[68:71], v[96:111]
  v_mfma_f32_32x32x16_bf16 v[112:127], v[28:31], v[84:87], v[112:127]
  v_mfma_f32_32x32x16_bf16 v[96:111], v[28:31], v[72:75], v[96:111]
  v_mfma_f32_32x32x16_bf16 v[112:127], v[28:31], v[88:91], v[112:127]
  v_mfma_f32_32x32x16_bf16 v[96:111], v[28:31], v[76:79], v[96:111]
  v_mfma_f32_32x32x16_bf16 v[112:127], v[28:31], v[92:95], v[112:127]
  s_nop 13
  v_mov_b32 v97, s6
  v_mov_b32 v113, s6
  s_mov_b32 exec_hi, 0
  buffer_store_dwordx2 v[96:97], v7, s[48:51], s10 offen sc1
  buffer_store_dwordx2 v[112:113], v7, s[48:51], s11 offen sc1
  s_mov_b32 exec_hi, -1
Hb_CS2:
  s_waitcnt vmcnt(17)
  s_barrier
  s_lshl_b32 s10, s76, 7
  s_mul_i32 s11, s76, 221184
  s_add_u32 s12, s10, s70
  s_add_u32 s10, s10, s71
  s_add_u32 s11, s11, s72
  s_add_u32 m0, s74, 139264
  s_add_u32 s13, s10, 0
  buffer_load_dwordx4 v4, s[56:59], s13 offen lds
  s_add_u32 m0, s74, 143360
  s_add_u32 s13, s10, 20480
  buffer_load_dwordx4 v4, s[56:59], s13 offen lds
  s_add_u32 m0, s75, 147456
  s_add_u32 s13, s11, 0
  buffer_load_dwordx4 v5, s[60:63], s13 offen lds
  s_add_u32 m0, s75, 148480
  s_add_u32 s13, s11, 55296
  buffer_load_dwordx4 v5, s[60:63], s13 offen lds
  s_add_u32 m0, s73, 106496
  s_add_u32 s13, s12, 0
  buffer_load_dwordx4 v2, s[52:55], s13 offen lds
  s_add_u32 m0, s73, 107520
  s_add_u32 s13, s12, 5120
  buffer_load_dwordx4 v3, s[52:55], s13 offen lds
  s_add_u32 m0, s73, 108544
  s_add_u32 s13, s12, 10240
  buffer_load_dwordx4 v2, s[52:55], s13 offen lds
  s_add_u32 m0, s73, 109568
  s_add_u32 s13, s12, 15360
  buffer_load_dwordx4 v3, s[52:55], s13 offen lds
  s_add_u32 m0, s73, 110592
  s_add_u32 s13, s12, 20480
  buffer_load_dwordx4 v2, s[52:55], s13 offen lds
  s_add_u32 m0, s73, 111616
  s_add_u32 s13, s12, 25600
  buffer_load_dwordx4 v3, s[52:55], s13 offen lds
  s_add_u32 m0, s73, 112640
  s_add_u32 s13, s12, 30720
  buffer_load_dwordx4 v2, s[52:55], s13 offen lds
  s_add_u32 m0, s73, 113664
  s_add_u32 s13, s12, 35840
  buffer_load_dwordx4 v3, s[52:55], s13 offen lds
  s_add_u32 s76, s76, 1
  s_cmp_eq_u32 s76, 10
  s_cselect_b32 s76, 0, s76
  s_and_b32 s10, s3, 3
  s_cmp_eq_u32 s10, 3
  s_cbranch_scc0 Hb_CS3
  v_add_u32 v58, 0, v20
  v_add_u32 v59, 0, v21
  v_add_u32 v60, 0, v22
  v_add_u32 v61, 0, v23
  v_add_u32 v62, 0, v24
  ds_read_b128 v[64:67], v58
  ds_read_b64_tr_b16 v[80:81], v62 offset:0
  ds_read_b64_tr_b16 v[82:83], v62 offset:256
  ds_read_b128 v[68:71], v59
  ds_read_b64_tr_b16 v[84:85], v62 offset:1024
  ds_read_b64_tr_b16 v[86:87], v62 offset:1280
  ds_read_b128 v[72:75], v60
  ds_read_b64_tr_b16 v[88:89], v62 offset:2048
  ds_read_b64_tr_b16 v[90:91], v62 offset:2304
  ds_read_b128 v[76:79], v61
  ds_read_b64_tr_b16 v[92:93], v62 offset:3072
  ds_read_b64_tr_b16 v[94:95], v62 offset:3328
  s_add_u32 s10, s77, 3
  s_mul_i32 s10, s10, 1280
  s_add_u32 s10, s10, s80
  s_add_u32 s11, s10, s78
  s_add_u32 s10, s10, s79
  s_waitcnt lgkmcnt(0)
  v_mfma_f32_32x32x16_bf16 v[96:111], v[28:31], v[64:67], 0
  v_mfma_f32_32x32x16_bf16 v[112:127], v[28:31], v[80:83], 0
  v_mfma_f32_32x32x16_bf16 v[96:111], v[28:31], v[68:71], v[96:111]
  v_mfma_f32_32x32x16_bf16 v[112:127], v[28:31], v[84:87], v[112:127]
  v_mfma_f32_32x32x16_bf16 v[96:111], v[28:31], v[72:75], v[96:111]
  v_mfma_f32_32x32x16_bf16 v[112:127], v[28:31], v[88:91], v[112:127]
  v_mfma_f32_32x32x16_bf16 v[96:111], v[28:31], v[76:79], v[96:111]
  v_mfma_f32_32x32x16_bf16 v[112:127], v[28:31], v[92:95], v[112:127]
  s_nop 13
  v_mov_b32 v97, s6
  v_mov_b32 v113, s6
  s_mov_b32 exec_hi, 0
  buffer_store_dwordx2 v[96:97], v7, s[48:51], s10 offen sc1
  buffer_store_dwordx2 v[112:113], v7, s[48:51], s11 offen sc1
  s_mov_b32 exec_hi, -1
Hb_CS3:
  s_waitcnt vmcnt(24)
  s_cmp_lt_u32 s82, 400
  s_cbranch_scc0 Hb_T0W
  ds_write_b128 v186, v[192:195]
  ds_read_b128 v[192:195], v187
  ds_write_b128 v186, v[196:199]
  ds_read_b128 v[196:199], v187
  ds_write_b128 v186, v[200:203]
  ds_read_b128 v[200:203], v187
  ds_write_b128 v186, v[204:207]
  ds_read_b128 v[204:207], v187
  s_waitcnt lgkmcnt(0)
  buffer_store_dwordx4 v[192:195], v188, s[48:51], s84 offen offset:0 sc1
  buffer_store_dwordx4 v[196:199], v188, s[48:51], s84 offen offset:128 sc1
  buffer_store_dwordx4 v[200:203], v188, s[48:51], s84 offen offset:512 sc1
  buffer_store_dwordx4 v[204:207], v188, s[48:51], s84 offen offset:640 sc1
  s_branch Hb_T0E
Hb_T0W:
  ds_write_b128 v186, v[192:195]
  ds_read_b64_tr_b16 v[192:193], v187
  ds_read_b64_tr_b16 v[194:195], v187 offset:512
  ds_write_b128 v186, v[196:199]
  ds_read_b64_tr_b16 v[196:197], v187
  ds_read_b64_tr_b16 v[198:199], v187 offset:512
  ds_write_b128 v186, v[200:203]
  ds_read_b64_tr_b16 v[200:201], v187
  ds_read_b64_tr_b16 v[202:203], v187 offset:512
  ds_write_b128 v186, v[204:207]
  ds_read_b64_tr_b16 v[204:205], v187
  ds_read_b64_tr_b16 v[206:207], v187 offset:512
  s_waitcnt lgkmcnt(0)
  buffer_store_dwordx4 v[192:195], v188, s[48:51], s84 offen offset:0 sc1
  buffer_store_dwordx4 v[196:199], v188, s[48:51], s84 offen offset:256 sc1
  buffer_store_dwordx4 v[200:203], v188, s[48:51], s84 offen offset:512 sc1
  buffer_store_dwordx4 v[204:207], v188, s[48:51], s84 offen offset:768 sc1
Hb_T0E:
  s_waitcnt vmcnt(16)
  s_barrier
  s_lshl_b32 s10, s76, 7
  s_mul_i32 s11, s76, 221184
  s_add_u32 s12, s10, s70
  s_add_u32 s10, s10, s71
  s_add_u32 s11, s11, s72
  s_add_u32 m0, s74, 32768
  s_add_u32 s13, s10, 0
  buffer_load_dwordx4 v4, s[56:59], s13 offen lds
  s_add_u32 m0, s74, 36864
  s_add_u32 s13, s10, 20480
  buffer_load_dwordx4 v4, s[56:59], s13 offen lds
  s_add_u32 m0, s75, 40960
  s_add_u32 s13, s11, 0
  buffer_load_dwordx4 v5, s[60:63], s13 offen lds
  s_add_u32 m0, s75, 41984
  s_add_u32 s13, s11, 55296
  buffer_load_dwordx4 v5, s[60:63], s13 offen lds
  s_add_u32 m0, s73, 0
  s_add_u32 s13, s12, 0
  buffer_load_dwordx4 v2, s[52:55], s13 offen lds
  s_add_u32 m0, s73, 1024
  s_add_u32 s13, s12, 5120
  buffer_load_dwordx4 v3, s[52:55], s13 offen lds
  s_add_u32 m0, s73, 2048
  s_add_u32 s13, s12, 10240
  buffer_load_dwordx4 v2, s[52:55], s13 offen lds
  s_add_u32 m0, s73, 3072
  s_add_u32 s13, s12, 15360
  buffer_load_dwordx4 v3, s[52:55], s13 offen lds
  s_add_u32 m0, s73, 4096
  s_add_u32 s13, s12, 20480
  buffer_load_dwordx4 v2, s[52:55], s13 offen lds
  s_add_u32 m0, s73, 5120
  s_add_u32 s13, s12, 25600
  buffer_load_dwordx4 v3, s[52:55], s13 offen lds
  s_add_u32 m0, s73, 6144
  s_add_u32 s13, s12, 30720
  buffer_load_dwordx4 v2, s[52:55], s13 offen lds
  s_add_u32 m0, s73, 7168
  s_add_u32 s13, s12, 35840
  buffer_load_dwordx4 v3, s[52:55], s13 offen lds
  s_add_u32 s76, s76, 1
  s_cmp_eq_u32 s76, 10
  s_cselect_b32 s76, 0, s76
  s_and_b32 s10, s3, 3
  s_cmp_eq_u32 s10, 0
  s_cbranch_scc0 Hb_CS4
  v_add_u32 v58, 53248, v20
  v_add_u32 v59, 53248, v21
  v_add_u32 v60, 53248, v22
  v_add_u32 v61, 53248, v23
  v_add_u32 v62, 53248, v24
  ds_read_b128 v[64:67], v58
  ds_read_b64_tr_b16 v[80:81], v62 offset:0
  ds_read_b64_tr_b16 v[82:83], v62 offset:256
  ds_read_b128 v[68:71], v59
  ds_read_b64_tr_b16 v[84:85], v62 offset:1024
  ds_read_b64_tr_b16 v[86:87], v62 offset:1280
  ds_read_b128 v[72:75], v60
  ds_read_b64_tr_b16 v[88:89], v62 offset:2048
  ds_read_b64_tr_b16 v[90:91], v62 offset:2304
  ds_read_b128 v[76:79], v61
  ds_read_b64_tr_b16 v[92:93], v62 offset:3072
  ds_read_b64_tr_b16 v[94:95], v62 offset:3328
  s_add_u32 s10, s77, 4
  s_mul_i32 s10, s10, 1280
  s_add_u32 s10, s10, s80
  s_add_u32 s11, s10, s78
  s_add_u32 s10, s10, s79
  s_waitcnt lgkmcnt(0)
  v_mfma_f32_32x32x16_bf16 v[96:111], v[28:31], v[64:67], 0
  v_mfma_f32_32x32x16_bf16 v[112:127], v[28:31], v[80:83], 0
  v_mfma_f32_32x32x16_bf16 v[96:111], v[28:31], v[68:71], v[96:111]
  v_mfma_f32_32x32x16_bf16 v[112:127], v[28:31], v[84:87], v[112:127]
  v_mfma_f32_32x32x16_bf16 v[96:111], v[28:31], v[72:75], v[96:111]
  v_mfma_f32_32x32x16_bf16 v[112:127], v[28:31], v[88:91], v[112:127]
  v_mfma_f32_32x32x16_bf16 v[96:111], v[28:31], v[76:79], v[96:111]
  v_mfma_f32_32x32x16_bf16 v[112:127], v[28:31], v[92:95], v[112:127]
  s_nop 13
  v_mov_b32 v97, s6
  v_mov_b32 v113, s6
  s_mov_b32 exec_hi, 0
  buffer_store_dwordx2 v[96:97], v7, s[48:51], s10 offen sc1
  buffer_store_dwordx2 v[112:113], v7, s[48:51], s11 offen sc1
  s_mov_b32 exec_hi, -1
Hb_CS4:
  s_waitcnt vmcnt(12)
  s_barrier
  s_cmp_eq_u32 s7, 0
  s_cbranch_scc0 Hb_NF
  s_lshl_b32 s10, s2, 2
  s_add_u32 s10, s10, s94
  v_mov_b32 v1, s6
  s_mov_b64 exec, 1
  buffer_store_dword v1, off, s[48:51], s10 sc1
  s_mov_b64 exec, -1
Hb_NF:
  s_lshl_b32 s10, s76, 7
  s_mul_i32 s11, s76, 221184
  s_add_u32 s12, s10, s70
  s_add_u32 s10, s10, s71
  s_add_u32 s11, s11, s72
  s_add_u32 m0, s74, 86016
  s_add_u32 s13, s10, 0
  buffer_load_dwordx4 v4, s[56:59], s13 offen lds
  s_add_u32 m0, s74, 90112
  s_add_u32 s13, s10, 20480
  buffer_load_dwordx4 v4, s[56:59], s13 offen lds
  s_add_u32 m0, s75, 94208
  s_add_u32 s13, s11, 0
  buffer_load_dwordx4 v5, s[60:63], s13 offen lds
  s_add_u32 m0, s75, 95232
  s_add_u32 s13, s11, 55296
  buffer_load_dwordx4 v5, s[60:63], s13 offen lds
  s_add_u32 m0, s73, 53248
  s_add_u32 s13, s12, 0
  buffer_load_dwordx4 v2, s[52:55], s13 offen lds
  s_add_u32 m0, s73, 54272
  s_add_u32 s13, s12, 5120
  buffer_load_dwordx4 v3, s[52:55], s13 offen lds
  s_add_u32 m0, s73, 55296
  s_add_u32 s13, s12, 10240
  buffer_load_dwordx4 v2, s[52:55], s13 offen lds
  s_add_u32 m0, s73, 56320
  s_add_u32 s13, s12, 15360
  buffer_load_dwordx4 v3, s[52:55], s13 offen lds
  s_add_u32 m0, s73, 57344
  s_add_u32 s13, s12, 20480
  buffer_load_dwordx4 v2, s[52:55], s13 offen lds
  s_add_u32 m0, s73, 58368
  s_add_u32 s13, s12, 25600
  buffer_load_dwordx4 v3, s[52:55], s13 offen lds
  s_add_u32 m0, s73, 59392
  s_add_u32 s13, s12, 30720
  buffer_load_dwordx4 v2, s[52:55], s13 offen lds
  s_add_u32 m0, s73, 60416
  s_add_u32 s13, s12, 35840
  buffer_load_dwordx4 v3, s[52:55], s13 offen lds
  s_add_u32 s76, s76, 1
  s_cmp_eq_u32 s76, 10
  s_cselect_b32 s76, 0, s76
  s_waitcnt vmcnt(12)
  s_barrier
  s_lshl_b32 s10, s76, 7
  s_mul_i32 s11, s76, 221184
  s_add_u32 s12, s10, s70
  s_add_u32 s10, s10, s71
  s_add_u32 s11, s11, s72
  s_add_u32 m0, s74, 139264
  s_add_u32 s13, s10, 0
  buffer_load_dwordx4 v4, s[56:59], s13 offen lds
  s_add_u32 m0, s74, 143360
  s_add_u32 s13, s10, 20480
  buffer_load_dwordx4 v4, s[56:59], s13 offen lds
  s_add_u32 m0, s75, 147456
  s_add_u32 s13, s11, 0
  buffer_load_dwordx4 v5, s[60:63], s13 offen lds
  s_add_u32 m0, s75, 148480
  s_add_u32 s13, s11, 55296
  buffer_load_dwordx4 v5, s[60:63], s13 offen lds
  s_add_u32 m0, s73, 106496
  s_add_u32 s13, s12, 0
  buffer_load_dwordx4 v2, s[52:55], s13 offen lds
  s_add_u32 m0, s73, 107520
  s_add_u32 s13, s12, 5120
  buffer_load_dwordx4 v3, s[52:55], s13 offen lds
  s_add_u32 m0, s73, 108544
  s_add_u32 s13, s12, 10240
  buffer_load_dwordx4 v2, s[52:55], s13 offen lds
  s_add_u32 m0, s73, 109568
  s_add_u32 s13, s12, 15360
  buffer_load_dwordx4 v3, s[52:55], s13 offen lds
  s_add_u32 m0, s73, 110592
  s_add_u32 s13, s12, 20480
  buffer_load_dwordx4 v2, s[52:55], s13 offen lds
  s_add_u32 m0, s73, 111616
  s_add_u32 s13, s12, 25600
  buffer_load_dwordx4 v3, s[52:55], s13 offen lds
  s_add_u32 m0, s73, 112640
  s_add_u32 s13, s12, 30720
  buffer_load_dwordx4 v2, s[52:55], s13 offen lds
  s_add_u32 m0, s73, 113664
  s_add_u32 s13, s12, 35840
  buffer_load_dwordx4 v3, s[52:55], s13 offen lds
  s_add_u32 s76, s76, 1
  s_cmp_eq_u32 s76, 10
  s_cselect_b32 s76, 0, s76
  s_add_u32 s10, s80, 0
  buffer_load_dwordx2 v[42:43], v33, s[48:51], s10 offen sc1
  s_add_u32 s10, s80, 1280
  buffer_load_dwordx2 v[44:45], v33, s[48:51], s10 offen sc1
  s_add_u32 s10, s80, 2560
  buffer_load_dwordx2 v[46:47], v33, s[48:51], s10 offen sc1
  s_add_u32 s10, s80, 3840
  buffer_load_dwordx2 v[48:49], v33, s[48:51], s10 offen sc1
  s_add_u32 s10, s80, 5120
  buffer_load_dwordx2 v[50:51], v33, s[48:51], s10 offen sc1
  s_add_u32 s10, s80, 6400
  buffer_load_dwordx2 v[52:53], v33, s[48:51], s10 offen sc1
  s_add_u32 s10, s80, 7680
  buffer_load_dwordx2 v[54:55], v33, s[48:51], s10 offen sc1
  s_add_u32 s10, s80, 8960
  buffer_load_dwordx2 v[56:57], v33, s[48:51], s10 offen sc1
  s_add_u32 s10, s80, 10240
  buffer_load_dwordx2 v[58:59], v33, s[48:51], s10 offen sc1
  s_add_u32 s10, s80, 11520
  buffer_load_dwordx2 v[60:61], v33, s[48:51], s10 offen sc1
  buffer_load_dwordx2 v[40:41], v34, s[48:51], s81 offen sc1
  s_waitcnt vmcnt(23)
  s_barrier
  buffer_load_dwordx4 v[148:151], v27, s[48:51], s94 offen sc1
  s_lshl_b32 s10, s76, 7
  s_mul_i32 s11, s76, 221184
  s_add_u32 s12, s10, s70
  s_add_u32 s10, s10, s71
  s_add_u32 s11, s11, s72
  s_add_u32 m0, s74, 32768
  s_add_u32 s13, s10, 0
  buffer_load_dwordx4 v4, s[56:59], s13 offen lds
  s_add_u32 m0, s74, 36864
  s_add_u32 s13, s10, 20480
  buffer_load_dwordx4 v4, s[56:59], s13 offen lds
  s_add_u32 m0, s75, 40960
  s_add_u32 s13, s11, 0
  buffer_load_dwordx4 v5, s[60:63], s13 offen lds
  s_add_u32 m0, s75, 41984
  s_add_u32 s13, s11, 55296
  buffer_load_dwordx4 v5, s[60:63], s13 offen lds
  s_add_u32 m0, s73, 0
  s_add_u32 s13, s12, 0
  buffer_load_dwordx4 v2, s[52:55], s13 offen lds
  s_add_u32 m0, s73, 1024
  s_add_u32 s13, s12, 5120
  buffer_load_dwordx4 v3, s[52:55], s13 offen lds
  s_add_u32 m0, s73, 2048
  s_add_u32 s13, s12, 10240
  buffer_load_dwordx4 v2, s[52:55], s13 offen lds
  s_add_u32 m0, s73, 3072
  s_add_u32 s13, s12, 15360
  buffer_load_dwordx4 v3, s[52:55], s13 offen lds
  s_add_u32 m0, s73, 4096
  s_add_u32 s13, s12, 20480
  buffer_load_dwordx4 v2, s[52:55], s13 offen lds
  s_add_u32 m0, s73, 5120
  s_add_u32 s13, s12, 25600
  buffer_load_dwordx4 v3, s[52:55], s13 offen lds
  s_add_u32 m0, s73, 6144
  s_add_u32 s13, s12, 30720
  buffer_load_dwordx4 v2, s[52:55], s13 offen lds
  s_add_u32 m0, s73, 7168
  s_add_u32 s13, s12, 35840
  buffer_load_dwordx4 v3, s[52:55], s13 offen lds
  s_add_u32 s76, s76, 1
  s_cmp_eq_u32 s76, 10
  s_cselect_b32 s76, 0, s76
  s_waitcnt vmcnt(12)
  s_barrier
  s_mov_b32 s85, 0
Hb_CHK:
  v_xor_b32 v1, s6, v41
  v_xor_b32 v36, s6, v43
  v_or_b32 v1, v1, v36
  v_xor_b32 v36, s6, v45
  v_or_b32 v1, v1, v36
  v_xor_b32 v36, s6, v47
  v_or_b32 v1, v1, v36
  v_xor_b32 v36, s6, v49
  v_or_b32 v1, v1, v36
  v_xor_b32 v36, s6, v51
  v_or_b32 v1, v1, v36
  v_xor_b32 v36, s6, v53
  v_or_b32 v1, v1, v36
  v_xor_b32 v36, s6, v55
  v_or_b32 v1, v1, v36
  v_xor_b32 v36, s6, v57
  v_or_b32 v1, v1, v36
  v_xor_b32 v36, s6, v59
  v_or_b32 v1, v1, v36
  v_xor_b32 v36, s6, v61
  v_or_b32 v1, v1, v36
  v_cmp_ne_u32 vcc, 0, v1
  s_add_u32 s85, s85, 1
  s_cmp_lt_u32 s85, 20000
  s_cselect_b64 s[12:13], -1, 0
  s_nop 1
  s_and_b64 vcc, vcc, s[12:13]
  s_cbranch_scc0 Hb_OK
  s_sleep 8
  s_add_u32 s10, s80, 0
  buffer_load_dwordx2 v[42:43], v33, s[48:51], s10 offen sc1
  s_add_u32 s10, s80, 1280
  buffer_load_dwordx2 v[44:45], v33, s[48:51], s10 offen sc1
  s_add_u32 s10, s80, 2560
  buffer_load_dwordx2 v[46:47], v33, s[48:51], s10 offen sc1
  s_add_u32 s10, s80, 3840
  buffer_load_dwordx2 v[48:49], v33, s[48:51], s10 offen sc1
  s_add_u32 s10, s80, 5120
  buffer_load_dwordx2 v[50:51], v33, s[48:51], s10 offen sc1
  s_add_u32 s10, s80, 6400
  buffer_load_dwordx2 v[52:53], v33, s[48:51], s10 offen sc1
  s_add_u32 s10, s80, 7680
  buffer_load_dwordx2 v[54:55], v33, s[48:51], s10 offen sc1
  s_add_u32 s10, s80, 8960
  buffer_load_dwordx2 v[56:57], v33, s[48:51], s10 offen sc1
  s_add_u32 s10, s80, 10240
  buffer_load_dwordx2 v[58:59], v33, s[48:51], s10 offen sc1
  s_add_u32 s10, s80, 11520
  buffer_load_dwordx2 v[60:61], v33, s[48:51], s10 offen sc1
  buffer_load_dwordx2 v[40:41], v34, s[48:51], s81 offen sc1
  s_waitcnt vmcnt(0)
  s_branch Hb_CHK
Hb_OK:
  v_add_f32 v42, v42, v44
  v_add_f32 v42, v42, v46
  v_add_f32 v42, v42, v48
  v_add_f32 v42, v42, v50
  v_add_f32 v42, v42, v52
  v_add_f32 v42, v42, v54
  v_add_f32 v42, v42, v56
  v_add_f32 v42, v42, v58
  v_add_f32 v42, v42, v60
  v_and_b32 v45, 0xffff, v40
  v_xor_b32 v45, 0x8000, v45
  v_lshl_or_b32 v44, v45, 16, v45
  v_mov_b32 v46, 0
  v_mov_b32 v47, 0
  v_lshlrev_b32 v36, 4, v32
  ds_write_b128 v36, v[44:47] offset:53248
  v_and_b32 v40, 0xffff0000, v40
  v_rcp_f32 v40, v40
  v_lshrrev_b32 v34, 1, v34
  v_cvt_pk_bf16_f32 v48, v42, v42
  ds_write_b32 v34, v40 offset:61440
  v_lshlrev_b32 v48, 16, v48
  v_sub_f32 v49, v42, v48
  v_cvt_pk_bf16_f32 v48, v42, v49
  v_and_b32 v50, 0xffff0000, v48
  v_sub_f32 v49, v49, v50
  v_mov_b32 v50, 0
  v_mov_b32 v51, 0
  v_cvt_pk_bf16_f32 v49, v49, v50
  v_lshlrev_b32 v33, 1, v33
  v_mov_b32 v52, 0
  v_mov_b32 v53, 0
  ds_write_b128 v33, v[48:51] offset:57856
  ds_write_b128 v50, v[50:53] offset:57344
  v_xor_b32 v148, s6, v148
  v_xor_b32 v149, s6, v149
  v_xor_b32 v150, s6, v150
  v_xor_b32 v151, s6, v151
  v_or3_b32 v148, v148, v149, v150
  v_or_b32 v148, v148, v151
  v_cmp_ne_u32 vcc, 0, v148
  s_nop 4
  s_cbranch_vccz Hb_FOK
  s_mov_b32 s85, 0
  s_branch Hb_FP_1
Hb_FP:
  s_sleep 16
Hb_FP_1:
  buffer_load_dwordx4 v[148:151], v27, s[48:51], s94 offen sc1
  s_waitcnt vmcnt(0)
  v_xor_b32 v148, s6, v148
  v_xor_b32 v149, s6, v149
  v_xor_b32 v150, s6, v150
  v_xor_b32 v151, s6, v151
  v_or3_b32 v148, v148, v149, v150
  v_or_b32 v148, v148, v151
  v_cmp_ne_u32 vcc, 0, v148
  s_add_u32 s85, s85, 1
  s_cmp_lt_u32 s85, 20000
  s_cselect_b64 s[12:13], -1, 0
  s_nop 1
  s_and_b64 vcc, vcc, s[12:13]
  s_cbranch_scc1 Hb_FP
Hb_FOK:
  s_add_u32 s91, s88, 102400
  s_add_u32 m0, s95, 63488
  s_add_u32 s68, s91, 0
  buffer_load_dwordx4 v27, s[48:51], s68 offen sc1 lds
  s_add_u32 m0, s95, 64512
  s_add_u32 s68, s91, 1024
  buffer_load_dwordx4 v27, s[48:51], s68 offen sc1 lds
  s_add_u32 m0, s95, 65536
  s_add_u32 s68, s91, 2048
  buffer_load_dwordx4 v27, s[48:51], s68 offen sc1 lds
  s_add_u32 m0, s95, 66560
  s_add_u32 s68, s91, 3072
  buffer_load_dwordx4 v27, s[48:51], s68 offen sc1 lds
  s_add_u32 m0, s95, 67584
  s_add_u32 s68, s91, 4096
  buffer_load_dwordx4 v27, s[48:51], s68 offen sc1 lds
  s_add_u32 s91, s88, 143360
  s_add_u32 m0, s95, 83968
  s_add_u32 s68, s91, 0
  buffer_load_dwordx4 v27, s[48:51], s68 offen sc1 lds
  s_add_u32 m0, s95, 84992
  s_add_u32 s68, s91, 1024
  buffer_load_dwordx4 v27, s[48:51], s68 offen sc1 lds
  s_add_u32 m0, s95, 86016
  s_add_u32 s68, s91, 2048
  buffer_load_dwordx4 v27, s[48:51], s68 offen sc1 lds
  s_add_u32 m0, s95, 87040
  s_add_u32 s68, s91, 3072
  buffer_load_dwordx4 v27, s[48:51], s68 offen sc1 lds
  s_add_u32 m0, s95, 88064
  s_add_u32 s68, s91, 4096
  buffer_load_dwordx4 v27, s[48:51], s68 offen sc1 lds
  s_waitcnt vmcnt(10)
  s_waitcnt lgkmcnt(0)
  s_barrier
  s_add_u32 s91, s88, 184320
  s_add_u32 m0, s95, 104448
  s_add_u32 s68, s91, 0
  buffer_load_dwordx4 v27, s[48:51], s68 offen sc1 lds
  s_add_u32 m0, s95, 105472
  s_add_u32 s68, s91, 1024
  buffer_load_dwordx4 v27, s[48:51], s68 offen sc1 lds
  s_add_u32 m0, s95, 106496
  s_add_u32 s68, s91, 2048
  buffer_load_dwordx4 v27, s[48:51], s68 offen sc1 lds
  s_add_u32 m0, s95, 107520
  s_add_u32 s68, s91, 3072
  buffer_load_dwordx4 v27, s[48:51], s68 offen sc1 lds
  s_add_u32 m0, s95, 108544
  s_add_u32 s68, s91, 4096
  buffer_load_dwordx4 v27, s[48:51], s68 offen sc1 lds
  s_add_u32 s91, s88, 225280
  s_add_u32 m0, s95, 124928
  s_add_u32 s68, s91, 0
  buffer_load_dwordx4 v27, s[48:51], s68 offen sc1 lds
  s_add_u32 m0, s95, 125952
  s_add_u32 s68, s91, 1024
  buffer_load_dwordx4 v27, s[48:51], s68 offen sc1 lds
  s_add_u32 m0, s95, 126976
  s_add_u32 s68, s91, 2048
  buffer_load_dwordx4 v27, s[48:51], s68 offen sc1 lds
  s_add_u32 m0, s95, 128000
  s_add_u32 s68, s91, 3072
  buffer_load_dwordx4 v27, s[48:51], s68 offen sc1 lds
  s_add_u32 m0, s95, 129024
  s_add_u32 s68, s91, 4096
  buffer_load_dwordx4 v27, s[48:51], s68 offen sc1 lds
  s_add_u32 s91, s88, 0
  buffer_load_dwordx4 v[160:163], v27, s[48:51], s91 offen offset:0 sc1
  buffer_load_dwordx4 v[164:167], v27, s[48:51], s91 offen offset:1024 sc1
  buffer_load_dwordx4 v[168:171], v27, s[48:51], s91 offen offset:2048 sc1
  buffer_load_dwordx4 v[172:175], v27, s[48:51], s91 offen offset:3072 sc1
  buffer_load_dwordx4 v[176:179], v25, s[48:51], s91 offen offset:3072 sc1
  s_add_u32 s91, s88, 20480
  buffer_load_dwordx4 v[180:183], v27, s[48:51], s91 offen offset:0 sc1
  buffer_load_dwordx4 v[184:187], v27, s[48:51], s91 offen offset:1024 sc1
  buffer_load_dwordx4 v[188:191], v27, s[48:51], s91 offen offset:2048 sc1
  buffer_load_dwordx4 v[192:195], v27, s[48:51], s91 offen offset:3072 sc1
  buffer_load_dwordx4 v[196:199], v25, s[48:51], s91 offen offset:3072 sc1
  s_add_u32 s91, s88, 40960
  buffer_load_dwordx4 v[200:203], v27, s[48:51], s91 offen offset:0 sc1
  buffer_load_dwordx4 v[204:207], v27, s[48:51], s91 offen offset:1024 sc1
  buffer_load_dwordx4 v[208:211], v27, s[48:51], s91 offen offset:2048 sc1
  buffer_load_dwordx4 v[212:215], v27, s[48:51], s91 offen offset:3072 sc1
  buffer_load_dwordx4 v[216:219], v25, s[48:51], s91 offen offset:3072 sc1
  s_add_u32 s91, s88, 61440
  buffer_load_dwordx4 v[220:223], v27, s[48:51], s91 offen offset:0 sc1
  buffer_load_dwordx4 v[224:227], v27, s[48:51], s91 offen offset:1024 sc1
  buffer_load_dwordx4 v[228:231], v27, s[48:51], s91 offen offset:2048 sc1
  buffer_load_dwordx4 v[232:235], v27, s[48:51], s91 offen offset:3072 sc1
  buffer_load_dwordx4 v[236:239], v25, s[48:51], s91 offen offset:3072 sc1
  s_waitcnt lgkmcnt(0)
  s_barrier
  s_branch P2_H
P2_C:
  v_lshlrev_b32 v2, 4, v0
  v_add_u32 v3, 1024, v2
  v_and_b32 v1, 31, v0
  v_lshlrev_b32 v1, 4, v1
  s_lshl_b32 s10, s86, 9
  s_add_u32 s10, s10, 18087936
  s_mul_i32 s92, s86, 94
  s_add_u32 s92, s92, 93
  s_lshl_b32 s92, s92, 12
  s_add_u32 s11, s7, 0
  s_and_b32 s11, s11, 3
  s_lshl_b32 s11, s11, 10
  v_add_u32 v4, s11, v2
  s_add_u32 s11, s7, 1
  s_and_b32 s11, s11, 3
  s_lshl_b32 s11, s11, 10
  v_add_u32 v5, s11, v2
  s_add_u32 s11, s7, 2
  s_and_b32 s11, s11, 3
  s_lshl_b32 s11, s11, 10
  v_add_u32 v6, s11, v2
  s_add_u32 s11, s7, 3
  s_and_b32 s11, s11, 3
  s_lshl_b32 s11, s11, 10
  v_add_u32 v7, s11, v2
  v_add_u32 v8, s90, v2
  s_mul_i32 s11, s7, 5120
  s_add_u32 s11, s11, 63488
  v_add_u32 v9, s11, v2
  s_barrier
  buffer_load_dword v13, v1, s[48:51], s10 offen sc1
  s_add_u32 s91, s88, 0
  buffer_load_dwordx4 v[160:163], v2, s[48:51], s91 offen offset:0 sc1
  buffer_load_dwordx4 v[164:167], v2, s[48:51], s91 offen offset:1024 sc1
  buffer_load_dwordx4 v[168:171], v2, s[48:51], s91 offen offset:2048 sc1
  buffer_load_dwordx4 v[172:175], v2, s[48:51], s91 offen offset:3072 sc1
  buffer_load_dwordx4 v[176:179], v3, s[48:51], s91 offen offset:3072 sc1
  s_add_u32 s91, s88, 20480
  buffer_load_dwordx4 v[180:183], v2, s[48:51], s91 offen offset:0 sc1
  buffer_load_dwordx4 v[184:187], v2, s[48:51], s91 offen offset:1024 sc1
  buffer_load_dwordx4 v[188:191], v2, s[48:51], s91 offen offset:2048 sc1
  buffer_load_dwordx4 v[192:195], v2, s[48:51], s91 offen offset:3072 sc1
  buffer_load_dwordx4 v[196:199], v3, s[48:51], s91 offen offset:3072 sc1
  s_waitcnt vmcnt(10)
  v_cmp_ne_u32 vcc, s6, v13
  s_nop 4
  s_cbranch_vccz Pc_PK
  s_mov_b32 s85, 0
  s_branch Pc_POLL_1
Pc_POLL:
  s_sleep 16
Pc_POLL_1:
  buffer_load_dword v13, v1, s[48:51], s10 offen sc1
  s_waitcnt vmcnt(0)
  v_xor_b32 v13, s6, v13
  v_cmp_ne_u32 vcc, 0, v13
  s_add_u32 s85, s85, 1
  s_cmp_lt_u32 s85, 20000
  s_cselect_b64 s[12:13], -1, 0
  s_nop 1
  s_and_b64 vcc, vcc, s[12:13]
  s_cbranch_scc1 Pc_POLL
Pc_PK:
  s_add_u32 s91, s89, 0
  buffer_load_dwordx4 v[96:99], v4, s[48:51], s91 offen sc1
  buffer_load_dwordx4 v[100:103], v5, s[48:51], s91 offen sc1
  buffer_load_dwordx4 v[104:107], v6, s[48:51], s91 offen sc1
  buffer_load_dwordx4 v[108:111], v7, s[48:51], s91 offen sc1
  s_add_u32 s91, s89, 16384
  buffer_load_dwordx4 v[112:115], v4, s[48:51], s91 offen sc1
  buffer_load_dwordx4 v[116:119], v5, s[48:51], s91 offen sc1
  buffer_load_dwordx4 v[120:123], v6, s[48:51], s91 offen sc1
  buffer_load_dwordx4 v[124:127], v7, s[48:51], s91 offen sc1
  s_waitcnt vmcnt(4)
  v_mfma_f32_16x16x32_bf16 v[16:19], v[160:163], v[96:99], 0
  v_mfma_f32_16x16x32_bf16 v[20:23], v[164:167], v[96:99], 0
  s_add_u32 s91, s89, 32768
  buffer_load_dwordx4 v[128:131], v4, s[48:51], s91 offen sc1
  buffer_load_dwordx4 v[132:135], v5, s[48:51], s91 offen sc1
  buffer_load_dwordx4 v[136:139], v6, s[48:51], s91 offen sc1
  buffer_load_dwordx4 v[140:143], v7, s[48:51], s91 offen sc1
  s_add_u32 s91, s88, 40960
  buffer_load_dwordx4 v[200:203], v2, s[48:51], s91 offen offset:0 sc1
  buffer_load_dwordx4 v[204:207], v2, s[48:51], s91 offen offset:1024 sc1
  buffer_load_dwordx4 v[208:211], v2, s[48:51], s91 offen offset:2048 sc1
  buffer_load_dwordx4 v[212:215], v2, s[48:51], s91 offen offset:3072 sc1
  buffer_load_dwordx4 v[216:219], v3, s[48:51], s91 offen offset:3072 sc1
  v_mfma_f32_16x16x32_bf16 v[24:27], v[168:171], v[96:99], 0
  v_mfma_f32_16x16x32_bf16 v[28:31], v[172:175], v[96:99], 0
  v_mfma_f32_16x16x32_bf16 v[32:35], v[176:179], v[96:99], 0
  v_mfma_f32_16x16x32_bf16 v[36:39], v[160:163], v[100:103], 0
  v_mfma_f32_16x16x32_bf16 v[40:43], v[164:167], v[100:103], 0
  v_mfma_f32_16x16x32_bf16 v[44:47], v[168:171], v[100:103], 0
  v_mfma_f32_16x16x32_bf16 v[48:51], v[172:175], v[100:103], 0
  v_mfma_f32_16x16x32_bf16 v[52:55], v[176:179], v[100:103], 0
  v_mfma_f32_16x16x32_bf16 v[56:59], v[160:163], v[104:107], 0
  v_mfma_f32_16x16x32_bf16 v[60:63], v[164:167], v[104:107], 0
  v_mfma_f32_16x16x32_bf16 v[64:67], v[168:171], v[104:107], 0
  v_mfma_f32_16x16x32_bf16 v[68:71], v[172:175], v[104:107], 0
  v_mfma_f32_16x16x32_bf16 v[72:75], v[176:179], v[104:107], 0
  v_mfma_f32_16x16x32_bf16 v[76:79], v[160:163], v[108:111], 0
  v_mfma_f32_16x16x32_bf16 v[80:83], v[164:167], v[108:111], 0
  v_mfma_f32_16x16x32_bf16 v[84:87], v[168:171], v[108:111], 0
  v_mfma_f32_16x16x32_bf16 v[88:91], v[172:175], v[108:111], 0
  v_mfma_f32_16x16x32_bf16 v[92:95], v[176:179], v[108:111], 0
  s_waitcnt vmcnt(9)
  v_mfma_f32_16x16x32_bf16 v[16:19], v[180:183], v[112:115], v[16:19]
  v_mfma_f32_16x16x32_bf16 v[20:23], v[184:187], v[112:115], v[20:23]
  s_add_u32 s91, s89, 49152
  buffer_load_dwordx4 v[144:147], v4, s[48:51], s91 offen sc1
  buffer_load_dwordx4 v[148:151], v5, s[48:51], s91 offen sc1
  buffer_load_dwordx4 v[152:155], v6, s[48:51], s91 offen sc1
  buffer_load_dwordx4 v[156:159], v7, s[48:51], s91 offen sc1
  s_add_u32 s91, s88, 61440
  buffer_load_dwordx4 v[220:223], v2, s[48:51], s91 offen offset:0 sc1
  buffer_load_dwordx4 v[224:227], v2, s[48:51], s91 offen offset:1024 sc1
  buffer_load_dwordx4 v[228:231], v2, s[48:51], s91 offen offset:2048 sc1
  buffer_load_dwordx4 v[232:235], v2, s[48:51], s91 offen offset:3072 sc1
  buffer_load_dwordx4 v[236:239], v3, s[48:51], s91 offen offset:3072 sc1
  v_mfma_f32_16x16x32_bf16 v[24:27], v[188:191], v[112:115], v[24:27]
  v_mfma_f32_16x16x32_bf16 v[28:31], v[192:195], v[112:115], v[28:31]
  v_mfma_f32_16x16x32_bf16 v[32:35], v[196:199], v[112:115], v[32:35]
  v_mfma_f32_16x16x32_bf16 v[36:39], v[180:183], v[116:119], v[36:39]
  v_mfma_f32_16x16x32_bf16 v[40:43], v[184:187], v[116:119], v[40:43]
  v_mfma_f32_16x16x32_bf16 v[44:47], v[188:191], v[116:119], v[44:47]
  v_mfma_f32_16x16x32_bf16 v[48:51], v[192:195], v[116:119], v[48:51]
  v_mfma_f32_16x16x32_bf16 v[52:55], v[196:199], v[116:119], v[52:55]
  v_mfma_f32_16x16x32_bf16 v[56:59], v[180:183], v[120:123], v[56:59]
  v_mfma_f32_16x16x32_bf16 v[60:63], v[184:187], v[120:123], v[60:63]
  v_mfma_f32_16x16x32_bf16 v[64:67], v[188:191], v[120:123], v[64:67]
  v_mfma_f32_16x16x32_bf16 v[68:71], v[192:195], v[120:123], v[68:71]
  v_mfma_f32_16x16x32_bf16 v[72:75], v[196:199], v[120:123], v[72:75]
  v_mfma_f32_16x16x32_bf16 v[76:79], v[180:183], v[124:127], v[76:79]
  v_mfma_f32_16x16x32_bf16 v[80:83], v[184:187], v[124:127], v[80:83]
  v_mfma_f32_16x16x32_bf16 v[84:87], v[188:191], v[124:127], v[84:87]
  v_mfma_f32_16x16x32_bf16 v[88:91], v[192:195], v[124:127], v[88:91]
  v_mfma_f32_16x16x32_bf16 v[92:95], v[196:199], v[124:127], v[92:95]
  s_barrier
  s_waitcnt vmcnt(9)
  v_mfma_f32_16x16x32_bf16 v[16:19], v[200:203], v[128:131], v[16:19]
  v_mfma_f32_16x16x32_bf16 v[20:23], v[204:207], v[128:131], v[20:23]
  s_add_u32 s91, s89, 65536
  buffer_load_dwordx4 v[240:243], v4, s[48:51], s91 offen sc1
  buffer_load_dwordx4 v[244:247], v5, s[48:51], s91 offen sc1
  buffer_load_dwordx4 v[248:251], v6, s[48:51], s91 offen sc1
  buffer_load_dwordx4 v[252:255], v7, s[48:51], s91 offen sc1
  s_add_u32 s91, s88, 81920
  buffer_load_dwordx4 v[160:163], v2, s[48:51], s91 offen offset:0 sc1
  buffer_load_dwordx4 v[164:167], v2, s[48:51], s91 offen offset:1024 sc1
  buffer_load_dwordx4 v[168:171], v2, s[48:51], s91 offen offset:2048 sc1
  buffer_load_dwordx4 v[172:175], v2, s[48:51], s91 offen offset:3072 sc1
  buffer_load_dwordx4 v[176:179], v3, s[48:51], s91 offen offset:3072 sc1
  v_mfma_f32_16x16x32_bf16 v[24:27], v[208:211], v[128:131], v[24:27]
  v_mfma_f32_16x16x32_bf16 v[28:31], v[212:215], v[128:131], v[28:31]
  v_mfma_f32_16x16x32_bf16 v[32:35], v[216:219], v[128:131], v[32:35]
  v_mfma_f32_16x16x32_bf16 v[36:39], v[200:203], v[132:135], v[36:39]
  v_mfma_f32_16x16x32_bf16 v[40:43], v[204:207], v[132:135], v[40:43]
  v_mfma_f32_16x16x32_bf16 v[44:47], v[208:211], v[132:135], v[44:47]
  v_mfma_f32_16x16x32_bf16 v[48:51], v[212:215], v[132:135], v[48:51]
  v_mfma_f32_16x16x32_bf16 v[52:55], v[216:219], v[132:135], v[52:55]
  v_mfma_f32_16x16x32_bf16 v[56:59], v[200:203], v[136:139], v[56:59]
  v_mfma_f32_16x16x32_bf16 v[60:63], v[204:207], v[136:139], v[60:63]
  v_mfma_f32_16x16x32_bf16 v[64:67], v[208:211], v[136:139], v[64:67]
  v_mfma_f32_16x16x32_bf16 v[68:71], v[212:215], v[136:139], v[68:71]
  v_mfma_f32_16x16x32_bf16 v[72:75], v[216:219], v[136:139], v[72:75]
  v_mfma_f32_16x16x32_bf16 v[76:79], v[200:203], v[140:143], v[76:79]
  v_mfma_f32_16x16x32_bf16 v[80:83], v[204:207], v[140:143], v[80:83]
  v_mfma_f32_16x16x32_bf16 v[84:87], v[208:211], v[140:143], v[84:87]
  v_mfma_f32_16x16x32_bf16 v[88:91], v[212:215], v[140:143], v[88:91]
  v_mfma_f32_16x16x32_bf16 v[92:95], v[216:219], v[140:143], v[92:95]
  s_waitcnt vmcnt(9)
  v_mfma_f32_16x16x32_bf16 v[16:19], v[220:223], v[144:147], v[16:19]
  v_mfma_f32_16x16x32_bf16 v[20:23], v[224:227], v[144:147], v[20:23]
  s_add_u32 s91, s89, 81920
  buffer_load_dwordx4 v[96:99], v4, s[48:51], s91 offen sc1
  buffer_load_dwordx4 v[100:103], v5, s[48:51], s91 offen sc1
  buffer_load_dwordx4 v[104:107], v6, s[48:51], s91 offen sc1
  buffer_load_dwordx4 v[108:111], v7, s[48:51], s91 offen sc1
  ds_read_b128 v[180:183], v8 offset:4096
  ds_read_b128 v[184:187], v8 offset:5120
  ds_read_b128 v[188:191], v8 offset:6144
  ds_read_b128 v[192:195], v8 offset:7168
  ds_read_b128 v[196:199], v8 offset:8192
  v_mfma_f32_16x16x32_bf16 v[24:27], v[228:231], v[144:147], v[24:27]
  v_mfma_f32_16x16x32_bf16 v[28:31], v[232:235], v[144:147], v[28:31]
  v_mfma_f32_16x16x32_bf16 v[32:35], v[236:239], v[144:147], v[32:35]
  v_mfma_f32_16x16x32_bf16 v[36:39], v[220:223], v[148:151], v[36:39]
  v_mfma_f32_16x16x32_bf16 v[40:43], v[224:227], v[148:151], v[40:43]
  v_mfma_f32_16x16x32_bf16 v[44:47], v[228:231], v[148:151], v[44:47]
  v_mfma_f32_16x16x32_bf16 v[48:51], v[232:235], v[148:151], v[48:51]
  v_mfma_f32_16x16x32_bf16 v[52:55], v[236:239], v[148:151], v[52:55]
  v_mfma_f32_16x16x32_bf16 v[56:59], v[220:223], v[152:155], v[56:59]
  v_mfma_f32_16x16x32_bf16 v[60:63], v[224:227], v[152:155], v[60:63]
  v_mfma_f32_16x16x32_bf16 v[64:67], v[228:231], v[152:155], v[64:67]
  v_mfma_f32_16x16x32_bf16 v[68:71], v[232:235], v[152:155], v[68:71]
  v_mfma_f32_16x16x32_bf16 v[72:75], v[236:239], v[152:155], v[72:75]
  v_mfma_f32_16x16x32_bf16 v[76:79], v[220:223], v[156:159], v[76:79]
  v_mfma_f32_16x16x32_bf16 v[80:83], v[224:227], v[156:159], v[80:83]
  v_mfma_f32_16x16x32_bf16 v[84:87], v[228:231], v[156:159], v[84:87]
  v_mfma_f32_16x16x32_bf16 v[88:91], v[232:235], v[156:159], v[88:91]
  v_mfma_f32_16x16x32_bf16 v[92:95], v[236:239], v[156:159], v[92:95]
  s_waitcnt vmcnt(4)
  v_mfma_f32_16x16x32_bf16 v[16:19], v[160:163], v[240:243], v[16:19]
  v_mfma_f32_16x16x32_bf16 v[20:23], v[164:167], v[240:243], v[20:23]
  s_add_u32 s91, s89, 98304
  buffer_load_dwordx4 v[112:115], v4, s[48:51], s91 offen sc1
  buffer_load_dwordx4 v[116:119], v5, s[48:51], s91 offen sc1
  buffer_load_dwordx4 v[120:123], v6, s[48:51], s91 offen sc1
  buffer_load_dwordx4 v[124:127], v7, s[48:51], s91 offen sc1
  s_add_u32 s91, s88, 122880
  buffer_load_dwordx4 v[200:203], v2, s[48:51], s91 offen offset:0 sc1
  buffer_load_dwordx4 v[204:207], v2, s[48:51], s91 offen offset:1024 sc1
  buffer_load_dwordx4 v[208:211], v2, s[48:51], s91 offen offset:2048 sc1
  buffer_load_dwordx4 v[212:215], v2, s[48:51], s91 offen offset:3072 sc1
  buffer_load_dwordx4 v[216:219], v3, s[48:51], s91 offen offset:3072 sc1
  v_mfma_f32_16x16x32_bf16 v[24:27], v[168:171], v[240:243], v[24:27]
  v_mfma_f32_16x16x32_bf16 v[28:31], v[172:175], v[240:243], v[28:31]
  v_mfma_f32_16x16x32_bf16 v[32:35], v[176:179], v[240:243], v[32:35]
  v_mfma_f32_16x16x32_bf16 v[36:39], v[160:163], v[244:247], v[36:39]
  v_mfma_f32_16x16x32_bf16 v[40:43], v[164:167], v[244:247], v[40:43]
  v_mfma_f32_16x16x32_bf16 v[44:47], v[168:171], v[244:247], v[44:47]
  v_mfma_f32_16x16x32_bf16 v[48:51], v[172:175], v[244:247], v[48:51]
  v_mfma_f32_16x16x32_bf16 v[52:55], v[176:179], v[244:247], v[52:55]
  v_mfma_f32_16x16x32_bf16 v[56:59], v[160:163], v[248:251], v[56:59]
  v_mfma_f32_16x16x32_bf16 v[60:63], v[164:167], v[248:251], v[60:63]
  v_mfma_f32_16x16x32_bf16 v[64:67], v[168:171], v[248:251], v[64:67]
  v_mfma_f32_16x16x32_bf16 v[68:71], v[172:175], v[248:251], v[68:71]
  v_mfma_f32_16x16x32_bf16 v[72:75], v[176:179], v[248:251], v[72:75]
  v_mfma_f32_16x16x32_bf16 v[76:79], v[160:163], v[252:255], v[76:79]
  v_mfma_f32_16x16x32_bf16 v[80:83], v[164:167], v[252:255], v[80:83]
  v_mfma_f32_16x16x32_bf16 v[84:87], v[168:171], v[252:255], v[84:87]
  v_mfma_f32_16x16x32_bf16 v[88:91], v[172:175], v[252:255], v[88:91]
  v_mfma_f32_16x16x32_bf16 v[92:95], v[176:179], v[252:255], v[92:95]
  s_waitcnt vmcnt(9)
  s_waitcnt lgkmcnt(0)
  v_mfma_f32_16x16x32_bf16 v[16:19], v[180:183], v[96:99], v[16:19]
  v_mfma_f32_16x16x32_bf16 v[20:23], v[184:187], v[96:99], v[20:23]
  s_add_u32 s91, s89, 114688
  buffer_load_dwordx4 v[128:131], v4, s[48:51], s91 offen sc1
  buffer_load_dwordx4 v[132:135], v5, s[48:51], s91 offen sc1
  buffer_load_dwordx4 v[136:139], v6, s[48:51], s91 offen sc1
  buffer_load_dwordx4 v[140:143], v7, s[48:51], s91 offen sc1
  ds_read_b128 v[220:223], v8 offset:9216
  ds_read_b128 v[224:227], v8 offset:10240
  ds_read_b128 v[228:231], v8 offset:11264
  ds_read_b128 v[232:235], v8 offset:12288
  ds_read_b128 v[236:239], v8 offset:13312
  v_mfma_f32_16x16x32_bf16 v[24:27], v[188:191], v[96:99], v[24:27]
  v_mfma_f32_16x16x32_bf16 v[28:31], v[192:195], v[96:99], v[28:31]
  v_mfma_f32_16x16x32_bf16 v[32:35], v[196:199], v[96:99], v[32:35]
  v_mfma_f32_16x16x32_bf16 v[36:39], v[180:183], v[100:103], v[36:39]
  v_mfma_f32_16x16x32_bf16 v[40:43], v[184:187], v[100:103], v[40:43]
  v_mfma_f32_16x16x32_bf16 v[44:47], v[188:191], v[100:103], v[44:47]
  v_mfma_f32_16x16x32_bf16 v[48:51], v[192:195], v[100:103], v[48:51]
  v_mfma_f32_16x16x32_bf16 v[52:55], v[196:199], v[100:103], v[52:55]
  v_mfma_f32_16x16x32_bf16 v[56:59], v[180:183], v[104:107], v[56:59]
  v_mfma_f32_16x16x32_bf16 v[60:63], v[184:187], v[104:107], v[60:63]
  v_mfma_f32_16x16x32_bf16 v[64:67], v[188:191], v[104:107], v[64:67]
  v_mfma_f32_16x16x32_bf16 v[68:71], v[192:195], v[104:107], v[68:71]
  v_mfma_f32_16x16x32_bf16 v[72:75], v[196:199], v[104:107], v[72:75]
  v_mfma_f32_16x16x32_bf16 v[76:79], v[180:183], v[108:111], v[76:79]
  v_mfma_f32_16x16x32_bf16 v[80:83], v[184:187], v[108:111], v[80:83]
  v_mfma_f32_16x16x32_bf16 v[84:87], v[188:191], v[108:111], v[84:87]
  v_mfma_f32_16x16x32_bf16 v[88:91], v[192:195], v[108:111], v[88:91]
  v_mfma_f32_16x16x32_bf16 v[92:95], v[196:199], v[108:111], v[92:95]
  s_waitcnt vmcnt(4)
  v_mfma_f32_16x16x32_bf16 v[16:19], v[200:203], v[112:115], v[16:19]
  v_mfma_f32_16x16x32_bf16 v[20:23], v[204:207], v[112:115], v[20:23]
  s_add_u32 s91, s89, 131072
  buffer_load_dwordx4 v[144:147], v4, s[48:51], s91 offen sc1
  buffer_load_dwordx4 v[148:151], v5, s[48:51], s91 offen sc1
  buffer_load_dwordx4 v[152:155], v6, s[48:51], s91 offen sc1
  buffer_load_dwordx4 v[156:159], v7, s[48:51], s91 offen sc1
  s_add_u32 s91, s88, 163840
  buffer_load_dwordx4 v[160:163], v2, s[48:51], s91 offen offset:0 sc1
  buffer_load_dwordx4 v[164:167], v2, s[48:51], s91 offen offset:1024 sc1
  buffer_load_dwordx4 v[168:171], v2, s[48:51], s91 offen offset:2048 sc1
  buffer_load_dwordx4 v[172:175], v2, s[48:51], s91 offen offset:3072 sc1
  buffer_load_dwordx4 v[176:179], v3, s[48:51], s91 offen offset:3072 sc1
  v_mfma_f32_16x16x32_bf16 v[24:27], v[208:211], v[112:115], v[24:27]
  v_mfma_f32_16x16x32_bf16 v[28:31], v[212:215], v[112:115], v[28:31]
  v_mfma_f32_16x16x32_bf16 v[32:35], v[216:219], v[112:115], v[32:35]
  v_mfma_f32_16x16x32_bf16 v[36:39], v[200:203], v[116:119], v[36:39]
  v_mfma_f32_16x16x32_bf16 v[40:43], v[204:207], v[116:119], v[40:43]
  v_mfma_f32_16x16x32_bf16 v[44:47], v[208:211], v[116:119], v[44:47]
  v_mfma_f32_16x16x32_bf16 v[48:51], v[212:215], v[116:119], v[48:51]
  v_mfma_f32_16x16x32_bf16 v[52:55], v[216:219], v[116:119], v[52:55]
  v_mfma_f32_16x16x32_bf16 v[56:59], v[200:203], v[120:123], v[56:59]
  v_mfma_f32_16x16x32_bf16 v[60:63], v[204:207], v[120:123], v[60:63]
  v_mfma_f32_16x16x32_bf16 v[64:67], v[208:211], v[120:123], v[64:67]
  v_mfma_f32_16x16x32_bf16 v[68:71], v[212:215], v[120:123], v[68:71]
  v_mfma_f32_16x16x32_bf16 v[72:75], v[216:219], v[120:123], v[72:75]
  v_mfma_f32_16x16x32_bf16 v[76:79], v[200:203], v[124:127], v[76:79]
  v_mfma_f32_16x16x32_bf16 v[80:83], v[204:207], v[124:127], v[80:83]
  v_mfma_f32_16x16x32_bf16 v[84:87], v[208:211], v[124:127], v[84:87]
  v_mfma_f32_16x16x32_bf16 v[88:91], v[212:215], v[124:127], v[88:91]
  v_mfma_f32_16x16x32_bf16 v[92:95], v[216:219], v[124:127], v[92:95]
  s_waitcnt vmcnt(9)
  s_waitcnt lgkmcnt(0)
  v_mfma_f32_16x16x32_bf16 v[16:19], v[220:223], v[128:131], v[16:19]
  v_mfma_f32_16x16x32_bf16 v[20:23], v[224:227], v[128:131], v[20:23]
  s_add_u32 s91, s89, 147456
  buffer_load_dwordx4 v[240:243], v4, s[48:51], s91 offen sc1
  buffer_load_dwordx4 v[244:247], v5, s[48:51], s91 offen sc1
  buffer_load_dwordx4 v[248:251], v6, s[48:51], s91 offen sc1
  buffer_load_dwordx4 v[252:255], v7, s[48:51], s91 offen sc1
  s_add_u32 s91, s88, 184320
  buffer_load_dwordx4 v[180:183], v2, s[48:51], s91 offen offset:0 sc1
  buffer_load_dwordx4 v[184:187], v2, s[48:51], s91 offen offset:1024 sc1
  buffer_load_dwordx4 v[188:191], v2, s[48:51], s91 offen offset:2048 sc1
  buffer_load_dwordx4 v[192:195], v2, s[48:51], s91 offen offset:3072 sc1
  buffer_load_dwordx4 v[196:199], v3, s[48:51], s91 offen offset:3072 sc1
  v_mfma_f32_16x16x32_bf16 v[24:27], v[228:231], v[128:131], v[24:27]
  v_mfma_f32_16x16x32_bf16 v[28:31], v[232:235], v[128:131], v[28:31]
  v_mfma_f32_16x16x32_bf16 v[32:35], v[236:239], v[128:131], v[32:35]
  v_mfma_f32_16x16x32_bf16 v[36:39], v[220:223], v[132:135], v[36:39]
  v_mfma_f32_16x16x32_bf16 v[40:43], v[224:227], v[132:135], v[40:43]
  v_mfma_f32_16x16x32_bf16 v[44:47], v[228:231], v[132:135], v[44:47]
  v_mfma_f32_16x16x32_bf16 v[48:51], v[232:235], v[132:135], v[48:51]
  v_mfma_f32_16x16x32_bf16 v[52:55], v[236:239], v[132:135], v[52:55]
  v_mfma_f32_16x16x32_bf16 v[56:59], v[220:223], v[136:139], v[56:59]
  v_mfma_f32_16x16x32_bf16 v[60:63], v[224:227], v[136:139], v[60:63]
  v_mfma_f32_16x16x32_bf16 v[64:67], v[228:231], v[136:139], v[64:67]
  v_mfma_f32_16x16x32_bf16 v[68:71], v[232:235], v[136:139], v[68:71]
  v_mfma_f32_16x16x32_bf16 v[72:75], v[236:239], v[136:139], v[72:75]
  v_mfma_f32_16x16x32_bf16 v[76:79], v[220:223], v[140:143], v[76:79]
  v_mfma_f32_16x16x32_bf16 v[80:83], v[224:227], v[140:143], v[80:83]
  v_mfma_f32_16x16x32_bf16 v[84:87], v[228:231], v[140:143], v[84:87]
  v_mfma_f32_16x16x32_bf16 v[88:91], v[232:235], v[140:143], v[88:91]
  v_mfma_f32_16x16x32_bf16 v[92:95], v[236:239], v[140:143], v[92:95]
  s_waitcnt vmcnt(9)
  v_mfma_f32_16x16x32_bf16 v[16:19], v[160:163], v[144:147], v[16:19]
  v_mfma_f32_16x16x32_bf16 v[20:23], v[164:167], v[144:147], v[20:23]
  v_mfma_f32_16x16x32_bf16 v[24:27], v[168:171], v[144:147], v[24:27]
  v_mfma_f32_16x16x32_bf16 v[28:31], v[172:175], v[144:147], v[28:31]
  v_mfma_f32_16x16x32_bf16 v[32:35], v[176:179], v[144:147], v[32:35]
  v_mfma_f32_16x16x32_bf16 v[36:39], v[160:163], v[148:151], v[36:39]
  v_mfma_f32_16x16x32_bf16 v[40:43], v[164:167], v[148:151], v[40:43]
  v_mfma_f32_16x16x32_bf16 v[44:47], v[168:171], v[148:151], v[44:47]
  v_mfma_f32_16x16x32_bf16 v[48:51], v[172:175], v[148:151], v[48:51]
  v_mfma_f32_16x16x32_bf16 v[52:55], v[176:179], v[148:151], v[52:55]
  v_mfma_f32_16x16x32_bf16 v[56:59], v[160:163], v[152:155], v[56:59]
  v_mfma_f32_16x16x32_bf16 v[60:63], v[164:167], v[152:155], v[60:63]
  v_mfma_f32_16x16x32_bf16 v[64:67], v[168:171], v[152:155], v[64:67]
  v_mfma_f32_16x16x32_bf16 v[68:71], v[172:175], v[152:155], v[68:71]
  v_mfma_f32_16x16x32_bf16 v[72:75], v[176:179], v[152:155], v[72:75]
  v_mfma_f32_16x16x32_bf16 v[76:79], v[160:163], v[156:159], v[76:79]
  v_mfma_f32_16x16x32_bf16 v[80:83], v[164:167], v[156:159], v[80:83]
  v_mfma_f32_16x16x32_bf16 v[84:87], v[168:171], v[156:159], v[84:87]
  v_mfma_f32_16x16x32_bf16 v[88:91], v[172:175], v[156:159], v[88:91]
  v_mfma_f32_16x16x32_bf16 v[92:95], v[176:179], v[156:159], v[92:95]
  s_waitcnt vmcnt(0)
  s_waitcnt lgkmcnt(0)
  v_lshrrev_b32 v1, 4, v0
  v_lshlrev_b32 v1, 6, v1
  v_xor_b32 v8, v1, v8
  v_xor_b32 v9, v1, v9
  v_mfma_f32_16x16x32_bf16 v[16:19], v[180:183], v[240:243], v[16:19]
  v_mfma_f32_16x16x32_bf16 v[20:23], v[184:187], v[240:243], v[20:23]
  v_mfma_f32_16x16x32_bf16 v[24:27], v[188:191], v[240:243], v[24:27]
  v_mfma_f32_16x16x32_bf16 v[28:31], v[192:195], v[240:243], v[28:31]
  v_mfma_f32_16x16x32_bf16 v[32:35], v[196:199], v[240:243], v[32:35]
  v_mfma_f32_16x16x32_bf16 v[36:39], v[180:183], v[244:247], v[36:39]
  v_mfma_f32_16x16x32_bf16 v[40:43], v[184:187], v[244:247], v[40:43]
  v_mfma_f32_16x16x32_bf16 v[44:47], v[188:191], v[244:247], v[44:47]
  v_mfma_f32_16x16x32_bf16 v[48:51], v[192:195], v[244:247], v[48:51]
  ds_write_b128 v9, v[16:19] offset:0
  v_mfma_f32_16x16x32_bf16 v[52:55], v[196:199], v[244:247], v[52:55]
  ds_write_b128 v9, v[20:23] offset:1024
  v_mfma_f32_16x16x32_bf16 v[56:59], v[180:183], v[248:251], v[56:59]
  ds_write_b128 v9, v[24:27] offset:2048
  v_mfma_f32_16x16x32_bf16 v[60:63], v[184:187], v[248:251], v[60:63]
  ds_write_b128 v9, v[28:31] offset:3072
  v_mfma_f32_16x16x32_bf16 v[64:67], v[188:191], v[248:251], v[64:67]
  ds_write_b128 v9, v[32:35] offset:4096
  v_mfma_f32_16x16x32_bf16 v[68:71], v[192:195], v[248:251], v[68:71]
  ds_write_b128 v8, v[36:39] offset:0
  v_mfma_f32_16x16x32_bf16 v[72:75], v[196:199], v[248:251], v[72:75]
  ds_write_b128 v8, v[40:43] offset:1024
  v_mfma_f32_16x16x32_bf16 v[76:79], v[180:183], v[252:255], v[76:79]
  ds_write_b128 v8, v[44:47] offset:2048
  v_mfma_f32_16x16x32_bf16 v[80:83], v[184:187], v[252:255], v[80:83]
  ds_write_b128 v8, v[48:51] offset:3072
  v_mfma_f32_16x16x32_bf16 v[84:87], v[188:191], v[252:255], v[84:87]
  ds_write_b128 v8, v[52:55] offset:4096
  v_mfma_f32_16x16x32_bf16 v[88:91], v[192:195], v[252:255], v[88:91]
  ds_write_b128 v8, v[56:59] offset:5120
  v_mfma_f32_16x16x32_bf16 v[92:95], v[196:199], v[252:255], v[92:95]
  ds_write_b128 v8, v[60:63] offset:6144
Pc_SKIP:
  s_nop 0
  s_waitcnt lgkmcnt(6)
  ds_write_b128 v8, v[64:67] offset:7168
  ds_write_b128 v8, v[68:71] offset:8192
  ds_write_b128 v8, v[72:75] offset:9216
  ds_write_b128 v8, v[76:79] offset:10240
  ds_write_b128 v8, v[80:83] offset:11264
  ds_write_b128 v8, v[84:87] offset:12288
  ds_write_b128 v8, v[88:91] offset:13312
  ds_write_b128 v8, v[92:95] offset:14336
  s_waitcnt lgkmcnt(0)
  s_barrier
  s_endpgm
P2_H:
  v_lshlrev_b32 v2, 4, v0
  v_add_u32 v3, 1024, v2
  v_and_b32 v1, 31, v0
  v_lshlrev_b32 v1, 4, v1
  s_lshl_b32 s10, s86, 9
  s_add_u32 s10, s10, 17956864
  s_mul_i32 s92, s86, 94
  s_add_u32 s92, s92, 93
  s_lshl_b32 s92, s92, 12
  s_add_u32 s11, s7, 0
  s_and_b32 s11, s11, 3
  s_lshl_b32 s11, s11, 10
  v_add_u32 v4, s11, v2
  s_add_u32 s11, s7, 1
  s_and_b32 s11, s11, 3
  s_lshl_b32 s11, s11, 10
  v_add_u32 v5, s11, v2
  s_add_u32 s11, s7, 2
  s_and_b32 s11, s11, 3
  s_lshl_b32 s11, s11, 10
  v_add_u32 v6, s11, v2
  s_add_u32 s11, s7, 3
  s_and_b32 s11, s11, 3
  s_lshl_b32 s11, s11, 10
  v_add_u32 v7, s11, v2
  s_mul_i32 s11, s7, 5120
  s_add_u32 s11, s11, 63488
  v_add_u32 v8, s11, v2
  v_add_u32 v9, 40960, v8
  s_mov_b32 s56, s32
  s_and_b32 s57, s33, 0xffff
  s_mov_b32 s58, 1280
  s_mov_b32 s59, 0x20000
  s_mov_b32 s60, s42
  s_and_b32 s61, s43, 0xffff
  s_mov_b32 s62, 5242880
  s_mov_b32 s63, 0x20000
  s_lshl_b32 s11, s86, 6
  s_lshl_b32 s12, s7, 3
  s_add_u32 s11, s11, s12
  v_bfe_u32 v12, v0, 2, 2
  v_add_u32 v12, s11, v12
  v_bfe_u32 v11, v0, 4, 1
  v_lshl_add_u32 v12, v11, 5, v12
  v_bfe_u32 v11, v0, 5, 1
  v_lshl_add_u32 v12, v11, 2, v12
  v_and_b32 v11, 3, v0
  v_lshlrev_b32 v11, 3, v11
  s_mul_i32 s11, s87, 160
  v_add_u32 v11, s11, v11
  v_mul_u32_u24 v10, 1280, v12
  v_add_u32 v10, v10, v11
  v_lshlrev_b32 v12, 3, v12
  s_mov_b32 s93, 16777216
  s_setprio 1
  s_cmp_eq_u32 s7, 0
  s_cbranch_scc0 Ph_NP
Ph_NP:
  s_barrier
  s_add_u32 s91, s89, 0
  buffer_load_dwordx4 v[96:99], v4, s[48:51], s91 offen sc1
  buffer_load_dwordx4 v[100:103], v5, s[48:51], s91 offen sc1
  buffer_load_dwordx4 v[104:107], v6, s[48:51], s91 offen sc1
  buffer_load_dwordx4 v[108:111], v7, s[48:51], s91 offen sc1
  s_add_u32 s91, s89, 16384
  buffer_load_dwordx4 v[112:115], v4, s[48:51], s91 offen sc1
  buffer_load_dwordx4 v[116:119], v5, s[48:51], s91 offen sc1
  buffer_load_dwordx4 v[120:123], v6, s[48:51], s91 offen sc1
  buffer_load_dwordx4 v[124:127], v7, s[48:51], s91 offen sc1
  s_add_u32 s91, s89, 32768
  buffer_load_dwordx4 v[128:131], v4, s[48:51], s91 offen sc1
  buffer_load_dwordx4 v[132:135], v5, s[48:51], s91 offen sc1
  buffer_load_dwordx4 v[136:139], v6, s[48:51], s91 offen sc1
  buffer_load_dwordx4 v[140:143], v7, s[48:51], s91 offen sc1
  s_add_u32 s91, s89, 49152
  buffer_load_dwordx4 v[144:147], v4, s[48:51], s91 offen sc1
  buffer_load_dwordx4 v[148:151], v5, s[48:51], s91 offen sc1
  buffer_load_dwordx4 v[152:155], v6, s[48:51], s91 offen sc1
  buffer_load_dwordx4 v[156:159], v7, s[48:51], s91 offen sc1
  s_waitcnt vmcnt(12)
  v_mfma_f32_16x16x32_bf16 v[16:19], v[160:163], v[96:99], 0
  v_mfma_f32_16x16x32_bf16 v[20:23], v[164:167], v[96:99], 0
  s_add_u32 s91, s89, 65536
  buffer_load_dwordx4 v[240:243], v4, s[48:51], s91 offen sc1
  buffer_load_dwordx4 v[244:247], v5, s[48:51], s91 offen sc1
  buffer_load_dwordx4 v[248:251], v6, s[48:51], s91 offen sc1
  buffer_load_dwordx4 v[252:255], v7, s[48:51], s91 offen sc1
  v_mfma_f32_16x16x32_bf16 v[24:27], v[168:171], v[96:99], 0
  v_mfma_f32_16x16x32_bf16 v[28:31], v[172:175], v[96:99], 0
  v_mfma_f32_16x16x32_bf16 v[32:35], v[176:179], v[96:99], 0
  v_mfma_f32_16x16x32_bf16 v[36:39], v[160:163], v[100:103], 0
  v_mfma_f32_16x16x32_bf16 v[40:43], v[164:167], v[100:103], 0
  v_mfma_f32_16x16x32_bf16 v[44:47], v[168:171], v[100:103], 0
  v_mfma_f32_16x16x32_bf16 v[48:51], v[172:175], v[100:103], 0
  v_mfma_f32_16x16x32_bf16 v[52:55], v[176:179], v[100:103], 0
  v_mfma_f32_16x16x32_bf16 v[56:59], v[160:163], v[104:107], 0
  v_mfma_f32_16x16x32_bf16 v[60:63], v[164:167], v[104:107], 0
  v_mfma_f32_16x16x32_bf16 v[64:67], v[168:171], v[104:107], 0
  v_mfma_f32_16x16x32_bf16 v[68:71], v[172:175], v[104:107], 0
  v_mfma_f32_16x16x32_bf16 v[72:75], v[176:179], v[104:107], 0
  v_mfma_f32_16x16x32_bf16 v[76:79], v[160:163], v[108:111], 0
  v_mfma_f32_16x16x32_bf16 v[80:83], v[164:167], v[108:111], 0
  v_mfma_f32_16x16x32_bf16 v[84:87], v[168:171], v[108:111], 0
  v_mfma_f32_16x16x32_bf16 v[88:91], v[172:175], v[108:111], 0
  v_mfma_f32_16x16x32_bf16 v[92:95], v[176:179], v[108:111], 0
  s_waitcnt vmcnt(12)
  v_mfma_f32_16x16x32_bf16 v[16:19], v[180:183], v[112:115], v[16:19]
  v_mfma_f32_16x16x32_bf16 v[20:23], v[184:187], v[112:115], v[20:23]
  s_add_u32 s91, s89, 81920
  buffer_load_dwordx4 v[96:99], v4, s[48:51], s91 offen sc1
  buffer_load_dwordx4 v[100:103], v5, s[48:51], s91 offen sc1
  buffer_load_dwordx4 v[104:107], v6, s[48:51], s91 offen sc1
  buffer_load_dwordx4 v[108:111], v7, s[48:51], s91 offen sc1
  s_add_u32 s91, s88, 81920
  buffer_load_dwordx4 v[160:163], v2, s[48:51], s91 offen offset:0 sc1
  buffer_load_dwordx4 v[164:167], v2, s[48:51], s91 offen offset:1024 sc1
  buffer_load_dwordx4 v[168:171], v2, s[48:51], s91 offen offset:2048 sc1
  buffer_load_dwordx4 v[172:175], v2, s[48:51], s91 offen offset:3072 sc1
  buffer_load_dwordx4 v[176:179], v3, s[48:51], s91 offen offset:3072 sc1
  v_mfma_f32_16x16x32_bf16 v[24:27], v[188:191], v[112:115], v[24:27]
  v_mfma_f32_16x16x32_bf16 v[28:31], v[192:195], v[112:115], v[28:31]
  v_mfma_f32_16x16x32_bf16 v[32:35], v[196:199], v[112:115], v[32:35]
  v_mfma_f32_16x16x32_bf16 v[36:39], v[180:183], v[116:119], v[36:39]
  v_mfma_f32_16x16x32_bf16 v[40:43], v[184:187], v[116:119], v[40:43]
  v_mfma_f32_16x16x32_bf16 v[44:47], v[188:191], v[116:119], v[44:47]
  v_mfma_f32_16x16x32_bf16 v[48:51], v[192:195], v[116:119], v[48:51]
  v_mfma_f32_16x16x32_bf16 v[52:55], v[196:199], v[116:119], v[52:55]
  v_mfma_f32_16x16x32_bf16 v[56:59], v[180:183], v[120:123], v[56:59]
  v_mfma_f32_16x16x32_bf16 v[60:63], v[184:187], v[120:123], v[60:63]
  v_mfma_f32_16x16x32_bf16 v[64:67], v[188:191], v[120:123], v[64:67]
  v_mfma_f32_16x16x32_bf16 v[68:71], v[192:195], v[120:123], v[68:71]
  v_mfma_f32_16x16x32_bf16 v[72:75], v[196:199], v[120:123], v[72:75]
  v_mfma_f32_16x16x32_bf16 v[76:79], v[180:183], v[124:127], v[76:79]
  v_mfma_f32_16x16x32_bf16 v[80:83], v[184:187], v[124:127], v[80:83]
  v_mfma_f32_16x16x32_bf16 v[84:87], v[188:191], v[124:127], v[84:87]
  v_mfma_f32_16x16x32_bf16 v[88:91], v[192:195], v[124:127], v[88:91]
  v_mfma_f32_16x16x32_bf16 v[92:95], v[196:199], v[124:127], v[92:95]
  s_waitcnt vmcnt(17)
  v_mfma_f32_16x16x32_bf16 v[16:19], v[200:203], v[128:131], v[16:19]
  v_mfma_f32_16x16x32_bf16 v[20:23], v[204:207], v[128:131], v[20:23]
  s_add_u32 s91, s89, 98304
  buffer_load_dwordx4 v[112:115], v4, s[48:51], s91 offen sc1
  buffer_load_dwordx4 v[116:119], v5, s[48:51], s91 offen sc1
  buffer_load_dwordx4 v[120:123], v6, s[48:51], s91 offen sc1
  buffer_load_dwordx4 v[124:127], v7, s[48:51], s91 offen sc1
  ds_read_b128 v[180:183], v8 offset:0
  ds_read_b128 v[184:187], v8 offset:1024
  ds_read_b128 v[188:191], v8 offset:2048
  ds_read_b128 v[192:195], v8 offset:3072
  ds_read_b128 v[196:199], v8 offset:4096
  v_mfma_f32_16x16x32_bf16 v[24:27], v[208:211], v[128:131], v[24:27]
  v_mfma_f32_16x16x32_bf16 v[28:31], v[212:215], v[128:131], v[28:31]
  v_mfma_f32_16x16x32_bf16 v[32:35], v[216:219], v[128:131], v[32:35]
  v_mfma_f32_16x16x32_bf16 v[36:39], v[200:203], v[132:135], v[36:39]
  v_mfma_f32_16x16x32_bf16 v[40:43], v[204:207], v[132:135], v[40:43]
  v_mfma_f32_16x16x32_bf16 v[44:47], v[208:211], v[132:135], v[44:47]
  v_mfma_f32_16x16x32_bf16 v[48:51], v[212:215], v[132:135], v[48:51]
  v_mfma_f32_16x16x32_bf16 v[52:55], v[216:219], v[132:135], v[52:55]
  v_mfma_f32_16x16x32_bf16 v[56:59], v[200:203], v[136:139], v[56:59]
  v_mfma_f32_16x16x32_bf16 v[60:63], v[204:207], v[136:139], v[60:63]
  v_mfma_f32_16x16x32_bf16 v[64:67], v[208:211], v[136:139], v[64:67]
  v_mfma_f32_16x16x32_bf16 v[68:71], v[212:215], v[136:139], v[68:71]
  v_mfma_f32_16x16x32_bf16 v[72:75], v[216:219], v[136:139], v[72:75]
  v_mfma_f32_16x16x32_bf16 v[76:79], v[200:203], v[140:143], v[76:79]
  v_mfma_f32_16x16x32_bf16 v[80:83], v[204:207], v[140:143], v[80:83]
  v_mfma_f32_16x16x32_bf16 v[84:87], v[208:211], v[140:143], v[84:87]
  v_mfma_f32_16x16x32_bf16 v[88:91], v[212:215], v[140:143], v[88:91]
  v_mfma_f32_16x16x32_bf16 v[92:95], v[216:219], v[140:143], v[92:95]
  s_waitcnt vmcnt(17)
  v_mfma_f32_16x16x32_bf16 v[16:19], v[220:223], v[144:147], v[16:19]
  v_mfma_f32_16x16x32_bf16 v[20:23], v[224:227], v[144:147], v[20:23]
  s_add_u32 s91, s89, 114688
  buffer_load_dwordx4 v[128:131], v4, s[48:51], s91 offen sc1
  buffer_load_dwordx4 v[132:135], v5, s[48:51], s91 offen sc1
  buffer_load_dwordx4 v[136:139], v6, s[48:51], s91 offen sc1
  buffer_load_dwordx4 v[140:143], v7, s[48:51], s91 offen sc1
  s_add_u32 s91, s88, 122880
  buffer_load_dwordx4 v[200:203], v2, s[48:51], s91 offen offset:0 sc1
  buffer_load_dwordx4 v[204:207], v2, s[48:51], s91 offen offset:1024 sc1
  buffer_load_dwordx4 v[208:211], v2, s[48:51], s91 offen offset:2048 sc1
  buffer_load_dwordx4 v[212:215], v2, s[48:51], s91 offen offset:3072 sc1
  buffer_load_dwordx4 v[216:219], v3, s[48:51], s91 offen offset:3072 sc1
  v_mfma_f32_16x16x32_bf16 v[24:27], v[228:231], v[144:147], v[24:27]
  v_mfma_f32_16x16x32_bf16 v[28:31], v[232:235], v[144:147], v[28:31]
  v_mfma_f32_16x16x32_bf16 v[32:35], v[236:239], v[144:147], v[32:35]
  v_mfma_f32_16x16x32_bf16 v[36:39], v[220:223], v[148:151], v[36:39]
  v_mfma_f32_16x16x32_bf16 v[40:43], v[224:227], v[148:151], v[40:43]
  v_mfma_f32_16x16x32_bf16 v[44:47], v[228:231], v[148:151], v[44:47]
  v_mfma_f32_16x16x32_bf16 v[48:51], v[232:235], v[148:151], v[48:51]
  v_mfma_f32_16x16x32_bf16 v[52:55], v[236:239], v[148:151], v[52:55]
  v_mfma_f32_16x16x32_bf16 v[56:59], v[220:223], v[152:155], v[56:59]
  v_mfma_f32_16x16x32_bf16 v[60:63], v[224:227], v[152:155], v[60:63]
  v_mfma_f32_16x16x32_bf16 v[64:67], v[228:231], v[152:155], v[64:67]
  v_mfma_f32_16x16x32_bf16 v[68:71], v[232:235], v[152:155], v[68:71]
  v_mfma_f32_16x16x32_bf16 v[72:75], v[236:239], v[152:155], v[72:75]
  v_mfma_f32_16x16x32_bf16 v[76:79], v[220:223], v[156:159], v[76:79]
  v_mfma_f32_16x16x32_bf16 v[80:83], v[224:227], v[156:159], v[80:83]
  v_mfma_f32_16x16x32_bf16 v[84:87], v[228:231], v[156:159], v[84:87]
  v_mfma_f32_16x16x32_bf16 v[88:91], v[232:235], v[156:159], v[88:91]
  v_mfma_f32_16x16x32_bf16 v[92:95], v[236:239], v[156:159], v[92:95]
  s_waitcnt vmcnt(13)
  v_mfma_f32_16x16x32_bf16 v[16:19], v[160:163], v[240:243], v[16:19]
  v_mfma_f32_16x16x32_bf16 v[20:23], v[164:167], v[240:243], v[20:23]
  s_add_u32 s91, s89, 131072
  buffer_load_dwordx4 v[144:147], v4, s[48:51], s91 offen sc1
  buffer_load_dwordx4 v[148:151], v5, s[48:51], s91 offen sc1
  buffer_load_dwordx4 v[152:155], v6, s[48:51], s91 offen sc1
  buffer_load_dwordx4 v[156:159], v7, s[48:51], s91 offen sc1
  ds_read_b128 v[220:223], v8 offset:20480
  ds_read_b128 v[224:227], v8 offset:21504
  ds_read_b128 v[228:231], v8 offset:22528
  ds_read_b128 v[232:235], v8 offset:23552
  ds_read_b128 v[236:239], v8 offset:24576
  v_mfma_f32_16x16x32_bf16 v[24:27], v[168:171], v[240:243], v[24:27]
  v_mfma_f32_16x16x32_bf16 v[28:31], v[172:175], v[240:243], v[28:31]
  v_mfma_f32_16x16x32_bf16 v[32:35], v[176:179], v[240:243], v[32:35]
  v_mfma_f32_16x16x32_bf16 v[36:39], v[160:163], v[244:247], v[36:39]
  v_mfma_f32_16x16x32_bf16 v[40:43], v[164:167], v[244:247], v[40:43]
  v_mfma_f32_16x16x32_bf16 v[44:47], v[168:171], v[244:247], v[44:47]
  v_mfma_f32_16x16x32_bf16 v[48:51], v[172:175], v[244:247], v[48:51]
  v_mfma_f32_16x16x32_bf16 v[52:55], v[176:179], v[244:247], v[52:55]
  v_mfma_f32_16x16x32_bf16 v[56:59], v[160:163], v[248:251], v[56:59]
  v_mfma_f32_16x16x32_bf16 v[60:63], v[164:167], v[248:251], v[60:63]
  v_mfma_f32_16x16x32_bf16 v[64:67], v[168:171], v[248:251], v[64:67]
  v_mfma_f32_16x16x32_bf16 v[68:71], v[172:175], v[248:251], v[68:71]
  v_mfma_f32_16x16x32_bf16 v[72:75], v[176:179], v[248:251], v[72:75]
  v_mfma_f32_16x16x32_bf16 v[76:79], v[160:163], v[252:255], v[76:79]
  v_mfma_f32_16x16x32_bf16 v[80:83], v[164:167], v[252:255], v[80:83]
  v_mfma_f32_16x16x32_bf16 v[84:87], v[168:171], v[252:255], v[84:87]
  v_mfma_f32_16x16x32_bf16 v[88:91], v[172:175], v[252:255], v[88:91]
  v_mfma_f32_16x16x32_bf16 v[92:95], v[176:179], v[252:255], v[92:95]
  s_waitcnt vmcnt(22)
  s_waitcnt lgkmcnt(5)
  v_mfma_f32_16x16x32_bf16 v[16:19], v[180:183], v[96:99], v[16:19]
  v_mfma_f32_16x16x32_bf16 v[20:23], v[184:187], v[96:99], v[20:23]
  s_add_u32 s91, s89, 147456
  buffer_load_dwordx4 v[240:243], v4, s[48:51], s91 offen sc1
  buffer_load_dwordx4 v[244:247], v5, s[48:51], s91 offen sc1
  buffer_load_dwordx4 v[248:251], v6, s[48:51], s91 offen sc1
  buffer_load_dwordx4 v[252:255], v7, s[48:51], s91 offen sc1
  s_add_u32 s91, s88, 163840
  buffer_load_dwordx4 v[160:163], v2, s[48:51], s91 offen offset:0 sc1
  buffer_load_dwordx4 v[164:167], v2, s[48:51], s91 offen offset:1024 sc1
  buffer_load_dwordx4 v[168:171], v2, s[48:51], s91 offen offset:2048 sc1
  buffer_load_dwordx4 v[172:175], v2, s[48:51], s91 offen offset:3072 sc1
  buffer_load_dwordx4 v[176:179], v3, s[48:51], s91 offen offset:3072 sc1
  v_mfma_f32_16x16x32_bf16 v[24:27], v[188:191], v[96:99], v[24:27]
  v_mfma_f32_16x16x32_bf16 v[28:31], v[192:195], v[96:99], v[28:31]
  v_mfma_f32_16x16x32_bf16 v[32:35], v[196:199], v[96:99], v[32:35]
  v_mfma_f32_16x16x32_bf16 v[36:39], v[180:183], v[100:103], v[36:39]
  v_mfma_f32_16x16x32_bf16 v[40:43], v[184:187], v[100:103], v[40:43]
  v_mfma_f32_16x16x32_bf16 v[44:47], v[188:191], v[100:103], v[44:47]
  v_mfma_f32_16x16x32_bf16 v[48:51], v[192:195], v[100:103], v[48:51]
  v_mfma_f32_16x16x32_bf16 v[52:55], v[196:199], v[100:103], v[52:55]
  v_mfma_f32_16x16x32_bf16 v[56:59], v[180:183], v[104:107], v[56:59]
  v_mfma_f32_16x16x32_bf16 v[60:63], v[184:187], v[104:107], v[60:63]
  v_mfma_f32_16x16x32_bf16 v[64:67], v[188:191], v[104:107], v[64:67]
  v_mfma_f32_16x16x32_bf16 v[68:71], v[192:195], v[104:107], v[68:71]
  v_mfma_f32_16x16x32_bf16 v[72:75], v[196:199], v[104:107], v[72:75]
  v_mfma_f32_16x16x32_bf16 v[76:79], v[180:183], v[108:111], v[76:79]
  v_mfma_f32_16x16x32_bf16 v[80:83], v[184:187], v[108:111], v[80:83]
  v_mfma_f32_16x16x32_bf16 v[84:87], v[188:191], v[108:111], v[84:87]
  v_mfma_f32_16x16x32_bf16 v[88:91], v[192:195], v[108:111], v[88:91]
  v_mfma_f32_16x16x32_bf16 v[92:95], v[196:199], v[108:111], v[92:95]
  s_waitcnt vmcnt(13)
  v_mfma_f32_16x16x32_bf16 v[16:19], v[200:203], v[112:115], v[16:19]
  v_mfma_f32_16x16x32_bf16 v[20:23], v[204:207], v[112:115], v[20:23]
  s_add_u32 s91, s89, 163840
  buffer_load_dwordx4 v[96:99], v4, s[48:51], s91 offen sc1
  buffer_load_dwordx4 v[100:103], v5, s[48:51], s91 offen sc1
  buffer_load_dwordx4 v[104:107], v6, s[48:51], s91 offen sc1
  buffer_load_dwordx4 v[108:111], v7, s[48:51], s91 offen sc1
  ds_read_b128 v[180:183], v9 offset:0
  ds_read_b128 v[184:187], v9 offset:1024
  ds_read_b128 v[188:191], v9 offset:2048
  ds_read_b128 v[192:195], v9 offset:3072
  ds_read_b128 v[196:199], v9 offset:4096
  v_mfma_f32_16x16x32_bf16 v[24:27], v[208:211], v[112:115], v[24:27]
  v_mfma_f32_16x16x32_bf16 v[28:31], v[212:215], v[112:115], v[28:31]
  v_mfma_f32_16x16x32_bf16 v[32:35], v[216:219], v[112:115], v[32:35]
  v_mfma_f32_16x16x32_bf16 v[36:39], v[200:203], v[116:119], v[36:39]
  v_mfma_f32_16x16x32_bf16 v[40:43], v[204:207], v[116:119], v[40:43]
  v_mfma_f32_16x16x32_bf16 v[44:47], v[208:211], v[116:119], v[44:47]
  v_mfma_f32_16x16x32_bf16 v[48:51], v[212:215], v[116:119], v[48:51]
  v_mfma_f32_16x16x32_bf16 v[52:55], v[216:219], v[116:119], v[52:55]
  v_mfma_f32_16x16x32_bf16 v[56:59], v[200:203], v[120:123], v[56:59]
  v_mfma_f32_16x16x32_bf16 v[60:63], v[204:207], v[120:123], v[60:63]
  v_mfma_f32_16x16x32_bf16 v[64:67], v[208:211], v[120:123], v[64:67]
  v_mfma_f32_16x16x32_bf16 v[68:71], v[212:215], v[120:123], v[68:71]
  v_mfma_f32_16x16x32_bf16 v[72:75], v[216:219], v[120:123], v[72:75]
  v_mfma_f32_16x16x32_bf16 v[76:79], v[200:203], v[124:127], v[76:79]
  v_mfma_f32_16x16x32_bf16 v[80:83], v[204:207], v[124:127], v[80:83]
  v_mfma_f32_16x16x32_bf16 v[84:87], v[208:211], v[124:127], v[84:87]
  v_mfma_f32_16x16x32_bf16 v[88:91], v[212:215], v[124:127], v[88:91]
  v_mfma_f32_16x16x32_bf16 v[92:95], v[216:219], v[124:127], v[92:95]
  s_waitcnt vmcnt(22)
  s_waitcnt lgkmcnt(5)
  v_mfma_f32_16x16x32_bf16 v[16:19], v[220:223], v[128:131], v[16:19]
  v_mfma_f32_16x16x32_bf16 v[20:23], v[224:227], v[128:131], v[20:23]
  s_add_u32 s91, s89, 180224
  buffer_load_dwordx4 v[112:115], v4, s[48:51], s91 offen sc1
  buffer_load_dwordx4 v[116:119], v5, s[48:51], s91 offen sc1
  buffer_load_dwordx4 v[120:123], v6, s[48:51], s91 offen sc1
  buffer_load_dwordx4 v[124:127], v7, s[48:51], s91 offen sc1
  s_add_u32 s91, s88, 204800
  buffer_load_dwordx4 v[200:203], v2, s[48:51], s91 offen offset:0 sc1
  buffer_load_dwordx4 v[204:207], v2, s[48:51], s91 offen offset:1024 sc1
  buffer_load_dwordx4 v[208:211], v2, s[48:51], s91 offen offset:2048 sc1
  buffer_load_dwordx4 v[212:215], v2, s[48:51], s91 offen offset:3072 sc1
  buffer_load_dwordx4 v[216:219], v3, s[48:51], s91 offen offset:3072 sc1
  v_mfma_f32_16x16x32_bf16 v[24:27], v[228:231], v[128:131], v[24:27]
  v_mfma_f32_16x16x32_bf16 v[28:31], v[232:235], v[128:131], v[28:31]
  v_mfma_f32_16x16x32_bf16 v[32:35], v[236:239], v[128:131], v[32:35]
  v_mfma_f32_16x16x32_bf16 v[36:39], v[220:223], v[132:135], v[36:39]
  v_mfma_f32_16x16x32_bf16 v[40:43], v[224:227], v[132:135], v[40:43]
  v_mfma_f32_16x16x32_bf16 v[44:47], v[228:231], v[132:135], v[44:47]
  v_mfma_f32_16x16x32_bf16 v[48:51], v[232:235], v[132:135], v[48:51]
  v_mfma_f32_16x16x32_bf16 v[52:55], v[236:239], v[132:135], v[52:55]
  v_mfma_f32_16x16x32_bf16 v[56:59], v[220:223], v[136:139], v[56:59]
  v_mfma_f32_16x16x32_bf16 v[60:63], v[224:227], v[136:139], v[60:63]
  v_mfma_f32_16x16x32_bf16 v[64:67], v[228:231], v[136:139], v[64:67]
  v_mfma_f32_16x16x32_bf16 v[68:71], v[232:235], v[136:139], v[68:71]
  v_mfma_f32_16x16x32_bf16 v[72:75], v[236:239], v[136:139], v[72:75]
  v_mfma_f32_16x16x32_bf16 v[76:79], v[220:223], v[140:143], v[76:79]
  v_mfma_f32_16x16x32_bf16 v[80:83], v[224:227], v[140:143], v[80:83]
  v_mfma_f32_16x16x32_bf16 v[84:87], v[228:231], v[140:143], v[84:87]
  v_mfma_f32_16x16x32_bf16 v[88:91], v[232:235], v[140:143], v[88:91]
  v_mfma_f32_16x16x32_bf16 v[92:95], v[236:239], v[140:143], v[92:95]
  s_barrier
  s_waitcnt vmcnt(13)
  v_mfma_f32_16x16x32_bf16 v[16:19], v[160:163], v[144:147], v[16:19]
  v_mfma_f32_16x16x32_bf16 v[20:23], v[164:167], v[144:147], v[20:23]
  s_add_u32 s91, s89, 196608
  buffer_load_dwordx4 v[128:131], v4, s[48:51], s91 offen sc1
  buffer_load_dwordx4 v[132:135], v5, s[48:51], s91 offen sc1
  buffer_load_dwordx4 v[136:139], v6, s[48:51], s91 offen sc1
  buffer_load_dwordx4 v[140:143], v7, s[48:51], s91 offen sc1
  ds_read_b128 v[220:223], v9 offset:20480
  ds_read_b128 v[224:227], v9 offset:21504
  ds_read_b128 v[228:231], v9 offset:22528
  ds_read_b128 v[232:235], v9 offset:23552
  ds_read_b128 v[236:239], v9 offset:24576
  v_mfma_f32_16x16x32_bf16 v[24:27], v[168:171], v[144:147], v[24:27]
  v_mfma_f32_16x16x32_bf16 v[28:31], v[172:175], v[144:147], v[28:31]
  v_mfma_f32_16x16x32_bf16 v[32:35], v[176:179], v[144:147], v[32:35]
  v_mfma_f32_16x16x32_bf16 v[36:39], v[160:163], v[148:151], v[36:39]
  v_mfma_f32_16x16x32_bf16 v[40:43], v[164:167], v[148:151], v[40:43]
  v_mfma_f32_16x16x32_bf16 v[44:47], v[168:171], v[148:151], v[44:47]
  v_mfma_f32_16x16x32_bf16 v[48:51], v[172:175], v[148:151], v[48:51]
  v_mfma_f32_16x16x32_bf16 v[52:55], v[176:179], v[148:151], v[52:55]
  v_mfma_f32_16x16x32_bf16 v[56:59], v[160:163], v[152:155], v[56:59]
  v_mfma_f32_16x16x32_bf16 v[60:63], v[164:167], v[152:155], v[60:63]
  v_mfma_f32_16x16x32_bf16 v[64:67], v[168:171], v[152:155], v[64:67]
  v_mfma_f32_16x16x32_bf16 v[68:71], v[172:175], v[152:155], v[68:71]
  v_mfma_f32_16x16x32_bf16 v[72:75], v[176:179], v[152:155], v[72:75]
  v_mfma_f32_16x16x32_bf16 v[76:79], v[160:163], v[156:159], v[76:79]
  v_mfma_f32_16x16x32_bf16 v[80:83], v[164:167], v[156:159], v[80:83]
  v_mfma_f32_16x16x32_bf16 v[84:87], v[168:171], v[156:159], v[84:87]
  v_mfma_f32_16x16x32_bf16 v[88:91], v[172:175], v[156:159], v[88:91]
  v_mfma_f32_16x16x32_bf16 v[92:95], v[176:179], v[156:159], v[92:95]
  s_waitcnt vmcnt(22)
  s_waitcnt lgkmcnt(5)
  v_mfma_f32_16x16x32_bf16 v[16:19], v[180:183], v[240:243], v[16:19]
  v_mfma_f32_16x16x32_bf16 v[20:23], v[184:187], v[240:243], v[20:23]
  s_add_u32 s91, s89, 212992
  s_cmp_ge_u32 s7, 2
  s_cselect_b32 s91, 20971520, s91
  buffer_load_dwordx4 v[144:147], v4, s[48:51], s91 offen sc1
  buffer_load_dwordx4 v[148:151], v5, s[48:51], s91 offen sc1
  buffer_load_dwordx4 v[152:155], v6, s[48:51], s91 offen sc1
  buffer_load_dwordx4 v[156:159], v7, s[48:51], s91 offen sc1
  s_add_u32 s91, s88, 245760
  buffer_load_dwordx4 v[160:163], v2, s[48:51], s91 offen offset:0 sc1
  buffer_load_dwordx4 v[164:167], v2, s[48:51], s91 offen offset:1024 sc1
  buffer_load_dwordx4 v[168:171], v2, s[48:51], s91 offen offset:2048 sc1
  buffer_load_dwordx4 v[172:175], v2, s[48:51], s91 offen offset:3072 sc1
  buffer_load_dwordx4 v[176:179], v3, s[48:51], s91 offen offset:3072 sc1
  v_mfma_f32_16x16x32_bf16 v[24:27], v[188:191], v[240:243], v[24:27]
  v_mfma_f32_16x16x32_bf16 v[28:31], v[192:195], v[240:243], v[28:31]
  v_mfma_f32_16x16x32_bf16 v[32:35], v[196:199], v[240:243], v[32:35]
  v_mfma_f32_16x16x32_bf16 v[36:39], v[180:183], v[244:247], v[36:39]
  v_mfma_f32_16x16x32_bf16 v[40:43], v[184:187], v[244:247], v[40:43]
  v_mfma_f32_16x16x32_bf16 v[44:47], v[188:191], v[244:247], v[44:47]
  v_mfma_f32_16x16x32_bf16 v[48:51], v[192:195], v[244:247], v[48:51]
  v_mfma_f32_16x16x32_bf16 v[52:55], v[196:199], v[244:247], v[52:55]
  v_mfma_f32_16x16x32_bf16 v[56:59], v[180:183], v[248:251], v[56:59]
  v_mfma_f32_16x16x32_bf16 v[60:63], v[184:187], v[248:251], v[60:63]
  v_mfma_f32_16x16x32_bf16 v[64:67], v[188:191], v[248:251], v[64:67]
  v_mfma_f32_16x16x32_bf16 v[68:71], v[192:195], v[248:251], v[68:71]
  v_mfma_f32_16x16x32_bf16 v[72:75], v[196:199], v[248:251], v[72:75]
  v_mfma_f32_16x16x32_bf16 v[76:79], v[180:183], v[252:255], v[76:79]
  v_mfma_f32_16x16x32_bf16 v[80:83], v[184:187], v[252:255], v[80:83]
  v_mfma_f32_16x16x32_bf16 v[84:87], v[188:191], v[252:255], v[84:87]
  v_mfma_f32_16x16x32_bf16 v[88:91], v[192:195], v[252:255], v[88:91]
  v_mfma_f32_16x16x32_bf16 v[92:95], v[196:199], v[252:255], v[92:95]
  s_waitcnt vmcnt(13)
  v_mfma_f32_16x16x32_bf16 v[16:19], v[200:203], v[96:99], v[16:19]
  v_mfma_f32_16x16x32_bf16 v[20:23], v[204:207], v[96:99], v[20:23]
  s_add_u32 s91, s88, 266240
  s_cmp_ge_u32 s7, 2
  s_cselect_b32 s91, 20971520, s91
  buffer_load_dwordx4 v[180:183], v2, s[48:51], s91 offen offset:0 sc1
  buffer_load_dwordx4 v[184:187], v2, s[48:51], s91 offen offset:1024 sc1
  buffer_load_dwordx4 v[188:191], v2, s[48:51], s91 offen offset:2048 sc1
  buffer_load_dwordx4 v[192:195], v2, s[48:51], s91 offen offset:3072 sc1
  buffer_load_dwordx4 v[196:199], v3, s[48:51], s91 offen offset:3072 sc1
  v_mfma_f32_16x16x32_bf16 v[24:27], v[208:211], v[96:99], v[24:27]
  v_mfma_f32_16x16x32_bf16 v[28:31], v[212:215], v[96:99], v[28:31]
  v_mfma_f32_16x16x32_bf16 v[32:35], v[216:219], v[96:99], v[32:35]
  v_mfma_f32_16x16x32_bf16 v[36:39], v[200:203], v[100:103], v[36:39]
  v_mfma_f32_16x16x32_bf16 v[40:43], v[204:207], v[100:103], v[40:43]
  v_mfma_f32_16x16x32_bf16 v[44:47], v[208:211], v[100:103], v[44:47]
  v_mfma_f32_16x16x32_bf16 v[48:51], v[212:215], v[100:103], v[48:51]
  v_mfma_f32_16x16x32_bf16 v[52:55], v[216:219], v[100:103], v[52:55]
  v_mfma_f32_16x16x32_bf16 v[56:59], v[200:203], v[104:107], v[56:59]
  v_mfma_f32_16x16x32_bf16 v[60:63], v[204:207], v[104:107], v[60:63]
  v_mfma_f32_16x16x32_bf16 v[64:67], v[208:211], v[104:107], v[64:67]
  v_mfma_f32_16x16x32_bf16 v[68:71], v[212:215], v[104:107], v[68:71]
  v_mfma_f32_16x16x32_bf16 v[72:75], v[216:219], v[104:107], v[72:75]
  v_mfma_f32_16x16x32_bf16 v[76:79], v[200:203], v[108:111], v[76:79]
  v_mfma_f32_16x16x32_bf16 v[80:83], v[204:207], v[108:111], v[80:83]
  v_mfma_f32_16x16x32_bf16 v[84:87], v[208:211], v[108:111], v[84:87]
  v_mfma_f32_16x16x32_bf16 v[88:91], v[212:215], v[108:111], v[88:91]
  v_mfma_f32_16x16x32_bf16 v[92:95], v[216:219], v[108:111], v[92:95]
  s_waitcnt vmcnt(23)
  s_waitcnt lgkmcnt(0)
  v_mfma_f32_16x16x32_bf16 v[16:19], v[220:223], v[112:115], v[16:19]
  v_mfma_f32_16x16x32_bf16 v[20:23], v[224:227], v[112:115], v[20:23]
  buffer_load_dwordx2 v[96:97], v10, s[52:55], 0 offen offset:0
  buffer_load_dwordx2 v[98:99], v11, s[56:59], 0 offen offset:0
  buffer_load_dwordx2 v[100:101], v10, s[52:55], 0 offen offset:32
  buffer_load_dwordx2 v[102:103], v11, s[56:59], 0 offen offset:32
  buffer_load_dwordx2 v[104:105], v10, s[52:55], 0 offen offset:64
  buffer_load_dwordx2 v[106:107], v11, s[56:59], 0 offen offset:64
  buffer_load_dwordx2 v[108:109], v10, s[52:55], 0 offen offset:96
  buffer_load_dwordx2 v[110:111], v11, s[56:59], 0 offen offset:96
  buffer_load_dwordx2 v[240:241], v10, s[52:55], 0 offen offset:128
  buffer_load_dwordx2 v[242:243], v11, s[56:59], 0 offen offset:128
  buffer_load_dword v13, v12, s[48:51], s93 offen sc1
  v_mfma_f32_16x16x32_bf16 v[24:27], v[228:231], v[112:115], v[24:27]
  v_mfma_f32_16x16x32_bf16 v[28:31], v[232:235], v[112:115], v[28:31]
  v_mfma_f32_16x16x32_bf16 v[32:35], v[236:239], v[112:115], v[32:35]
  v_mfma_f32_16x16x32_bf16 v[36:39], v[220:223], v[116:119], v[36:39]
  v_mfma_f32_16x16x32_bf16 v[40:43], v[224:227], v[116:119], v[40:43]
  v_mfma_f32_16x16x32_bf16 v[44:47], v[228:231], v[116:119], v[44:47]
  v_mfma_f32_16x16x32_bf16 v[48:51], v[232:235], v[116:119], v[48:51]
  v_mfma_f32_16x16x32_bf16 v[52:55], v[236:239], v[116:119], v[52:55]
  v_mfma_f32_16x16x32_bf16 v[56:59], v[220:223], v[120:123], v[56:59]
  v_mfma_f32_16x16x32_bf16 v[60:63], v[224:227], v[120:123], v[60:63]
  v_mfma_f32_16x16x32_bf16 v[64:67], v[228:231], v[120:123], v[64:67]
  v_mfma_f32_16x16x32_bf16 v[68:71], v[232:235], v[120:123], v[68:71]
  v_mfma_f32_16x16x32_bf16 v[72:75], v[236:239], v[120:123], v[72:75]
  v_mfma_f32_16x16x32_bf16 v[76:79], v[220:223], v[124:127], v[76:79]
  v_mfma_f32_16x16x32_bf16 v[80:83], v[224:227], v[124:127], v[80:83]
  v_mfma_f32_16x16x32_bf16 v[84:87], v[228:231], v[124:127], v[84:87]
  v_mfma_f32_16x16x32_bf16 v[88:91], v[232:235], v[124:127], v[88:91]
  v_mfma_f32_16x16x32_bf16 v[92:95], v[236:239], v[124:127], v[92:95]
  s_waitcnt vmcnt(16)
  v_mfma_f32_16x16x32_bf16 v[16:19], v[160:163], v[128:131], v[16:19]
  v_mfma_f32_16x16x32_bf16 v[20:23], v[164:167], v[128:131], v[20:23]
  v_mfma_f32_16x16x32_bf16 v[24:27], v[168:171], v[128:131], v[24:27]
  v_mfma_f32_16x16x32_bf16 v[28:31], v[172:175], v[128:131], v[28:31]
  v_mfma_f32_16x16x32_bf16 v[32:35], v[176:179], v[128:131], v[32:35]
  v_mfma_f32_16x16x32_bf16 v[36:39], v[160:163], v[132:135], v[36:39]
  v_mfma_f32_16x16x32_bf16 v[40:43], v[164:167], v[132:135], v[40:43]
  v_mfma_f32_16x16x32_bf16 v[44:47], v[168:171], v[132:135], v[44:47]
  v_mfma_f32_16x16x32_bf16 v[48:51], v[172:175], v[132:135], v[48:51]
  v_mfma_f32_16x16x32_bf16 v[52:55], v[176:179], v[132:135], v[52:55]
  v_mfma_f32_16x16x32_bf16 v[56:59], v[160:163], v[136:139], v[56:59]
  v_mfma_f32_16x16x32_bf16 v[60:63], v[164:167], v[136:139], v[60:63]
  v_mfma_f32_16x16x32_bf16 v[64:67], v[168:171], v[136:139], v[64:67]
  v_mfma_f32_16x16x32_bf16 v[68:71], v[172:175], v[136:139], v[68:71]
  v_mfma_f32_16x16x32_bf16 v[72:75], v[176:179], v[136:139], v[72:75]
  v_mfma_f32_16x16x32_bf16 v[76:79], v[160:163], v[140:143], v[76:79]
  v_mfma_f32_16x16x32_bf16 v[80:83], v[164:167], v[140:143], v[80:83]
  v_mfma_f32_16x16x32_bf16 v[84:87], v[168:171], v[140:143], v[84:87]
  v_mfma_f32_16x16x32_bf16 v[88:91], v[172:175], v[140:143], v[88:91]
  v_mfma_f32_16x16x32_bf16 v[92:95], v[176:179], v[140:143], v[92:95]
  s_waitcnt vmcnt(11)
  s_cmp_ge_u32 s7, 2
  s_cbranch_scc1 Ph_SKIP
  v_mfma_f32_16x16x32_bf16 v[16:19], v[180:183], v[144:147], v[16:19]
  v_mfma_f32_16x16x32_bf16 v[20:23], v[184:187], v[144:147], v[20:23]
  v_mfma_f32_16x16x32_bf16 v[24:27], v[188:191], v[144:147], v[24:27]
  v_mfma_f32_16x16x32_bf16 v[28:31], v[192:195], v[144:147], v[28:31]
  v_mfma_f32_16x16x32_bf16 v[32:35], v[196:199], v[144:147], v[32:35]
  v_mfma_f32_16x16x32_bf16 v[36:39], v[180:183], v[148:151], v[36:39]
  v_mfma_f32_16x16x32_bf16 v[40:43], v[184:187], v[148:151], v[40:43]
  v_mfma_f32_16x16x32_bf16 v[44:47], v[188:191], v[148:151], v[44:47]
  v_mfma_f32_16x16x32_bf16 v[48:51], v[192:195], v[148:151], v[48:51]
  v_mfma_f32_16x16x32_bf16 v[52:55], v[196:199], v[148:151], v[52:55]
  v_mfma_f32_16x16x32_bf16 v[56:59], v[180:183], v[152:155], v[56:59]
  v_mfma_f32_16x16x32_bf16 v[60:63], v[184:187], v[152:155], v[60:63]
  v_mfma_f32_16x16x32_bf16 v[64:67], v[188:191], v[152:155], v[64:67]
  v_mfma_f32_16x16x32_bf16 v[68:71], v[192:195], v[152:155], v[68:71]
  v_mfma_f32_16x16x32_bf16 v[72:75], v[196:199], v[152:155], v[72:75]
  v_mfma_f32_16x16x32_bf16 v[76:79], v[180:183], v[156:159], v[76:79]
  v_mfma_f32_16x16x32_bf16 v[80:83], v[184:187], v[156:159], v[80:83]
  v_mfma_f32_16x16x32_bf16 v[84:87], v[188:191], v[156:159], v[84:87]
  v_mfma_f32_16x16x32_bf16 v[88:91], v[192:195], v[156:159], v[88:91]
  v_mfma_f32_16x16x32_bf16 v[92:95], v[196:199], v[156:159], v[92:95]
Ph_SKIP:
  s_waitcnt lgkmcnt(0)
  v_lshrrev_b32 v1, 4, v0
  v_lshlrev_b32 v1, 6, v1
  v_xor_b32 v8, v1, v8
  v_xor_b32 v9, v1, v9
  v_and_b32 v1, 3, v0
  v_lshrrev_b32 v2, 2, v0
  v_lshlrev_b32 v3, 2, v1
  v_xor_b32 v2, v2, v3
  v_lshl_add_u32 v2, v1, 4, v2
  v_lshlrev_b32 v2, 4, v2
  ds_write_b128 v8, v[16:19] offset:0
  ds_write_b128 v8, v[20:23] offset:1024
  ds_write_b128 v8, v[24:27] offset:2048
  ds_write_b128 v8, v[28:31] offset:3072
  ds_write_b128 v8, v[32:35] offset:4096
  ds_write_b128 v8, v[36:39] offset:20480
  ds_write_b128 v8, v[40:43] offset:21504
  ds_write_b128 v8, v[44:47] offset:22528
  ds_write_b128 v8, v[48:51] offset:23552
  ds_write_b128 v8, v[52:55] offset:24576
  s_waitcnt lgkmcnt(5)
  ds_write_b128 v9, v[56:59] offset:0
  ds_write_b128 v9, v[60:63] offset:1024
  ds_write_b128 v9, v[64:67] offset:2048
  ds_write_b128 v9, v[68:71] offset:3072
  ds_write_b128 v9, v[72:75] offset:4096
  ds_write_b128 v9, v[76:79] offset:20480
  ds_write_b128 v9, v[80:83] offset:21504
  ds_write_b128 v9, v[84:87] offset:22528
  ds_write_b128 v9, v[88:91] offset:23552
  ds_write_b128 v9, v[92:95] offset:24576
  s_sub_u32 s11, s7, 0
  s_and_b32 s11, s11, 3
  s_mul_i32 s12, s11, 17408
  s_cmp_eq_u32 s11, 3
  s_cselect_b32 s12, 145408, s12
  v_add_u32 v4, s12, v2
  s_mul_i32 s12, s11, 5120
  s_add_u32 s12, s12, 63488
  v_add_u32 v228, s12, v2
  s_sub_u32 s11, s7, 1
  s_and_b32 s11, s11, 3
  s_mul_i32 s12, s11, 17408
  s_cmp_eq_u32 s11, 3
  s_cselect_b32 s12, 145408, s12
  v_add_u32 v5, s12, v2
  s_mul_i32 s12, s11, 5120
  s_add_u32 s12, s12, 83968
  v_add_u32 v229, s12, v2
  s_sub_u32 s11, s7, 2
  s_and_b32 s11, s11, 3
  s_mul_i32 s12, s11, 17408
  s_cmp_eq_u32 s11, 3
  s_cselect_b32 s12, 145408, s12
  v_add_u32 v6, s12, v2
  s_mul_i32 s12, s11, 5120
  s_add_u32 s12, s12, 104448
  v_add_u32 v230, s12, v2
  s_sub_u32 s11, s7, 3
  s_and_b32 s11, s11, 3
  s_mul_i32 s12, s11, 17408
  s_cmp_eq_u32 s11, 3
  s_cselect_b32 s12, 145408, s12
  v_add_u32 v7, s12, v2
  s_mul_i32 s12, s11, 5120
  s_add_u32 s12, s12, 124928
  v_add_u32 v231, s12, v2
  s_waitcnt lgkmcnt(10)
  ds_read_b128 v[16:19], v228 offset:0
  ds_read_b128 v[20:23], v228 offset:1024
  ds_read_b128 v[24:27], v228 offset:2048
  ds_read_b128 v[28:31], v228 offset:3072
  ds_read_b128 v[32:35], v228 offset:4096
  s_waitcnt lgkmcnt(0)
  s_barrier
  s_setprio 0
  ds_read_b128 v[36:39], v229 offset:0
  ds_read_b128 v[40:43], v230 offset:0
  ds_read_b128 v[44:47], v231 offset:0
  ds_read_b128 v[48:51], v229 offset:1024
  ds_read_b128 v[52:55], v230 offset:1024
  ds_read_b128 v[56:59], v231 offset:1024
  ds_read_b128 v[60:63], v229 offset:2048
  ds_read_b128 v[64:67], v230 offset:2048
  ds_read_b128 v[68:71], v231 offset:2048
  ds_read_b128 v[72:75], v229 offset:3072
  ds_read_b128 v[76:79], v230 offset:3072
  ds_read_b128 v[80:83], v231 offset:3072
  ds_read_b128 v[84:87], v229 offset:4096
  ds_read_b128 v[88:91], v230 offset:4096
  ds_read_b128 v[92:95], v231 offset:4096
  s_waitcnt vmcnt(0)
  v_lshlrev_b32 v14, 16, v13
  v_and_b32 v15, 0xffff0000, v13
  v_rcp_f32 v15, v15
  v_lshlrev_b32 v10, 1, v10
  v_lshlrev_b32 v168, 16, v96
  v_and_b32 v169, 0xffff0000, v96
  v_sub_f32 v160, v168, v14
  v_sub_f32 v161, v169, v14
  v_cvt_pk_bf16_f32 v160, v160, v161
  v_lshlrev_b32 v162, 16, v98
  v_and_b32 v161, 0xffff0000, v160
  v_lshlrev_b32 v160, 16, v160
  v_mul_f32 v160, v160, v15
  v_mul_f32 v161, v161, v15
  v_cvt_pk_bf16_f32 v160, v160, v161
  v_and_b32 v163, 0xffff0000, v98
  v_and_b32 v161, 0xffff0000, v160
  v_lshlrev_b32 v160, 16, v160
  v_mul_f32 v160, v160, v162
  v_mul_f32 v161, v161, v163
  v_cvt_pk_bf16_f32 v160, v160, v161
  v_lshlrev_b32 v188, 16, v160
  v_and_b32 v189, 0xffff0000, v160
  v_lshlrev_b32 v170, 16, v97
  v_and_b32 v171, 0xffff0000, v97
  v_sub_f32 v160, v170, v14
  v_sub_f32 v161, v171, v14
  v_cvt_pk_bf16_f32 v160, v160, v161
  v_lshlrev_b32 v162, 16, v99
  v_and_b32 v161, 0xffff0000, v160
  v_lshlrev_b32 v160, 16, v160
  v_mul_f32 v160, v160, v15
  v_mul_f32 v161, v161, v15
  v_cvt_pk_bf16_f32 v160, v160, v161
  v_and_b32 v163, 0xffff0000, v99
  v_and_b32 v161, 0xffff0000, v160
  v_lshlrev_b32 v160, 16, v160
  v_mul_f32 v160, v160, v162
  v_mul_f32 v161, v161, v163
  v_cvt_pk_bf16_f32 v160, v160, v161
  v_lshlrev_b32 v190, 16, v160
  v_and_b32 v191, 0xffff0000, v160
  v_lshlrev_b32 v172, 16, v100
  v_and_b32 v173, 0xffff0000, v100
  v_sub_f32 v160, v172, v14
  v_sub_f32 v161, v173, v14
  v_cvt_pk_bf16_f32 v160, v160, v161
  v_lshlrev_b32 v162, 16, v102
  v_and_b32 v161, 0xffff0000, v160
  v_lshlrev_b32 v160, 16, v160
  v_mul_f32 v160, v160, v15
  v_mul_f32 v161, v161, v15
  v_cvt_pk_bf16_f32 v160, v160, v161
  v_and_b32 v163, 0xffff0000, v102
  v_and_b32 v161, 0xffff0000, v160
  v_lshlrev_b32 v160, 16, v160
  v_mul_f32 v160, v160, v162
  v_mul_f32 v161, v161, v163
  v_cvt_pk_bf16_f32 v160, v160, v161
  v_lshlrev_b32 v192, 16, v160
  v_and_b32 v193, 0xffff0000, v160
  v_lshlrev_b32 v174, 16, v101
  v_and_b32 v175, 0xffff0000, v101
  v_sub_f32 v160, v174, v14
  v_sub_f32 v161, v175, v14
  v_cvt_pk_bf16_f32 v160, v160, v161
  v_lshlrev_b32 v162, 16, v103
  v_and_b32 v161, 0xffff0000, v160
  v_lshlrev_b32 v160, 16, v160
  v_mul_f32 v160, v160, v15
  v_mul_f32 v161, v161, v15
  v_cvt_pk_bf16_f32 v160, v160, v161
  v_and_b32 v163, 0xffff0000, v103
  v_and_b32 v161, 0xffff0000, v160
  v_lshlrev_b32 v160, 16, v160
  v_mul_f32 v160, v160, v162
  v_mul_f32 v161, v161, v163
  v_cvt_pk_bf16_f32 v160, v160, v161
  v_lshlrev_b32 v194, 16, v160
  v_and_b32 v195, 0xffff0000, v160
  v_lshlrev_b32 v176, 16, v104
  v_and_b32 v177, 0xffff0000, v104
  v_sub_f32 v160, v176, v14
  v_sub_f32 v161, v177, v14
  v_cvt_pk_bf16_f32 v160, v160, v161
  v_lshlrev_b32 v162, 16, v106
  v_and_b32 v161, 0xffff0000, v160
  v_lshlrev_b32 v160, 16, v160
  v_mul_f32 v160, v160, v15
  v_mul_f32 v161, v161, v15
  v_cvt_pk_bf16_f32 v160, v160, v161
  v_and_b32 v163, 0xffff0000, v106
  v_and_b32 v161, 0xffff0000, v160
  v_lshlrev_b32 v160, 16, v160
  v_mul_f32 v160, v160, v162
  v_mul_f32 v161, v161, v163
  v_cvt_pk_bf16_f32 v160, v160, v161
  v_lshlrev_b32 v196, 16, v160
  v_and_b32 v197, 0xffff0000, v160
  v_lshlrev_b32 v178, 16, v105
  v_and_b32 v179, 0xffff0000, v105
  v_sub_f32 v160, v178, v14
  v_sub_f32 v161, v179, v14
  v_cvt_pk_bf16_f32 v160, v160, v161
  v_lshlrev_b32 v162, 16, v107
  v_and_b32 v161, 0xffff0000, v160
  v_lshlrev_b32 v160, 16, v160
  v_mul_f32 v160, v160, v15
  v_mul_f32 v161, v161, v15
  v_cvt_pk_bf16_f32 v160, v160, v161
  v_and_b32 v163, 0xffff0000, v107
  v_and_b32 v161, 0xffff0000, v160
  v_lshlrev_b32 v160, 16, v160
  v_mul_f32 v160, v160, v162
  v_mul_f32 v161, v161, v163
  v_cvt_pk_bf16_f32 v160, v160, v161
  v_lshlrev_b32 v198, 16, v160
  v_and_b32 v199, 0xffff0000, v160
  v_lshlrev_b32 v180, 16, v108
  v_and_b32 v181, 0xffff0000, v108
  v_sub_f32 v160, v180, v14
  v_sub_f32 v161, v181, v14
  v_cvt_pk_bf16_f32 v160, v160, v161
  v_lshlrev_b32 v162, 16, v110
  v_and_b32 v161, 0xffff0000, v160
  v_lshlrev_b32 v160, 16, v160
  v_mul_f32 v160, v160, v15
  v_mul_f32 v161, v161, v15
  v_cvt_pk_bf16_f32 v160, v160, v161
  v_and_b32 v163, 0xffff0000, v110
  v_and_b32 v161, 0xffff0000, v160
  v_lshlrev_b32 v160, 16, v160
  v_mul_f32 v160, v160, v162
  v_mul_f32 v161, v161, v163
  v_cvt_pk_bf16_f32 v160, v160, v161
  v_lshlrev_b32 v200, 16, v160
  v_and_b32 v201, 0xffff0000, v160
  v_lshlrev_b32 v182, 16, v109
  v_and_b32 v183, 0xffff0000, v109
  v_sub_f32 v160, v182, v14
  v_sub_f32 v161, v183, v14
  v_cvt_pk_bf16_f32 v160, v160, v161
  v_lshlrev_b32 v162, 16, v111
  v_and_b32 v161, 0xffff0000, v160
  v_lshlrev_b32 v160, 16, v160
  v_mul_f32 v160, v160, v15
  v_mul_f32 v161, v161, v15
  v_cvt_pk_bf16_f32 v160, v160, v161
  v_and_b32 v163, 0xffff0000, v111
  v_and_b32 v161, 0xffff0000, v160
  v_lshlrev_b32 v160, 16, v160
  v_mul_f32 v160, v160, v162
  v_mul_f32 v161, v161, v163
  v_cvt_pk_bf16_f32 v160, v160, v161
  v_lshlrev_b32 v202, 16, v160
  v_and_b32 v203, 0xffff0000, v160
  v_lshlrev_b32 v184, 16, v240
  v_and_b32 v185, 0xffff0000, v240
  v_sub_f32 v160, v184, v14
  v_sub_f32 v161, v185, v14
  v_cvt_pk_bf16_f32 v160, v160, v161
  v_lshlrev_b32 v162, 16, v242
  v_and_b32 v161, 0xffff0000, v160
  v_lshlrev_b32 v160, 16, v160
  v_mul_f32 v160, v160, v15
  v_mul_f32 v161, v161, v15
  v_cvt_pk_bf16_f32 v160, v160, v161
  v_and_b32 v163, 0xffff0000, v242
  v_and_b32 v161, 0xffff0000, v160
  v_lshlrev_b32 v160, 16, v160
  v_mul_f32 v160, v160, v162
  v_mul_f32 v161, v161, v163
  v_cvt_pk_bf16_f32 v160, v160, v161
  v_lshlrev_b32 v204, 16, v160
  v_and_b32 v205, 0xffff0000, v160
  v_lshlrev_b32 v186, 16, v241
  v_and_b32 v187, 0xffff0000, v241
  v_sub_f32 v160, v186, v14
  v_sub_f32 v161, v187, v14
  v_cvt_pk_bf16_f32 v160, v160, v161
  v_lshlrev_b32 v162, 16, v243
  v_and_b32 v161, 0xffff0000, v160
  v_lshlrev_b32 v160, 16, v160
  v_mul_f32 v160, v160, v15
  v_mul_f32 v161, v161, v15
  v_cvt_pk_bf16_f32 v160, v160, v161
  v_and_b32 v163, 0xffff0000, v243
  v_and_b32 v161, 0xffff0000, v160
  v_lshlrev_b32 v160, 16, v160
  v_mul_f32 v160, v160, v162
  v_mul_f32 v161, v161, v163
  v_cvt_pk_bf16_f32 v160, v160, v161
  v_lshlrev_b32 v206, 16, v160
  v_and_b32 v207, 0xffff0000, v160
  v_mul_f32 v15, v15, v15
  s_mov_b32 s13, 0xbfb8aa3b
  s_waitcnt lgkmcnt(0)
  v_add_f32 v160, v16, v36
  v_add_f32 v40, v40, v44
  v_add_f32 v160, v160, v40
  v_mul_f32 v160, v160, v15
  v_add_f32 v161, v17, v37
  v_add_f32 v41, v41, v45
  v_add_f32 v161, v161, v41
  v_mul_f32 v161, v161, v15
  v_add_f32 v162, v18, v38
  v_add_f32 v42, v42, v46
  v_add_f32 v162, v162, v42
  v_mul_f32 v162, v162, v15
  v_add_f32 v163, v19, v39
  v_add_f32 v43, v43, v47
  v_add_f32 v163, v163, v43
  v_mul_f32 v163, v163, v15
  v_cvt_pk_bf16_f32 v160, v160, v161
  v_cvt_pk_bf16_f32 v162, v162, v163
  v_and_b32 v161, 0xffff0000, v160
  v_lshlrev_b32 v160, 16, v160
  v_and_b32 v163, 0xffff0000, v162
  v_lshlrev_b32 v162, 16, v162
  v_mul_f32 v36, s13, v160
  v_mul_f32 v37, s13, v161
  v_mul_f32 v38, s13, v162
  v_mul_f32 v39, s13, v163
  v_exp_f32 v36, v36
  v_exp_f32 v37, v37
  v_exp_f32 v38, v38
  v_exp_f32 v39, v39
  v_add_f32 v36, 1.0, v36
  v_add_f32 v37, 1.0, v37
  v_add_f32 v38, 1.0, v38
  v_add_f32 v39, 1.0, v39
  v_rcp_f32 v36, v36
  v_rcp_f32 v37, v37
  v_rcp_f32 v38, v38
  v_rcp_f32 v39, v39
  v_mul_f32 v160, v160, v36
  v_mul_f32 v161, v161, v37
  v_mul_f32 v162, v162, v38
  v_mul_f32 v163, v163, v39
  v_cvt_pk_bf16_f32 v160, v160, v161
  v_cvt_pk_bf16_f32 v162, v162, v163
  v_and_b32 v209, 0xffff0000, v160
  v_lshlrev_b32 v208, 16, v160
  v_and_b32 v211, 0xffff0000, v162
  v_lshlrev_b32 v210, 16, v162
  v_add_f32 v160, v20, v48
  v_add_f32 v52, v52, v56
  v_add_f32 v160, v160, v52
  v_mul_f32 v160, v160, v15
  v_add_f32 v161, v21, v49
  v_add_f32 v53, v53, v57
  v_add_f32 v161, v161, v53
  v_mul_f32 v161, v161, v15
  v_add_f32 v162, v22, v50
  v_add_f32 v54, v54, v58
  v_add_f32 v162, v162, v54
  v_mul_f32 v162, v162, v15
  v_add_f32 v163, v23, v51
  v_add_f32 v55, v55, v59
  v_add_f32 v163, v163, v55
  v_mul_f32 v163, v163, v15
  v_cvt_pk_bf16_f32 v160, v160, v161
  v_cvt_pk_bf16_f32 v162, v162, v163
  v_and_b32 v161, 0xffff0000, v160
  v_lshlrev_b32 v160, 16, v160
  v_and_b32 v163, 0xffff0000, v162
  v_lshlrev_b32 v162, 16, v162
  v_mul_f32 v48, s13, v160
  v_mul_f32 v49, s13, v161
  v_mul_f32 v50, s13, v162
  v_mul_f32 v51, s13, v163
  v_exp_f32 v48, v48
  v_exp_f32 v49, v49
  v_exp_f32 v50, v50
  v_exp_f32 v51, v51
  v_add_f32 v48, 1.0, v48
  v_add_f32 v49, 1.0, v49
  v_add_f32 v50, 1.0, v50
  v_add_f32 v51, 1.0, v51
  v_rcp_f32 v48, v48
  v_rcp_f32 v49, v49
  v_rcp_f32 v50, v50
  v_rcp_f32 v51, v51
  v_mul_f32 v160, v160, v48
  v_mul_f32 v161, v161, v49
  v_mul_f32 v162, v162, v50
  v_mul_f32 v163, v163, v51
  v_cvt_pk_bf16_f32 v160, v160, v161
  v_cvt_pk_bf16_f32 v162, v162, v163
  v_and_b32 v213, 0xffff0000, v160
  v_lshlrev_b32 v212, 16, v160
  v_and_b32 v215, 0xffff0000, v162
  v_lshlrev_b32 v214, 16, v162
  v_add_f32 v160, v24, v60
  v_add_f32 v64, v64, v68
  v_add_f32 v160, v160, v64
  v_mul_f32 v160, v160, v15
  v_add_f32 v161, v25, v61
  v_add_f32 v65, v65, v69
  v_add_f32 v161, v161, v65
  v_mul_f32 v161, v161, v15
  v_add_f32 v162, v26, v62
  v_add_f32 v66, v66, v70
  v_add_f32 v162, v162, v66
  v_mul_f32 v162, v162, v15
  v_add_f32 v163, v27, v63
  v_add_f32 v67, v67, v71
  v_add_f32 v163, v163, v67
  v_mul_f32 v163, v163, v15
  v_cvt_pk_bf16_f32 v160, v160, v161
  v_cvt_pk_bf16_f32 v162, v162, v163
  v_and_b32 v161, 0xffff0000, v160
  v_lshlrev_b32 v160, 16, v160
  v_and_b32 v163, 0xffff0000, v162
  v_lshlrev_b32 v162, 16, v162
  v_mul_f32 v60, s13, v160
  v_mul_f32 v61, s13, v161
  v_mul_f32 v62, s13, v162
  v_mul_f32 v63, s13, v163
  v_exp_f32 v60, v60
  v_exp_f32 v61, v61
  v_exp_f32 v62, v62
  v_exp_f32 v63, v63
  v_add_f32 v60, 1.0, v60
  v_add_f32 v61, 1.0, v61
  v_add_f32 v62, 1.0, v62
  v_add_f32 v63, 1.0, v63
  v_rcp_f32 v60, v60
  v_rcp_f32 v61, v61
  v_rcp_f32 v62, v62
  v_rcp_f32 v63, v63
  v_mul_f32 v160, v160, v60
  v_mul_f32 v161, v161, v61
  v_mul_f32 v162, v162, v62
  v_mul_f32 v163, v163, v63
  v_cvt_pk_bf16_f32 v160, v160, v161
  v_cvt_pk_bf16_f32 v162, v162, v163
  v_and_b32 v217, 0xffff0000, v160
  v_lshlrev_b32 v216, 16, v160
  v_and_b32 v219, 0xffff0000, v162
  v_lshlrev_b32 v218, 16, v162
  v_add_f32 v160, v28, v72
  v_add_f32 v76, v76, v80
  v_add_f32 v160, v160, v76
  v_mul_f32 v160, v160, v15
  v_add_f32 v161, v29, v73
  v_add_f32 v77, v77, v81
  v_add_f32 v161, v161, v77
  v_mul_f32 v161, v161, v15
  v_add_f32 v162, v30, v74
  v_add_f32 v78, v78, v82
  v_add_f32 v162, v162, v78
  v_mul_f32 v162, v162, v15
  v_add_f32 v163, v31, v75
  v_add_f32 v79, v79, v83
  v_add_f32 v163, v163, v79
  v_mul_f32 v163, v163, v15
  v_cvt_pk_bf16_f32 v160, v160, v161
  v_cvt_pk_bf16_f32 v162, v162, v163
  v_and_b32 v161, 0xffff0000, v160
  v_lshlrev_b32 v160, 16, v160
  v_and_b32 v163, 0xffff0000, v162
  v_lshlrev_b32 v162, 16, v162
  v_mul_f32 v72, s13, v160
  v_mul_f32 v73, s13, v161
  v_mul_f32 v74, s13, v162
  v_mul_f32 v75, s13, v163
  v_exp_f32 v72, v72
  v_exp_f32 v73, v73
  v_exp_f32 v74, v74
  v_exp_f32 v75, v75
  v_add_f32 v72, 1.0, v72
  v_add_f32 v73, 1.0, v73
  v_add_f32 v74, 1.0, v74
  v_add_f32 v75, 1.0, v75
  v_rcp_f32 v72, v72
  v_rcp_f32 v73, v73
  v_rcp_f32 v74, v74
  v_rcp_f32 v75, v75
  v_mul_f32 v160, v160, v72
  v_mul_f32 v161, v161, v73
  v_mul_f32 v162, v162, v74
  v_mul_f32 v163, v163, v75
  v_cvt_pk_bf16_f32 v160, v160, v161
  v_cvt_pk_bf16_f32 v162, v162, v163
  v_and_b32 v221, 0xffff0000, v160
  v_lshlrev_b32 v220, 16, v160
  v_and_b32 v223, 0xffff0000, v162
  v_lshlrev_b32 v222, 16, v162
  v_add_f32 v160, v32, v84
  v_add_f32 v88, v88, v92
  v_add_f32 v160, v160, v88
  v_mul_f32 v160, v160, v15
  v_add_f32 v161, v33, v85
  v_add_f32 v89, v89, v93
  v_add_f32 v161, v161, v89
  v_mul_f32 v161, v161, v15
  v_add_f32 v162, v34, v86
  v_add_f32 v90, v90, v94
  v_add_f32 v162, v162, v90
  v_mul_f32 v162, v162, v15
  v_add_f32 v163, v35, v87
  v_add_f32 v91, v91, v95
  v_add_f32 v163, v163, v91
  v_mul_f32 v163, v163, v15
  v_cvt_pk_bf16_f32 v160, v160, v161
  v_cvt_pk_bf16_f32 v162, v162, v163
  v_and_b32 v161, 0xffff0000, v160
  v_lshlrev_b32 v160, 16, v160
  v_and_b32 v163, 0xffff0000, v162
  v_lshlrev_b32 v162, 16, v162
  v_mul_f32 v84, s13, v160
  v_mul_f32 v85, s13, v161
  v_mul_f32 v86, s13, v162
  v_mul_f32 v87, s13, v163
  v_exp_f32 v84, v84
  v_exp_f32 v85, v85
  v_exp_f32 v86, v86
  v_exp_f32 v87, v87
  v_add_f32 v84, 1.0, v84
  v_add_f32 v85, 1.0, v85
  v_add_f32 v86, 1.0, v86
  v_add_f32 v87, 1.0, v87
  v_rcp_f32 v84, v84
  v_rcp_f32 v85, v85
  v_rcp_f32 v86, v86
  v_rcp_f32 v87, v87
  v_mul_f32 v160, v160, v84
  v_mul_f32 v161, v161, v85
  v_mul_f32 v162, v162, v86
  v_mul_f32 v163, v163, v87
  v_cvt_pk_bf16_f32 v160, v160, v161
  v_cvt_pk_bf16_f32 v162, v162, v163
  v_and_b32 v225, 0xffff0000, v160
  v_lshlrev_b32 v224, 16, v160
  v_and_b32 v227, 0xffff0000, v162
  v_lshlrev_b32 v226, 16, v162
  s_barrier
  ds_read_b128 v[16:19], v228 offset:0
  ds_read_b128 v[20:23], v5 offset:0
  ds_read_b128 v[24:27], v6 offset:5120
  ds_read_b128 v[28:31], v7 offset:10240
  ds_read_b128 v[32:35], v228 offset:1024
  ds_read_b128 v[36:39], v5 offset:1024
  ds_read_b128 v[40:43], v6 offset:6144
  ds_read_b128 v[44:47], v7 offset:11264
  ds_read_b128 v[48:51], v228 offset:2048
  ds_read_b128 v[52:55], v5 offset:2048
  ds_read_b128 v[56:59], v6 offset:7168
  ds_read_b128 v[60:63], v7 offset:12288
  s_waitcnt lgkmcnt(8)
  ds_read_b128 v[64:67], v228 offset:3072
  ds_read_b128 v[68:71], v5 offset:3072
  ds_read_b128 v[72:75], v6 offset:8192
  ds_read_b128 v[76:79], v7 offset:13312
  v_pk_add_f32 v[16:17], v[16:17], v[20:21]
  v_pk_add_f32 v[24:25], v[24:25], v[28:29]
  v_pk_add_f32 v[16:17], v[16:17], v[24:25]
  v_pk_add_f32 v[16:17], v[16:17], v[188:189]
  v_pk_fma_f32 v[16:17], v[16:17], v[208:209], v[168:169]
  v_pk_add_f32 v[18:19], v[18:19], v[22:23]
  v_pk_add_f32 v[26:27], v[26:27], v[30:31]
  v_pk_add_f32 v[18:19], v[18:19], v[26:27]
  v_pk_add_f32 v[18:19], v[18:19], v[190:191]
  v_pk_fma_f32 v[18:19], v[18:19], v[210:211], v[170:171]
  buffer_store_dwordx4 v[16:19], v10, s[60:63], 0 offen offset:0 nt
  s_waitcnt lgkmcnt(8)
  ds_read_b128 v[80:83], v228 offset:4096
  ds_read_b128 v[84:87], v5 offset:4096
  ds_read_b128 v[88:91], v6 offset:9216
  ds_read_b128 v[92:95], v7 offset:14336
  v_pk_add_f32 v[32:33], v[32:33], v[36:37]
  v_pk_add_f32 v[40:41], v[40:41], v[44:45]
  v_pk_add_f32 v[32:33], v[32:33], v[40:41]
  v_pk_add_f32 v[32:33], v[32:33], v[192:193]
  v_pk_fma_f32 v[32:33], v[32:33], v[212:213], v[172:173]
  v_pk_add_f32 v[34:35], v[34:35], v[38:39]
  v_pk_add_f32 v[42:43], v[42:43], v[46:47]
  v_pk_add_f32 v[34:35], v[34:35], v[42:43]
  v_pk_add_f32 v[34:35], v[34:35], v[194:195]
  v_pk_fma_f32 v[34:35], v[34:35], v[214:215], v[174:175]
  buffer_store_dwordx4 v[32:35], v10, s[60:63], 0 offen offset:64 nt
  s_waitcnt lgkmcnt(8)
  v_pk_add_f32 v[48:49], v[48:49], v[52:53]
  v_pk_add_f32 v[56:57], v[56:57], v[60:61]
  v_pk_add_f32 v[48:49], v[48:49], v[56:57]
  v_pk_add_f32 v[48:49], v[48:49], v[196:197]
  v_pk_fma_f32 v[48:49], v[48:49], v[216:217], v[176:177]
  v_pk_add_f32 v[50:51], v[50:51], v[54:55]
  v_pk_add_f32 v[58:59], v[58:59], v[62:63]
  v_pk_add_f32 v[50:51], v[50:51], v[58:59]
  v_pk_add_f32 v[50:51], v[50:51], v[198:199]
  v_pk_fma_f32 v[50:51], v[50:51], v[218:219], v[178:179]
  buffer_store_dwordx4 v[48:51], v10, s[60:63], 0 offen offset:128 nt
  s_waitcnt lgkmcnt(4)
  v_pk_add_f32 v[64:65], v[64:65], v[68:69]
  v_pk_add_f32 v[72:73], v[72:73], v[76:77]
  v_pk_add_f32 v[64:65], v[64:65], v[72:73]
  v_pk_add_f32 v[64:65], v[64:65], v[200:201]
  v_pk_fma_f32 v[64:65], v[64:65], v[220:221], v[180:181]
  v_pk_add_f32 v[66:67], v[66:67], v[70:71]
  v_pk_add_f32 v[74:75], v[74:75], v[78:79]
  v_pk_add_f32 v[66:67], v[66:67], v[74:75]
  v_pk_add_f32 v[66:67], v[66:67], v[202:203]
  v_pk_fma_f32 v[66:67], v[66:67], v[222:223], v[182:183]
  buffer_store_dwordx4 v[64:67], v10, s[60:63], 0 offen offset:192 nt
  s_waitcnt lgkmcnt(0)
  v_pk_add_f32 v[80:81], v[80:81], v[84:85]
  v_pk_add_f32 v[88:89], v[88:89], v[92:93]
  v_pk_add_f32 v[80:81], v[80:81], v[88:89]
  v_pk_add_f32 v[80:81], v[80:81], v[204:205]
  v_pk_fma_f32 v[80:81], v[80:81], v[224:225], v[184:185]
  v_pk_add_f32 v[82:83], v[82:83], v[86:87]
  v_pk_add_f32 v[90:91], v[90:91], v[94:95]
  v_pk_add_f32 v[82:83], v[82:83], v[90:91]
  v_pk_add_f32 v[82:83], v[82:83], v[206:207]
  v_pk_fma_f32 v[82:83], v[82:83], v[226:227], v[186:187]
  buffer_store_dwordx4 v[80:83], v10, s[60:63], 0 offen offset:256 nt
  s_endpgm
K1_END:
  s_endpgm
.section .rodata,"a"
.p2align 6
.amdhsa_kernel recurrent_scan__ssm_conv_s5__glu_gated_reglu__prompt_kernel
  .amdhsa_next_free_vgpr 256
  .amdhsa_next_free_sgpr 102
  .amdhsa_accum_offset 256
  .amdhsa_group_segment_fixed_size 0
  .amdhsa_kernarg_size 128
  .amdhsa_user_sgpr_count 2
  .amdhsa_user_sgpr_kernarg_segment_ptr 1
  .amdhsa_system_sgpr_workgroup_id_x 1
.end_amdhsa_kernel
```
